```python
import torch

def _softmax(x, axis=-1):
    return torch.softmax(x, dim=axis)
def _gelu(x):
    return torch.nn.functional.gelu(x, approximate="tanh")
def _silu(x):
    return torch.nn.functional.silu(x)
def _sigmoid(x):
    return torch.sigmoid(x)
def _layernorm(x, axis=-1, eps=1e-5):
    m = x.mean(dim=axis, keepdim=True)
    v = x.var(dim=axis, keepdim=True, unbiased=False)
    return (x - m) / torch.sqrt(v + eps)
def _scatter_add(tgt, idx, src, axis=0):
    return tgt.clone().index_add_(axis, idx, src)
def _segment_sum(src, seg, n):
    out = torch.zeros((n,) + src.shape[1:], dtype=src.dtype)
    return out.index_add_(0, seg, src)
def _pad(x, pw):
    flat = tuple(v for pair in reversed(pw) for v in pair)
    return torch.nn.functional.pad(x, flat)

kernel_name = 'concat_heads__linear_attn_block__ssm_conv_s4d__prompt'

def setup_inputs():

    _w = (lambda a: (lambda t: t.to(torch.bfloat16) if t.is_floating_point() else t)(torch.as_tensor(a)))
    def _A_setup():
        B, S, D = 1, 2048, 640
        return {
            "x": _w((lambda *s: torch.randn(*s, dtype=torch.bfloat16) * 0.05)(B, S, D)),
            "wqkv": _w((lambda *s: torch.randn(*s, dtype=torch.bfloat16) * 0.4)(D, 3 * D)),
            "wo": _w((lambda *s: torch.randn(*s, dtype=torch.bfloat16) * 0.05)(D, D)),
        }
    _A_in = _A_setup()

    def _B_setup():
        Bsz, L, D, N = 1, 2048, 640, 192
        return {
            "u": _w((lambda *s: torch.randn(*s, dtype=torch.bfloat16) * 0.05)(Bsz, L, D)),
            "log_A_real": _w((lambda *s: torch.randn(*s, dtype=torch.bfloat16) * 6.4)(D, N) * 0.5),
            "A_imag": _w((lambda *s: torch.randn(*s, dtype=torch.bfloat16) * 0.05)(D, N) * 3.14),
            "C_real": _w((lambda *s: torch.randn(*s, dtype=torch.bfloat16) * 0.1)(D, N) / N ** 0.5),
            "C_imag": _w((lambda *s: torch.randn(*s, dtype=torch.bfloat16) * 0.1)(D, N) / N ** 0.5),
            "log_dt": _w((lambda *s: torch.randn(*s, dtype=torch.bfloat16) * 0.05)(D) * 0.5 - 4.0),
            "D_skip": _w((lambda *s: torch.randn(*s, dtype=torch.bfloat16) * 0.05)(D)),
        }
    _B_in = _B_setup()

    return {
        "A_x": _A_in["x"],
        "A_wqkv": _A_in["wqkv"],
        "A_wo": _A_in["wo"],
        "B_u": _B_in["u"],
        "B_log_A_real": _B_in["log_A_real"],
        "B_A_imag": _B_in["A_imag"],
        "B_C_real": _B_in["C_real"],
        "B_C_imag": _B_in["C_imag"],
        "B_log_dt": _B_in["log_dt"],
        "B_D_skip": _B_in["D_skip"],
    }

def reference(A_x, A_wqkv, A_wo, B_u, B_log_A_real, B_A_imag, B_C_real, B_C_imag, B_log_dt, B_D_skip):
    def _A_ref(x, wqkv, wo):
        B, S, D = x.shape
        H = 32; Dh = D // H
        qkv = (lambda x, *d: x.permute(*d))((x @ wqkv).reshape(B, S, 3, H, Dh), 2, 0, 3, 1, 4)
        q, k, v = qkv[0], qkv[1], qkv[2]
        phi = lambda t: torch.where(t > 0, t + 1, torch.exp(t)) + 1e-6
        pq, pk = phi(q), phi(k)
        kv = torch.einsum("bhsd,bhse->bhde", pk, v)
        z = torch.einsum("bhsd->bhd", pk)
        num = torch.einsum("bhqd,bhde->bhqe", pq, kv)
        den = torch.einsum("bhqd,bhd->bhq", pq, z)[..., None] + 1e-6
        o = num / den
        return (lambda x, *d: x.permute(*d))(o, 0, 2, 1, 3).reshape(B, S, D) @ wo

    def _B_ref(u, log_A_real, A_imag, C_real, C_imag, log_dt, D_skip):
        L = u.shape[1]
        dt = torch.exp(log_dt)
        A = -torch.exp(log_A_real) + 1j * A_imag
        C = (C_real + 1j * C_imag) * dt[:, None]
        pos = (lambda x, dt: x.to(dt))(torch.arange(L), log_dt.dtype)
        P = torch.exp((A * dt[:, None])[:, :, None] * pos[None, None, :])
        K = 2.0 * torch.einsum("dn,dnl->dl", C, P).real
        L2 = 2 * L
        u_t = (lambda x, *d: x.permute(*d))(u, 0, 2, 1)
        Kf = (lambda x, *a, **k: torch.fft.rfft(x.float(), *a, **k))(K, L2)
        Uf = (lambda x, *a, **k: torch.fft.rfft(x.float(), *a, **k))(u_t, L2)
        y = (lambda x, *a, **k: torch.fft.irfft(x, *a, **k).to(torch.bfloat16))(Uf * Kf[None, :, :], L2)[:, :, :L]
        y = (lambda x, *d: x.permute(*d))(y, 0, 2, 1)
        return y + u * D_skip[None, None, :]

    a = _A_ref(A_x, A_wqkv, A_wo)
    b = _B_ref(B_u, B_log_A_real, B_A_imag, B_C_real, B_C_imag, B_log_dt, B_D_skip)
    return torch.concatenate([a, b], axis=-1)
```

```asm
; @launch grid=(352,1,1) block=(512,1,1) lds=81920
.amdgcn_target "amdgcn-amd-amdhsa--gfx950"
.text
.globl concat_heads__linear_attn_block__ssm_conv_s4d__prompt_kernel
.p2align 8
.type concat_heads__linear_attn_block__ssm_conv_s4d__prompt_kernel,@function
concat_heads__linear_attn_block__ssm_conv_s4d__prompt_kernel:
    s_cmp_ge_u32 s2, 352
    s_cbranch_scc1 K1_EXIT
    s_load_dwordx16 s[16:31], s[0:1], 0
    s_load_dwordx8 s[32:39], s[0:1], 64
    s_load_dwordx2 s[40:41], s[0:1], 96
    v_lshrrev_b32 v1, 6, v0
    s_mov_b32 s84, 0x3fb8aa3b
    v_readfirstlane_b32 s3, v1
    s_mov_b32 s85, 0xffff0000
    s_mov_b32 s86, 0x358637bd
    v_and_b32 v1, 63, v0
    v_lshrrev_b32 v2, 4, v1
    v_and_b32 v3, 15, v1
    s_waitcnt lgkmcnt(0)
    s_cmp_lt_u32 s2, 64
    s_cbranch_scc1 K1_MAPQ0
    s_cmp_lt_u32 s2, 96
    s_cbranch_scc1 K1_MAPB0
    s_cmp_lt_u32 s2, 224
    s_cbranch_scc1 K1_MAPKV
    s_branch K1_KGEN
K1_MAPQ0:
    s_add_u32 s2, s2, 128
    s_branch K1_Q
K1_MAPB0:
    s_add_u32 s2, s2, 128
    s_branch K1_KGEN
K1_MAPKV:
    s_sub_u32 s2, s2, 96
    s_setprio 3
    s_and_b32 s4, s2, 7
    s_lshr_b32 s5, s2, 3
    s_lshr_b32 s10, s4, 1
    s_lshl_b32 s10, s10, 2
    s_and_b32 s6, s5, 3
    s_add_u32 s10, s10, s6
    s_and_b32 s14, s4, 1
    s_lshl_b32 s14, s14, 2
    s_lshr_b32 s6, s5, 2
    s_add_u32 s14, s14, s6
    s_mul_i32 s4, s14, 160
    s_add_u32 s8, s4, 1280
    s_add_u32 s9, s4, 2480
    s_add_u32 s52, s40, 4194304
    s_addc_u32 s53, s41, 0
    s_and_b32 s53, s53, 0xffff
    s_mov_b32 s54, 64768
    s_mov_b32 s55, 0x00020000
    s_mov_b32 s60, s38
    s_and_b32 s61, s39, 0xffff
    s_mov_b32 s62, 256
    s_mov_b32 s63, 0x00020000
    s_mul_i32 s15, s14, 8096
    s_lshl_b32 s5, s14, 2
    v_mov_b32 v125, s5
    s_cmp_eq_u32 s10, 0
    s_cselect_b32 s5, s15, 0x40000000
    v_mov_b32 v84, 0
    v_mov_b32 v85, 0
    v_mov_b32 v86, 0
    v_mov_b32 v87, 0
    v_lshlrev_b32 v13, 4, v0
    v_cmp_gt_u32 vcc, 8096, v13
    v_mov_b32 v15, 0x7ffffff0
    s_nop 0
    v_cndmask_b32 v13, v15, v13, vcc
    buffer_store_dwordx4 v[84:87], v13, s[52:55], s5 offen sc1
    s_mov_b32 s44, s16
    s_and_b32 s45, s17, 0xffff
    s_mov_b32 s46, 2621440
    s_mov_b32 s47, 0x00020000
    s_mov_b32 s48, s18
    s_and_b32 s49, s19, 0xffff
    s_mov_b32 s50, 2457600
    s_mov_b32 s51, 0x00020000
    s_and_b32 s88, s3, 3
    s_lshr_b32 s89, s3, 2
    s_mov_b32 s90, 0xffff
    s_mov_b32 s91, 0
    v_lshrrev_b32 v13, 2, v1
    v_lshrrev_b32 v14, 4, v1
    v_sub_u32 v14, 0, v14
    v_xor_b32 v14, v14, v1
    v_and_b32 v14, 3, v14
    s_lshl_b32 s4, s10, 7
    s_lshl_b32 s5, s3, 4
    s_add_u32 s4, s4, s5
    v_add_u32 v13, s4, v13
    s_movk_i32 s5, 1280
    v_mul_u32_u24 v13, s5, v13
    v_lshl_add_u32 v4, v14, 4, v13
    s_mul_i32 s4, s3, 80
    s_mov_b32 s5, 3277
    s_mov_b32 s6, 3840
    v_add_u32 v13, s4, v1
    v_mul_u32_u24 v14, s5, v13
    v_lshrrev_b32 v14, 16, v14
    v_mul_u32_u24 v15, 20, v14
    v_sub_u32 v15, v13, v15
    v_bfe_u32 v16, v14, 3, 1
    v_lshlrev_b32 v16, 1, v16
    v_xor_b32 v15, v15, v16
    v_cmp_le_u32 vcc, 10, v15
    v_mul_u32_u24 v14, s6, v14
    v_cndmask_b32 v16, 0, 1, vcc
    v_mul_u32_u24 v17, 10, v16
    v_sub_u32 v15, v15, v17
    v_mul_u32_u24 v16, 80, v16
    v_cmp_gt_u32 vcc, 5, v15
    v_mov_b32 v17, s9
    v_mov_b32 v18, s8
    v_lshl_add_u32 v14, v15, 4, v14
    v_cndmask_b32 v17, v17, v18, vcc
    v_add3_u32 v5, v14, v16, v17
    v_add_u32 v13, s4, v1
    v_add_u32 v13, 64, v13
    v_mul_u32_u24 v14, s5, v13
    v_lshrrev_b32 v14, 16, v14
    v_mul_u32_u24 v15, 20, v14
    v_sub_u32 v15, v13, v15
    v_bfe_u32 v16, v14, 3, 1
    v_lshlrev_b32 v16, 1, v16
    v_xor_b32 v15, v15, v16
    v_cmp_le_u32 vcc, 10, v15
    v_mul_u32_u24 v14, s6, v14
    v_cndmask_b32 v16, 0, 1, vcc
    v_mul_u32_u24 v17, 10, v16
    v_sub_u32 v15, v15, v17
    v_mul_u32_u24 v16, 80, v16
    v_cmp_gt_u32 vcc, 5, v15
    v_mov_b32 v17, s9
    v_mov_b32 v18, s8
    v_lshl_add_u32 v14, v15, 4, v14
    v_cndmask_b32 v17, v17, v18, vcc
    v_add3_u32 v6, v14, v16, v17
    s_mul_i32 s12, s3, 1280
    buffer_load_dwordx4 v[60:63], v4, s[44:47], 0 offen offset:0
    buffer_load_dwordx4 v[64:67], v4, s[44:47], 0 offen offset:64
    s_add_u32 m0, s12, 0
    s_mov_b32 s13, 0
    buffer_load_dwordx4 v5, s[48:51], s13 offen lds
    s_add_u32 m0, s12, 1024
    s_mov_b64 exec, s[90:91]
    buffer_load_dwordx4 v6, s[48:51], s13 offen lds
    s_mov_b64 exec, -1
    buffer_load_dwordx4 v[68:71], v4, s[44:47], 0 offen offset:128
    s_add_u32 m0, s12, 10240
    s_mov_b32 s13, 122880
    buffer_load_dwordx4 v5, s[48:51], s13 offen lds
    s_add_u32 m0, s12, 11264
    s_mov_b64 exec, s[90:91]
    buffer_load_dwordx4 v6, s[48:51], s13 offen lds
    s_mov_b64 exec, -1
    s_lshl_b32 s5, s3, 10
    s_add_u32 s5, s5, 61440
    v_lshl_add_u32 v8, v1, 4, s5
    v_lshrrev_b32 v13, 2, v3
    v_lshl_add_u32 v13, v2, 3, v13
    s_movk_i32 s5, 320
    v_mul_u32_u24 v13, s5, v13
    v_and_b32 v14, 3, v3
    v_lshl_add_u32 v13, v14, 3, v13
    s_mul_i32 s5, s89, 160
    v_add_u32 v13, s5, v13
    v_and_b32 v14, 1, v2
    v_lshlrev_b32 v14, 5, v14
    s_cmp_eq_u32 s89, 0
    s_cselect_b32 s5, 1, -1
    v_mul_lo_u32 v14, v14, s5
    v_add_u32 v9, v13, v14
    v_sub_u32 v10, v13, v14
    v_lshrrev_b32 v13, 2, v3
    v_sub_u32 v13, 0, v13
    v_xor_b32 v13, v13, v2
    v_and_b32 v13, 3, v13
    v_lshlrev_b32 v13, 4, v13
    v_lshl_add_u32 v13, v3, 6, v13
    s_lshl_b32 s5, s88, 11
    s_add_u32 s5, s5, 61440
    v_add_u32 v7, s5, v13
    s_movk_i32 s5, 2731
    s_movk_i32 s6, 3121
    s_mov_b32 s7, 40960
    v_add_u32 v13, 0, v0
    v_mul_u32_u24 v14, s5, v13
    v_lshrrev_b32 v14, 16, v14
    v_mul_u32_u24 v15, 24, v14
    v_sub_u32 v13, v13, v15
    v_mul_u32_u24 v15, s6, v14
    v_lshrrev_b32 v15, 16, v15
    v_mul_u32_u24 v16, 21, v15
    v_sub_u32 v14, v14, v16
    v_and_b32 v16, 1, v15
    v_mul_u32_u24 v16, 20, v16
    v_add_u32 v17, v16, v13
    v_add3_u32 v16, v16, v14, 8
    v_lshrrev_b32 v18, 4, v17
    v_lshrrev_b32 v19, 4, v16
    v_lshl_add_u32 v19, v18, 1, v19
    v_and_b32 v16, 15, v16
    v_cmp_eq_u32 vcc, 20, v14
    v_add_u32 v18, 7, v18
    v_and_b32 v17, 15, v17
    v_cndmask_b32 v19, v19, v18, vcc
    v_cndmask_b32 v16, v16, 0, vcc
    v_lshlrev_b32 v19, 10, v19
    v_lshl_add_u32 v19, v16, 6, v19
    v_lshl_add_u32 v19, v17, 2, v19
    v_lshrrev_b32 v15, 1, v15
    v_mad_u32_u24 v19, v15, s7, v19
    v_cmp_gt_u32 vcc, 20, v13
    v_cmp_gt_u32 s[92:93], 2, v15
    s_and_b64 vcc, vcc, s[92:93]
    v_mov_b32 v18, 0x80000000
    s_nop 0
    v_cndmask_b32 v20, v18, v19, vcc
    v_add_u32 v13, 512, v0
    v_mul_u32_u24 v14, s5, v13
    v_lshrrev_b32 v14, 16, v14
    v_mul_u32_u24 v15, 24, v14
    v_sub_u32 v13, v13, v15
    v_mul_u32_u24 v15, s6, v14
    v_lshrrev_b32 v15, 16, v15
    v_mul_u32_u24 v16, 21, v15
    v_sub_u32 v14, v14, v16
    v_and_b32 v16, 1, v15
    v_mul_u32_u24 v16, 20, v16
    v_add_u32 v17, v16, v13
    v_add3_u32 v16, v16, v14, 8
    v_lshrrev_b32 v18, 4, v17
    v_lshrrev_b32 v19, 4, v16
    v_lshl_add_u32 v19, v18, 1, v19
    v_and_b32 v16, 15, v16
    v_cmp_eq_u32 vcc, 20, v14
    v_add_u32 v18, 7, v18
    v_and_b32 v17, 15, v17
    v_cndmask_b32 v19, v19, v18, vcc
    v_cndmask_b32 v16, v16, 0, vcc
    v_lshlrev_b32 v19, 10, v19
    v_lshl_add_u32 v19, v16, 6, v19
    v_lshl_add_u32 v19, v17, 2, v19
    v_lshrrev_b32 v15, 1, v15
    v_mad_u32_u24 v19, v15, s7, v19
    v_cmp_gt_u32 vcc, 20, v13
    v_cmp_gt_u32 s[92:93], 2, v15
    s_and_b64 vcc, vcc, s[92:93]
    v_mov_b32 v18, 0x80000000
    s_nop 0
    v_cndmask_b32 v21, v18, v19, vcc
    v_add_u32 v13, 1024, v0
    v_mul_u32_u24 v14, s5, v13
    v_lshrrev_b32 v14, 16, v14
    v_mul_u32_u24 v15, 24, v14
    v_sub_u32 v13, v13, v15
    v_mul_u32_u24 v15, s6, v14
    v_lshrrev_b32 v15, 16, v15
    v_mul_u32_u24 v16, 21, v15
    v_sub_u32 v14, v14, v16
    v_and_b32 v16, 1, v15
    v_mul_u32_u24 v16, 20, v16
    v_add_u32 v17, v16, v13
    v_add3_u32 v16, v16, v14, 8
    v_lshrrev_b32 v18, 4, v17
    v_lshrrev_b32 v19, 4, v16
    v_lshl_add_u32 v19, v18, 1, v19
    v_and_b32 v16, 15, v16
    v_cmp_eq_u32 vcc, 20, v14
    v_add_u32 v18, 7, v18
    v_and_b32 v17, 15, v17
    v_cndmask_b32 v19, v19, v18, vcc
    v_cndmask_b32 v16, v16, 0, vcc
    v_lshlrev_b32 v19, 10, v19
    v_lshl_add_u32 v19, v16, 6, v19
    v_lshl_add_u32 v19, v17, 2, v19
    v_lshrrev_b32 v15, 1, v15
    v_mad_u32_u24 v19, v15, s7, v19
    v_cmp_gt_u32 vcc, 20, v13
    v_cmp_gt_u32 s[92:93], 2, v15
    s_and_b64 vcc, vcc, s[92:93]
    v_mov_b32 v18, 0x80000000
    s_nop 0
    v_cndmask_b32 v22, v18, v19, vcc
    v_add_u32 v13, 1536, v0
    v_mul_u32_u24 v14, s5, v13
    v_lshrrev_b32 v14, 16, v14
    v_mul_u32_u24 v15, 24, v14
    v_sub_u32 v13, v13, v15
    v_mul_u32_u24 v15, s6, v14
    v_lshrrev_b32 v15, 16, v15
    v_mul_u32_u24 v16, 21, v15
    v_sub_u32 v14, v14, v16
    v_and_b32 v16, 1, v15
    v_mul_u32_u24 v16, 20, v16
    v_add_u32 v17, v16, v13
    v_add3_u32 v16, v16, v14, 8
    v_lshrrev_b32 v18, 4, v17
    v_lshrrev_b32 v19, 4, v16
    v_lshl_add_u32 v19, v18, 1, v19
    v_and_b32 v16, 15, v16
    v_cmp_eq_u32 vcc, 20, v14
    v_add_u32 v18, 7, v18
    v_and_b32 v17, 15, v17
    v_cndmask_b32 v19, v19, v18, vcc
    v_cndmask_b32 v16, v16, 0, vcc
    v_lshlrev_b32 v19, 10, v19
    v_lshl_add_u32 v19, v16, 6, v19
    v_lshl_add_u32 v19, v17, 2, v19
    v_lshrrev_b32 v15, 1, v15
    v_mad_u32_u24 v19, v15, s7, v19
    v_cmp_gt_u32 vcc, 20, v13
    v_cmp_gt_u32 s[92:93], 2, v15
    s_and_b64 vcc, vcc, s[92:93]
    v_mov_b32 v18, 0x80000000
    s_nop 0
    v_cndmask_b32 v23, v18, v19, vcc
    s_waitcnt vmcnt(5)
    ds_write_b128 v8, v[60:63] offset:0
    ds_write_b128 v8, v[64:67] offset:8192
    buffer_load_dwordx4 v[72:75], v4, s[44:47], 0 offen offset:192
    s_add_u32 m0, s12, 20480
    s_mov_b32 s13, 245760
    buffer_load_dwordx4 v5, s[48:51], s13 offen lds
    s_add_u32 m0, s12, 21504
    s_mov_b64 exec, s[90:91]
    buffer_load_dwordx4 v6, s[48:51], s13 offen lds
    s_mov_b64 exec, -1
    s_waitcnt vmcnt(6) lgkmcnt(0)
    s_barrier
    ds_read_b128 v[24:27], v7 offset:0
    ds_read_b128 v[28:31], v7 offset:1024
    ds_read_b64_tr_b16 v[40:41], v9 offset:0
    ds_read_b64_tr_b16 v[42:43], v9 offset:1280
    ds_read_b64_tr_b16 v[44:45], v10 offset:32
    ds_read_b64_tr_b16 v[46:47], v10 offset:1312
    ds_read_b64_tr_b16 v[48:49], v9 offset:64
    ds_read_b64_tr_b16 v[50:51], v9 offset:1344
    ds_read_b64_tr_b16 v[52:53], v10 offset:96
    ds_read_b64_tr_b16 v[54:55], v10 offset:1376
    ds_read_b64_tr_b16 v[56:57], v9 offset:128
    ds_read_b64_tr_b16 v[58:59], v9 offset:1408
    s_waitcnt vmcnt(3) lgkmcnt(0)
    s_barrier
    s_cmp_lg_u32 s10, 0
    s_cbranch_scc1 KV_NOFLAG
    s_cmp_lg_u32 s3, 0
    s_cbranch_scc1 KV_NOFLAG
    v_mov_b32 v13, 1
    buffer_store_dword v13, v125, s[60:63], 0 offen sc1
KV_NOFLAG:
    v_mfma_f32_16x16x32_bf16 v[84:87], v[24:27], v[40:43], 0
    ds_write_b128 v8, v[68:71] offset:0
    v_mfma_f32_16x16x32_bf16 v[104:107], v[28:31], v[40:43], 0
    ds_read_b128 v[32:35], v7 offset:8192
    ds_read_b128 v[36:39], v7 offset:9216
    ds_read_b64_tr_b16 v[40:41], v9 offset:10240
    ds_read_b64_tr_b16 v[42:43], v9 offset:11520
    v_mfma_f32_16x16x32_bf16 v[88:91], v[24:27], v[44:47], 0
    buffer_load_dwordx4 v[76:79], v4, s[44:47], 0 offen offset:256
    v_mfma_f32_16x16x32_bf16 v[108:111], v[28:31], v[44:47], 0
    s_add_u32 m0, s12, 30720
    s_mov_b32 s13, 368640
    buffer_load_dwordx4 v5, s[48:51], s13 offen lds
    ds_read_b64_tr_b16 v[44:45], v10 offset:10272
    ds_read_b64_tr_b16 v[46:47], v10 offset:11552
    v_mfma_f32_16x16x32_bf16 v[92:95], v[24:27], v[48:51], 0
    s_add_u32 m0, s12, 31744
    s_mov_b64 exec, s[90:91]
    buffer_load_dwordx4 v6, s[48:51], s13 offen lds
    s_mov_b64 exec, -1
    v_mfma_f32_16x16x32_bf16 v[112:115], v[28:31], v[48:51], 0
    buffer_load_dwordx4 v[80:83], v4, s[44:47], 0 offen offset:320
    ds_read_b64_tr_b16 v[48:49], v9 offset:10304
    ds_read_b64_tr_b16 v[50:51], v9 offset:11584
    v_mfma_f32_16x16x32_bf16 v[96:99], v[24:27], v[52:55], 0
    s_add_u32 m0, s12, 40960
    s_mov_b32 s13, 491520
    buffer_load_dwordx4 v5, s[48:51], s13 offen lds
    v_mfma_f32_16x16x32_bf16 v[116:119], v[28:31], v[52:55], 0
    s_add_u32 m0, s12, 41984
    s_mov_b64 exec, s[90:91]
    buffer_load_dwordx4 v6, s[48:51], s13 offen lds
    s_mov_b64 exec, -1
    ds_read_b64_tr_b16 v[52:53], v10 offset:10336
    ds_read_b64_tr_b16 v[54:55], v10 offset:11616
    v_mfma_f32_16x16x32_bf16 v[100:103], v[24:27], v[56:59], 0
    v_mfma_f32_16x16x32_bf16 v[120:123], v[28:31], v[56:59], 0
    ds_read_b64_tr_b16 v[56:57], v9 offset:10368
    ds_read_b64_tr_b16 v[58:59], v9 offset:11648
    s_waitcnt vmcnt(6) lgkmcnt(0)
    s_barrier
    v_mfma_f32_16x16x32_bf16 v[84:87], v[32:35], v[40:43], v[84:87]
    ds_write_b128 v8, v[72:75] offset:8192
    v_mfma_f32_16x16x32_bf16 v[104:107], v[36:39], v[40:43], v[104:107]
    ds_read_b128 v[24:27], v7 offset:0
    ds_read_b128 v[28:31], v7 offset:1024
    ds_read_b64_tr_b16 v[40:41], v9 offset:20480
    ds_read_b64_tr_b16 v[42:43], v9 offset:21760
    v_mfma_f32_16x16x32_bf16 v[88:91], v[32:35], v[44:47], v[88:91]
    buffer_load_dwordx4 v[60:63], v4, s[44:47], 0 offen offset:384
    v_mfma_f32_16x16x32_bf16 v[108:111], v[36:39], v[44:47], v[108:111]
    s_add_u32 m0, s12, 51200
    s_mov_b32 s13, 614400
    buffer_load_dwordx4 v5, s[48:51], s13 offen lds
    ds_read_b64_tr_b16 v[44:45], v10 offset:20512
    ds_read_b64_tr_b16 v[46:47], v10 offset:21792
    v_mfma_f32_16x16x32_bf16 v[92:95], v[32:35], v[48:51], v[92:95]
    s_add_u32 m0, s12, 52224
    s_mov_b64 exec, s[90:91]
    buffer_load_dwordx4 v6, s[48:51], s13 offen lds
    s_mov_b64 exec, -1
    v_mfma_f32_16x16x32_bf16 v[112:115], v[36:39], v[48:51], v[112:115]
    buffer_load_dwordx4 v[64:67], v4, s[44:47], 0 offen offset:448
    ds_read_b64_tr_b16 v[48:49], v9 offset:20544
    ds_read_b64_tr_b16 v[50:51], v9 offset:21824
    v_mfma_f32_16x16x32_bf16 v[96:99], v[32:35], v[52:55], v[96:99]
    s_add_u32 m0, s12, 0
    s_mov_b32 s13, 737280
    buffer_load_dwordx4 v5, s[48:51], s13 offen lds
    v_mfma_f32_16x16x32_bf16 v[116:119], v[36:39], v[52:55], v[116:119]
    s_add_u32 m0, s12, 1024
    s_mov_b64 exec, s[90:91]
    buffer_load_dwordx4 v6, s[48:51], s13 offen lds
    s_mov_b64 exec, -1
    ds_read_b64_tr_b16 v[52:53], v10 offset:20576
    ds_read_b64_tr_b16 v[54:55], v10 offset:21856
    v_mfma_f32_16x16x32_bf16 v[100:103], v[32:35], v[56:59], v[100:103]
    v_mfma_f32_16x16x32_bf16 v[120:123], v[36:39], v[56:59], v[120:123]
    ds_read_b64_tr_b16 v[56:57], v9 offset:20608
    ds_read_b64_tr_b16 v[58:59], v9 offset:21888
    s_waitcnt vmcnt(9) lgkmcnt(0)
    s_barrier
    v_mfma_f32_16x16x32_bf16 v[84:87], v[24:27], v[40:43], v[84:87]
    ds_write_b128 v8, v[76:79] offset:0
    v_mfma_f32_16x16x32_bf16 v[104:107], v[28:31], v[40:43], v[104:107]
    ds_read_b128 v[32:35], v7 offset:8192
    ds_read_b128 v[36:39], v7 offset:9216
    ds_read_b64_tr_b16 v[40:41], v9 offset:30720
    ds_read_b64_tr_b16 v[42:43], v9 offset:32000
    v_mfma_f32_16x16x32_bf16 v[88:91], v[24:27], v[44:47], v[88:91]
    buffer_load_dwordx4 v[68:71], v4, s[44:47], 0 offen offset:512
    v_mfma_f32_16x16x32_bf16 v[108:111], v[28:31], v[44:47], v[108:111]
    s_add_u32 m0, s12, 10240
    s_mov_b32 s13, 860160
    buffer_load_dwordx4 v5, s[48:51], s13 offen lds
    ds_read_b64_tr_b16 v[44:45], v10 offset:30752
    ds_read_b64_tr_b16 v[46:47], v10 offset:32032
    v_mfma_f32_16x16x32_bf16 v[92:95], v[24:27], v[48:51], v[92:95]
    s_add_u32 m0, s12, 11264
    s_mov_b64 exec, s[90:91]
    buffer_load_dwordx4 v6, s[48:51], s13 offen lds
    s_mov_b64 exec, -1
    v_mfma_f32_16x16x32_bf16 v[112:115], v[28:31], v[48:51], v[112:115]
    buffer_load_dwordx4 v[72:75], v4, s[44:47], 0 offen offset:576
    ds_read_b64_tr_b16 v[48:49], v9 offset:30784
    ds_read_b64_tr_b16 v[50:51], v9 offset:32064
    v_mfma_f32_16x16x32_bf16 v[96:99], v[24:27], v[52:55], v[96:99]
    s_add_u32 m0, s12, 20480
    s_mov_b32 s13, 983040
    buffer_load_dwordx4 v5, s[48:51], s13 offen lds
    v_mfma_f32_16x16x32_bf16 v[116:119], v[28:31], v[52:55], v[116:119]
    s_add_u32 m0, s12, 21504
    s_mov_b64 exec, s[90:91]
    buffer_load_dwordx4 v6, s[48:51], s13 offen lds
    s_mov_b64 exec, -1
    ds_read_b64_tr_b16 v[52:53], v10 offset:30816
    ds_read_b64_tr_b16 v[54:55], v10 offset:32096
    v_mfma_f32_16x16x32_bf16 v[100:103], v[24:27], v[56:59], v[100:103]
    v_mfma_f32_16x16x32_bf16 v[120:123], v[28:31], v[56:59], v[120:123]
    ds_read_b64_tr_b16 v[56:57], v9 offset:30848
    ds_read_b64_tr_b16 v[58:59], v9 offset:32128
    s_waitcnt vmcnt(12) lgkmcnt(0)
    s_barrier
    v_mfma_f32_16x16x32_bf16 v[84:87], v[32:35], v[40:43], v[84:87]
    ds_write_b128 v8, v[80:83] offset:8192
    v_mfma_f32_16x16x32_bf16 v[104:107], v[36:39], v[40:43], v[104:107]
    ds_read_b128 v[24:27], v7 offset:0
    ds_read_b128 v[28:31], v7 offset:1024
    ds_read_b64_tr_b16 v[40:41], v9 offset:40960
    ds_read_b64_tr_b16 v[42:43], v9 offset:42240
    v_mfma_f32_16x16x32_bf16 v[88:91], v[32:35], v[44:47], v[88:91]
    buffer_load_dwordx4 v[76:79], v4, s[44:47], 0 offen offset:640
    v_mfma_f32_16x16x32_bf16 v[108:111], v[36:39], v[44:47], v[108:111]
    s_add_u32 m0, s12, 30720
    s_mov_b32 s13, 1105920
    buffer_load_dwordx4 v5, s[48:51], s13 offen lds
    ds_read_b64_tr_b16 v[44:45], v10 offset:40992
    ds_read_b64_tr_b16 v[46:47], v10 offset:42272
    v_mfma_f32_16x16x32_bf16 v[92:95], v[32:35], v[48:51], v[92:95]
    s_add_u32 m0, s12, 31744
    s_mov_b64 exec, s[90:91]
    buffer_load_dwordx4 v6, s[48:51], s13 offen lds
    s_mov_b64 exec, -1
    v_mfma_f32_16x16x32_bf16 v[112:115], v[36:39], v[48:51], v[112:115]
    ds_read_b64_tr_b16 v[48:49], v9 offset:41024
    ds_read_b64_tr_b16 v[50:51], v9 offset:42304
    v_mfma_f32_16x16x32_bf16 v[96:99], v[32:35], v[52:55], v[96:99]
    v_mfma_f32_16x16x32_bf16 v[116:119], v[36:39], v[52:55], v[116:119]
    ds_read_b64_tr_b16 v[52:53], v10 offset:41056
    ds_read_b64_tr_b16 v[54:55], v10 offset:42336
    v_mfma_f32_16x16x32_bf16 v[100:103], v[32:35], v[56:59], v[100:103]
    v_mfma_f32_16x16x32_bf16 v[120:123], v[36:39], v[56:59], v[120:123]
    ds_read_b64_tr_b16 v[56:57], v9 offset:41088
    ds_read_b64_tr_b16 v[58:59], v9 offset:42368
    s_waitcnt vmcnt(12) lgkmcnt(0)
    s_barrier
    v_mfma_f32_16x16x32_bf16 v[84:87], v[24:27], v[40:43], v[84:87]
    ds_write_b128 v8, v[60:63] offset:0
    v_mfma_f32_16x16x32_bf16 v[104:107], v[28:31], v[40:43], v[104:107]
    ds_read_b128 v[32:35], v7 offset:8192
    ds_read_b128 v[36:39], v7 offset:9216
    ds_read_b64_tr_b16 v[40:41], v9 offset:51200
    ds_read_b64_tr_b16 v[42:43], v9 offset:52480
    v_mfma_f32_16x16x32_bf16 v[88:91], v[24:27], v[44:47], v[88:91]
    buffer_load_dwordx4 v[80:83], v4, s[44:47], 0 offen offset:704
    v_mfma_f32_16x16x32_bf16 v[108:111], v[28:31], v[44:47], v[108:111]
    s_add_u32 m0, s12, 40960
    s_mov_b32 s13, 1228800
    buffer_load_dwordx4 v5, s[48:51], s13 offen lds
    ds_read_b64_tr_b16 v[44:45], v10 offset:51232
    ds_read_b64_tr_b16 v[46:47], v10 offset:52512
    v_mfma_f32_16x16x32_bf16 v[92:95], v[24:27], v[48:51], v[92:95]
    s_add_u32 m0, s12, 41984
    s_mov_b64 exec, s[90:91]
    buffer_load_dwordx4 v6, s[48:51], s13 offen lds
    s_mov_b64 exec, -1
    v_mfma_f32_16x16x32_bf16 v[112:115], v[28:31], v[48:51], v[112:115]
    ds_read_b64_tr_b16 v[48:49], v9 offset:51264
    ds_read_b64_tr_b16 v[50:51], v9 offset:52544
    v_mfma_f32_16x16x32_bf16 v[96:99], v[24:27], v[52:55], v[96:99]
    v_mfma_f32_16x16x32_bf16 v[116:119], v[28:31], v[52:55], v[116:119]
    ds_read_b64_tr_b16 v[52:53], v10 offset:51296
    ds_read_b64_tr_b16 v[54:55], v10 offset:52576
    v_mfma_f32_16x16x32_bf16 v[100:103], v[24:27], v[56:59], v[100:103]
    v_mfma_f32_16x16x32_bf16 v[120:123], v[28:31], v[56:59], v[120:123]
    ds_read_b64_tr_b16 v[56:57], v9 offset:51328
    ds_read_b64_tr_b16 v[58:59], v9 offset:52608
    s_waitcnt vmcnt(12) lgkmcnt(0)
    s_barrier
    v_mfma_f32_16x16x32_bf16 v[84:87], v[32:35], v[40:43], v[84:87]
    ds_write_b128 v8, v[64:67] offset:8192
    v_mfma_f32_16x16x32_bf16 v[104:107], v[36:39], v[40:43], v[104:107]
    ds_read_b128 v[24:27], v7 offset:0
    ds_read_b128 v[28:31], v7 offset:1024
    ds_read_b64_tr_b16 v[40:41], v9 offset:0
    ds_read_b64_tr_b16 v[42:43], v9 offset:1280
    v_mfma_f32_16x16x32_bf16 v[88:91], v[32:35], v[44:47], v[88:91]
    buffer_load_dwordx4 v[60:63], v4, s[44:47], 0 offen offset:768
    v_mfma_f32_16x16x32_bf16 v[108:111], v[36:39], v[44:47], v[108:111]
    s_add_u32 m0, s12, 51200
    s_mov_b32 s13, 1351680
    buffer_load_dwordx4 v5, s[48:51], s13 offen lds
    ds_read_b64_tr_b16 v[44:45], v10 offset:32
    ds_read_b64_tr_b16 v[46:47], v10 offset:1312
    v_mfma_f32_16x16x32_bf16 v[92:95], v[32:35], v[48:51], v[92:95]
    s_add_u32 m0, s12, 52224
    s_mov_b64 exec, s[90:91]
    buffer_load_dwordx4 v6, s[48:51], s13 offen lds
    s_mov_b64 exec, -1
    v_mfma_f32_16x16x32_bf16 v[112:115], v[36:39], v[48:51], v[112:115]
    ds_read_b64_tr_b16 v[48:49], v9 offset:64
    ds_read_b64_tr_b16 v[50:51], v9 offset:1344
    v_mfma_f32_16x16x32_bf16 v[96:99], v[32:35], v[52:55], v[96:99]
    v_mfma_f32_16x16x32_bf16 v[116:119], v[36:39], v[52:55], v[116:119]
    ds_read_b64_tr_b16 v[52:53], v10 offset:96
    ds_read_b64_tr_b16 v[54:55], v10 offset:1376
    v_mfma_f32_16x16x32_bf16 v[100:103], v[32:35], v[56:59], v[100:103]
    v_mfma_f32_16x16x32_bf16 v[120:123], v[36:39], v[56:59], v[120:123]
    ds_read_b64_tr_b16 v[56:57], v9 offset:128
    ds_read_b64_tr_b16 v[58:59], v9 offset:1408
    s_waitcnt vmcnt(12) lgkmcnt(0)
    s_barrier
    v_mfma_f32_16x16x32_bf16 v[84:87], v[24:27], v[40:43], v[84:87]
    ds_write_b128 v8, v[68:71] offset:0
    v_mfma_f32_16x16x32_bf16 v[104:107], v[28:31], v[40:43], v[104:107]
    ds_read_b128 v[32:35], v7 offset:8192
    ds_read_b128 v[36:39], v7 offset:9216
    ds_read_b64_tr_b16 v[40:41], v9 offset:10240
    ds_read_b64_tr_b16 v[42:43], v9 offset:11520
    v_mfma_f32_16x16x32_bf16 v[88:91], v[24:27], v[44:47], v[88:91]
    buffer_load_dwordx4 v[64:67], v4, s[44:47], 0 offen offset:832
    v_mfma_f32_16x16x32_bf16 v[108:111], v[28:31], v[44:47], v[108:111]
    s_add_u32 m0, s12, 0
    s_mov_b32 s13, 1474560
    buffer_load_dwordx4 v5, s[48:51], s13 offen lds
    ds_read_b64_tr_b16 v[44:45], v10 offset:10272
    ds_read_b64_tr_b16 v[46:47], v10 offset:11552
    v_mfma_f32_16x16x32_bf16 v[92:95], v[24:27], v[48:51], v[92:95]
    s_add_u32 m0, s12, 1024
    s_mov_b64 exec, s[90:91]
    buffer_load_dwordx4 v6, s[48:51], s13 offen lds
    s_mov_b64 exec, -1
    v_mfma_f32_16x16x32_bf16 v[112:115], v[28:31], v[48:51], v[112:115]
    ds_read_b64_tr_b16 v[48:49], v9 offset:10304
    ds_read_b64_tr_b16 v[50:51], v9 offset:11584
    v_mfma_f32_16x16x32_bf16 v[96:99], v[24:27], v[52:55], v[96:99]
    v_mfma_f32_16x16x32_bf16 v[116:119], v[28:31], v[52:55], v[116:119]
    ds_read_b64_tr_b16 v[52:53], v10 offset:10336
    ds_read_b64_tr_b16 v[54:55], v10 offset:11616
    v_mfma_f32_16x16x32_bf16 v[100:103], v[24:27], v[56:59], v[100:103]
    v_mfma_f32_16x16x32_bf16 v[120:123], v[28:31], v[56:59], v[120:123]
    ds_read_b64_tr_b16 v[56:57], v9 offset:10368
    ds_read_b64_tr_b16 v[58:59], v9 offset:11648
    s_waitcnt vmcnt(12) lgkmcnt(0)
    s_barrier
    v_mfma_f32_16x16x32_bf16 v[84:87], v[32:35], v[40:43], v[84:87]
    ds_write_b128 v8, v[72:75] offset:8192
    v_mfma_f32_16x16x32_bf16 v[104:107], v[36:39], v[40:43], v[104:107]
    ds_read_b128 v[24:27], v7 offset:0
    ds_read_b128 v[28:31], v7 offset:1024
    ds_read_b64_tr_b16 v[40:41], v9 offset:20480
    ds_read_b64_tr_b16 v[42:43], v9 offset:21760
    v_mfma_f32_16x16x32_bf16 v[88:91], v[32:35], v[44:47], v[88:91]
    buffer_load_dwordx4 v[68:71], v4, s[44:47], 0 offen offset:896
    v_mfma_f32_16x16x32_bf16 v[108:111], v[36:39], v[44:47], v[108:111]
    s_add_u32 m0, s12, 10240
    s_mov_b32 s13, 1597440
    buffer_load_dwordx4 v5, s[48:51], s13 offen lds
    ds_read_b64_tr_b16 v[44:45], v10 offset:20512
    ds_read_b64_tr_b16 v[46:47], v10 offset:21792
    v_mfma_f32_16x16x32_bf16 v[92:95], v[32:35], v[48:51], v[92:95]
    s_add_u32 m0, s12, 11264
    s_mov_b64 exec, s[90:91]
    buffer_load_dwordx4 v6, s[48:51], s13 offen lds
    s_mov_b64 exec, -1
    v_mfma_f32_16x16x32_bf16 v[112:115], v[36:39], v[48:51], v[112:115]
    ds_read_b64_tr_b16 v[48:49], v9 offset:20544
    ds_read_b64_tr_b16 v[50:51], v9 offset:21824
    v_mfma_f32_16x16x32_bf16 v[96:99], v[32:35], v[52:55], v[96:99]
    v_mfma_f32_16x16x32_bf16 v[116:119], v[36:39], v[52:55], v[116:119]
    ds_read_b64_tr_b16 v[52:53], v10 offset:20576
    ds_read_b64_tr_b16 v[54:55], v10 offset:21856
    v_mfma_f32_16x16x32_bf16 v[100:103], v[32:35], v[56:59], v[100:103]
    v_mfma_f32_16x16x32_bf16 v[120:123], v[36:39], v[56:59], v[120:123]
    ds_read_b64_tr_b16 v[56:57], v9 offset:20608
    ds_read_b64_tr_b16 v[58:59], v9 offset:21888
    s_waitcnt vmcnt(12) lgkmcnt(0)
    s_barrier
    v_mfma_f32_16x16x32_bf16 v[84:87], v[24:27], v[40:43], v[84:87]
    ds_write_b128 v8, v[76:79] offset:0
    v_mfma_f32_16x16x32_bf16 v[104:107], v[28:31], v[40:43], v[104:107]
    ds_read_b128 v[32:35], v7 offset:8192
    ds_read_b128 v[36:39], v7 offset:9216
    ds_read_b64_tr_b16 v[40:41], v9 offset:30720
    ds_read_b64_tr_b16 v[42:43], v9 offset:32000
    v_mfma_f32_16x16x32_bf16 v[88:91], v[24:27], v[44:47], v[88:91]
    buffer_load_dwordx4 v[72:75], v4, s[44:47], 0 offen offset:960
    v_mfma_f32_16x16x32_bf16 v[108:111], v[28:31], v[44:47], v[108:111]
    s_add_u32 m0, s12, 20480
    s_mov_b32 s13, 1720320
    buffer_load_dwordx4 v5, s[48:51], s13 offen lds
    ds_read_b64_tr_b16 v[44:45], v10 offset:30752
    ds_read_b64_tr_b16 v[46:47], v10 offset:32032
    v_mfma_f32_16x16x32_bf16 v[92:95], v[24:27], v[48:51], v[92:95]
    s_add_u32 m0, s12, 21504
    s_mov_b64 exec, s[90:91]
    buffer_load_dwordx4 v6, s[48:51], s13 offen lds
    s_mov_b64 exec, -1
    v_mfma_f32_16x16x32_bf16 v[112:115], v[28:31], v[48:51], v[112:115]
    ds_read_b64_tr_b16 v[48:49], v9 offset:30784
    ds_read_b64_tr_b16 v[50:51], v9 offset:32064
    v_mfma_f32_16x16x32_bf16 v[96:99], v[24:27], v[52:55], v[96:99]
    v_mfma_f32_16x16x32_bf16 v[116:119], v[28:31], v[52:55], v[116:119]
    ds_read_b64_tr_b16 v[52:53], v10 offset:30816
    ds_read_b64_tr_b16 v[54:55], v10 offset:32096
    v_mfma_f32_16x16x32_bf16 v[100:103], v[24:27], v[56:59], v[100:103]
    v_mfma_f32_16x16x32_bf16 v[120:123], v[28:31], v[56:59], v[120:123]
    ds_read_b64_tr_b16 v[56:57], v9 offset:30848
    ds_read_b64_tr_b16 v[58:59], v9 offset:32128
    s_waitcnt vmcnt(12) lgkmcnt(0)
    s_barrier
    v_mfma_f32_16x16x32_bf16 v[84:87], v[32:35], v[40:43], v[84:87]
    ds_write_b128 v8, v[80:83] offset:8192
    v_mfma_f32_16x16x32_bf16 v[104:107], v[36:39], v[40:43], v[104:107]
    ds_read_b128 v[24:27], v7 offset:0
    ds_read_b128 v[28:31], v7 offset:1024
    ds_read_b64_tr_b16 v[40:41], v9 offset:40960
    ds_read_b64_tr_b16 v[42:43], v9 offset:42240
    v_mfma_f32_16x16x32_bf16 v[88:91], v[32:35], v[44:47], v[88:91]
    buffer_load_dwordx4 v[76:79], v4, s[44:47], 0 offen offset:1024
    v_mfma_f32_16x16x32_bf16 v[108:111], v[36:39], v[44:47], v[108:111]
    s_add_u32 m0, s12, 30720
    s_mov_b32 s13, 1843200
    buffer_load_dwordx4 v5, s[48:51], s13 offen lds
    ds_read_b64_tr_b16 v[44:45], v10 offset:40992
    ds_read_b64_tr_b16 v[46:47], v10 offset:42272
    v_mfma_f32_16x16x32_bf16 v[92:95], v[32:35], v[48:51], v[92:95]
    s_add_u32 m0, s12, 31744
    s_mov_b64 exec, s[90:91]
    buffer_load_dwordx4 v6, s[48:51], s13 offen lds
    s_mov_b64 exec, -1
    v_mfma_f32_16x16x32_bf16 v[112:115], v[36:39], v[48:51], v[112:115]
    ds_read_b64_tr_b16 v[48:49], v9 offset:41024
    ds_read_b64_tr_b16 v[50:51], v9 offset:42304
    v_mfma_f32_16x16x32_bf16 v[96:99], v[32:35], v[52:55], v[96:99]
    v_mfma_f32_16x16x32_bf16 v[116:119], v[36:39], v[52:55], v[116:119]
    ds_read_b64_tr_b16 v[52:53], v10 offset:41056
    ds_read_b64_tr_b16 v[54:55], v10 offset:42336
    v_mfma_f32_16x16x32_bf16 v[100:103], v[32:35], v[56:59], v[100:103]
    v_mfma_f32_16x16x32_bf16 v[120:123], v[36:39], v[56:59], v[120:123]
    ds_read_b64_tr_b16 v[56:57], v9 offset:41088
    ds_read_b64_tr_b16 v[58:59], v9 offset:42368
    s_waitcnt vmcnt(12) lgkmcnt(0)
    s_barrier
    v_mfma_f32_16x16x32_bf16 v[84:87], v[24:27], v[40:43], v[84:87]
    ds_write_b128 v8, v[60:63] offset:0
    v_mfma_f32_16x16x32_bf16 v[104:107], v[28:31], v[40:43], v[104:107]
    ds_read_b128 v[32:35], v7 offset:8192
    ds_read_b128 v[36:39], v7 offset:9216
    ds_read_b64_tr_b16 v[40:41], v9 offset:51200
    ds_read_b64_tr_b16 v[42:43], v9 offset:52480
    v_mfma_f32_16x16x32_bf16 v[88:91], v[24:27], v[44:47], v[88:91]
    buffer_load_dwordx4 v[80:83], v4, s[44:47], 0 offen offset:1088
    v_mfma_f32_16x16x32_bf16 v[108:111], v[28:31], v[44:47], v[108:111]
    s_add_u32 m0, s12, 40960
    s_mov_b32 s13, 1966080
    buffer_load_dwordx4 v5, s[48:51], s13 offen lds
    ds_read_b64_tr_b16 v[44:45], v10 offset:51232
    ds_read_b64_tr_b16 v[46:47], v10 offset:52512
    v_mfma_f32_16x16x32_bf16 v[92:95], v[24:27], v[48:51], v[92:95]
    s_add_u32 m0, s12, 41984
    s_mov_b64 exec, s[90:91]
    buffer_load_dwordx4 v6, s[48:51], s13 offen lds
    s_mov_b64 exec, -1
    v_mfma_f32_16x16x32_bf16 v[112:115], v[28:31], v[48:51], v[112:115]
    ds_read_b64_tr_b16 v[48:49], v9 offset:51264
    ds_read_b64_tr_b16 v[50:51], v9 offset:52544
    v_mfma_f32_16x16x32_bf16 v[96:99], v[24:27], v[52:55], v[96:99]
    v_mfma_f32_16x16x32_bf16 v[116:119], v[28:31], v[52:55], v[116:119]
    ds_read_b64_tr_b16 v[52:53], v10 offset:51296
    ds_read_b64_tr_b16 v[54:55], v10 offset:52576
    v_mfma_f32_16x16x32_bf16 v[100:103], v[24:27], v[56:59], v[100:103]
    v_mfma_f32_16x16x32_bf16 v[120:123], v[28:31], v[56:59], v[120:123]
    ds_read_b64_tr_b16 v[56:57], v9 offset:51328
    ds_read_b64_tr_b16 v[58:59], v9 offset:52608
    s_waitcnt vmcnt(12) lgkmcnt(0)
    s_barrier
    v_mfma_f32_16x16x32_bf16 v[84:87], v[32:35], v[40:43], v[84:87]
    ds_write_b128 v8, v[64:67] offset:8192
    v_mfma_f32_16x16x32_bf16 v[104:107], v[36:39], v[40:43], v[104:107]
    ds_read_b128 v[24:27], v7 offset:0
    ds_read_b128 v[28:31], v7 offset:1024
    ds_read_b64_tr_b16 v[40:41], v9 offset:0
    ds_read_b64_tr_b16 v[42:43], v9 offset:1280
    v_mfma_f32_16x16x32_bf16 v[88:91], v[32:35], v[44:47], v[88:91]
    buffer_load_dwordx4 v[60:63], v4, s[44:47], 0 offen offset:1152
    v_mfma_f32_16x16x32_bf16 v[108:111], v[36:39], v[44:47], v[108:111]
    s_add_u32 m0, s12, 51200
    s_mov_b32 s13, 2088960
    buffer_load_dwordx4 v5, s[48:51], s13 offen lds
    ds_read_b64_tr_b16 v[44:45], v10 offset:32
    ds_read_b64_tr_b16 v[46:47], v10 offset:1312
    v_mfma_f32_16x16x32_bf16 v[92:95], v[32:35], v[48:51], v[92:95]
    s_add_u32 m0, s12, 52224
    s_mov_b64 exec, s[90:91]
    buffer_load_dwordx4 v6, s[48:51], s13 offen lds
    s_mov_b64 exec, -1
    v_mfma_f32_16x16x32_bf16 v[112:115], v[36:39], v[48:51], v[112:115]
    ds_read_b64_tr_b16 v[48:49], v9 offset:64
    ds_read_b64_tr_b16 v[50:51], v9 offset:1344
    v_mfma_f32_16x16x32_bf16 v[96:99], v[32:35], v[52:55], v[96:99]
    v_mfma_f32_16x16x32_bf16 v[116:119], v[36:39], v[52:55], v[116:119]
    ds_read_b64_tr_b16 v[52:53], v10 offset:96
    ds_read_b64_tr_b16 v[54:55], v10 offset:1376
    v_mfma_f32_16x16x32_bf16 v[100:103], v[32:35], v[56:59], v[100:103]
    v_mfma_f32_16x16x32_bf16 v[120:123], v[36:39], v[56:59], v[120:123]
    ds_read_b64_tr_b16 v[56:57], v9 offset:128
    ds_read_b64_tr_b16 v[58:59], v9 offset:1408
    s_waitcnt vmcnt(12) lgkmcnt(0)
    s_barrier
    v_mfma_f32_16x16x32_bf16 v[84:87], v[24:27], v[40:43], v[84:87]
    ds_write_b128 v8, v[68:71] offset:0
    v_mfma_f32_16x16x32_bf16 v[104:107], v[28:31], v[40:43], v[104:107]
    ds_read_b128 v[32:35], v7 offset:8192
    ds_read_b128 v[36:39], v7 offset:9216
    ds_read_b64_tr_b16 v[40:41], v9 offset:10240
    ds_read_b64_tr_b16 v[42:43], v9 offset:11520
    v_mfma_f32_16x16x32_bf16 v[88:91], v[24:27], v[44:47], v[88:91]
    buffer_load_dwordx4 v[64:67], v4, s[44:47], 0 offen offset:1216
    v_mfma_f32_16x16x32_bf16 v[108:111], v[28:31], v[44:47], v[108:111]
    s_add_u32 m0, s12, 0
    s_mov_b32 s13, 2211840
    buffer_load_dwordx4 v5, s[48:51], s13 offen lds
    ds_read_b64_tr_b16 v[44:45], v10 offset:10272
    ds_read_b64_tr_b16 v[46:47], v10 offset:11552
    v_mfma_f32_16x16x32_bf16 v[92:95], v[24:27], v[48:51], v[92:95]
    s_add_u32 m0, s12, 1024
    s_mov_b64 exec, s[90:91]
    buffer_load_dwordx4 v6, s[48:51], s13 offen lds
    s_mov_b64 exec, -1
    v_mfma_f32_16x16x32_bf16 v[112:115], v[28:31], v[48:51], v[112:115]
    ds_read_b64_tr_b16 v[48:49], v9 offset:10304
    ds_read_b64_tr_b16 v[50:51], v9 offset:11584
    v_mfma_f32_16x16x32_bf16 v[96:99], v[24:27], v[52:55], v[96:99]
    v_mfma_f32_16x16x32_bf16 v[116:119], v[28:31], v[52:55], v[116:119]
    ds_read_b64_tr_b16 v[52:53], v10 offset:10336
    ds_read_b64_tr_b16 v[54:55], v10 offset:11616
    v_mfma_f32_16x16x32_bf16 v[100:103], v[24:27], v[56:59], v[100:103]
    v_mfma_f32_16x16x32_bf16 v[120:123], v[28:31], v[56:59], v[120:123]
    ds_read_b64_tr_b16 v[56:57], v9 offset:10368
    ds_read_b64_tr_b16 v[58:59], v9 offset:11648
    s_waitcnt vmcnt(12) lgkmcnt(0)
    s_barrier
    v_mfma_f32_16x16x32_bf16 v[84:87], v[32:35], v[40:43], v[84:87]
    ds_write_b128 v8, v[72:75] offset:8192
    v_mfma_f32_16x16x32_bf16 v[104:107], v[36:39], v[40:43], v[104:107]
    ds_read_b128 v[24:27], v7 offset:0
    ds_read_b128 v[28:31], v7 offset:1024
    ds_read_b64_tr_b16 v[40:41], v9 offset:20480
    ds_read_b64_tr_b16 v[42:43], v9 offset:21760
    v_mfma_f32_16x16x32_bf16 v[88:91], v[32:35], v[44:47], v[88:91]
    s_add_u32 m0, s12, 10240
    s_mov_b32 s13, 2334720
    buffer_load_dwordx4 v5, s[48:51], s13 offen lds
    v_mfma_f32_16x16x32_bf16 v[108:111], v[36:39], v[44:47], v[108:111]
    s_add_u32 m0, s12, 11264
    s_mov_b64 exec, s[90:91]
    buffer_load_dwordx4 v6, s[48:51], s13 offen lds
    s_mov_b64 exec, -1
    ds_read_b64_tr_b16 v[44:45], v10 offset:20512
    ds_read_b64_tr_b16 v[46:47], v10 offset:21792
    v_mfma_f32_16x16x32_bf16 v[92:95], v[32:35], v[48:51], v[92:95]
    v_mfma_f32_16x16x32_bf16 v[112:115], v[36:39], v[48:51], v[112:115]
    ds_read_b64_tr_b16 v[48:49], v9 offset:20544
    ds_read_b64_tr_b16 v[50:51], v9 offset:21824
    v_mfma_f32_16x16x32_bf16 v[96:99], v[32:35], v[52:55], v[96:99]
    v_mfma_f32_16x16x32_bf16 v[116:119], v[36:39], v[52:55], v[116:119]
    ds_read_b64_tr_b16 v[52:53], v10 offset:20576
    ds_read_b64_tr_b16 v[54:55], v10 offset:21856
    v_mfma_f32_16x16x32_bf16 v[100:103], v[32:35], v[56:59], v[100:103]
    v_mfma_f32_16x16x32_bf16 v[120:123], v[36:39], v[56:59], v[120:123]
    ds_read_b64_tr_b16 v[56:57], v9 offset:20608
    ds_read_b64_tr_b16 v[58:59], v9 offset:21888
    s_waitcnt vmcnt(11) lgkmcnt(0)
    s_barrier
    v_mfma_f32_16x16x32_bf16 v[84:87], v[24:27], v[40:43], v[84:87]
    ds_write_b128 v8, v[76:79] offset:0
    v_mfma_f32_16x16x32_bf16 v[104:107], v[28:31], v[40:43], v[104:107]
    ds_read_b128 v[32:35], v7 offset:8192
    ds_read_b128 v[36:39], v7 offset:9216
    ds_read_b64_tr_b16 v[40:41], v9 offset:30720
    ds_read_b64_tr_b16 v[42:43], v9 offset:32000
    v_mfma_f32_16x16x32_bf16 v[88:91], v[24:27], v[44:47], v[88:91]
    v_mfma_f32_16x16x32_bf16 v[108:111], v[28:31], v[44:47], v[108:111]
    ds_read_b64_tr_b16 v[44:45], v10 offset:30752
    ds_read_b64_tr_b16 v[46:47], v10 offset:32032
    v_mfma_f32_16x16x32_bf16 v[92:95], v[24:27], v[48:51], v[92:95]
    v_mfma_f32_16x16x32_bf16 v[112:115], v[28:31], v[48:51], v[112:115]
    ds_read_b64_tr_b16 v[48:49], v9 offset:30784
    ds_read_b64_tr_b16 v[50:51], v9 offset:32064
    v_mfma_f32_16x16x32_bf16 v[96:99], v[24:27], v[52:55], v[96:99]
    v_mfma_f32_16x16x32_bf16 v[116:119], v[28:31], v[52:55], v[116:119]
    ds_read_b64_tr_b16 v[52:53], v10 offset:30816
    ds_read_b64_tr_b16 v[54:55], v10 offset:32096
    v_mfma_f32_16x16x32_bf16 v[100:103], v[24:27], v[56:59], v[100:103]
    v_mfma_f32_16x16x32_bf16 v[120:123], v[28:31], v[56:59], v[120:123]
    ds_read_b64_tr_b16 v[56:57], v9 offset:30848
    ds_read_b64_tr_b16 v[58:59], v9 offset:32128
    s_waitcnt vmcnt(8) lgkmcnt(0)
    s_barrier
    v_mfma_f32_16x16x32_bf16 v[84:87], v[32:35], v[40:43], v[84:87]
    ds_write_b128 v8, v[80:83] offset:8192
    v_mfma_f32_16x16x32_bf16 v[104:107], v[36:39], v[40:43], v[104:107]
    ds_read_b128 v[24:27], v7 offset:0
    ds_read_b128 v[28:31], v7 offset:1024
    ds_read_b64_tr_b16 v[40:41], v9 offset:40960
    ds_read_b64_tr_b16 v[42:43], v9 offset:42240
    v_mfma_f32_16x16x32_bf16 v[88:91], v[32:35], v[44:47], v[88:91]
    v_mfma_f32_16x16x32_bf16 v[108:111], v[36:39], v[44:47], v[108:111]
    ds_read_b64_tr_b16 v[44:45], v10 offset:40992
    ds_read_b64_tr_b16 v[46:47], v10 offset:42272
    v_mfma_f32_16x16x32_bf16 v[92:95], v[32:35], v[48:51], v[92:95]
    v_mfma_f32_16x16x32_bf16 v[112:115], v[36:39], v[48:51], v[112:115]
    ds_read_b64_tr_b16 v[48:49], v9 offset:41024
    ds_read_b64_tr_b16 v[50:51], v9 offset:42304
    v_mfma_f32_16x16x32_bf16 v[96:99], v[32:35], v[52:55], v[96:99]
    v_mfma_f32_16x16x32_bf16 v[116:119], v[36:39], v[52:55], v[116:119]
    ds_read_b64_tr_b16 v[52:53], v10 offset:41056
    ds_read_b64_tr_b16 v[54:55], v10 offset:42336
    v_mfma_f32_16x16x32_bf16 v[100:103], v[32:35], v[56:59], v[100:103]
    v_mfma_f32_16x16x32_bf16 v[120:123], v[36:39], v[56:59], v[120:123]
    ds_read_b64_tr_b16 v[56:57], v9 offset:41088
    ds_read_b64_tr_b16 v[58:59], v9 offset:42368
    s_waitcnt vmcnt(5) lgkmcnt(0)
    s_barrier
    v_mfma_f32_16x16x32_bf16 v[84:87], v[24:27], v[40:43], v[84:87]
    ds_write_b128 v8, v[60:63] offset:0
    v_mfma_f32_16x16x32_bf16 v[104:107], v[28:31], v[40:43], v[104:107]
    ds_read_b128 v[32:35], v7 offset:8192
    ds_read_b128 v[36:39], v7 offset:9216
    ds_read_b64_tr_b16 v[40:41], v9 offset:51200
    ds_read_b64_tr_b16 v[42:43], v9 offset:52480
    v_mfma_f32_16x16x32_bf16 v[88:91], v[24:27], v[44:47], v[88:91]
    v_mfma_f32_16x16x32_bf16 v[108:111], v[28:31], v[44:47], v[108:111]
    ds_read_b64_tr_b16 v[44:45], v10 offset:51232
    ds_read_b64_tr_b16 v[46:47], v10 offset:52512
    v_mfma_f32_16x16x32_bf16 v[92:95], v[24:27], v[48:51], v[92:95]
    v_mfma_f32_16x16x32_bf16 v[112:115], v[28:31], v[48:51], v[112:115]
    ds_read_b64_tr_b16 v[48:49], v9 offset:51264
    ds_read_b64_tr_b16 v[50:51], v9 offset:52544
    v_mfma_f32_16x16x32_bf16 v[96:99], v[24:27], v[52:55], v[96:99]
    v_mfma_f32_16x16x32_bf16 v[116:119], v[28:31], v[52:55], v[116:119]
    ds_read_b64_tr_b16 v[52:53], v10 offset:51296
    ds_read_b64_tr_b16 v[54:55], v10 offset:52576
    v_mfma_f32_16x16x32_bf16 v[100:103], v[24:27], v[56:59], v[100:103]
    v_mfma_f32_16x16x32_bf16 v[120:123], v[28:31], v[56:59], v[120:123]
    ds_read_b64_tr_b16 v[56:57], v9 offset:51328
    ds_read_b64_tr_b16 v[58:59], v9 offset:52608
    s_waitcnt vmcnt(2) lgkmcnt(0)
    s_barrier
    v_mfma_f32_16x16x32_bf16 v[84:87], v[32:35], v[40:43], v[84:87]
    ds_write_b128 v8, v[64:67] offset:8192
    v_mfma_f32_16x16x32_bf16 v[104:107], v[36:39], v[40:43], v[104:107]
    ds_read_b128 v[24:27], v7 offset:0
    ds_read_b128 v[28:31], v7 offset:1024
    ds_read_b64_tr_b16 v[40:41], v9 offset:0
    ds_read_b64_tr_b16 v[42:43], v9 offset:1280
    v_mfma_f32_16x16x32_bf16 v[88:91], v[32:35], v[44:47], v[88:91]
    v_mfma_f32_16x16x32_bf16 v[108:111], v[36:39], v[44:47], v[108:111]
    ds_read_b64_tr_b16 v[44:45], v10 offset:32
    ds_read_b64_tr_b16 v[46:47], v10 offset:1312
    v_mfma_f32_16x16x32_bf16 v[92:95], v[32:35], v[48:51], v[92:95]
    v_mfma_f32_16x16x32_bf16 v[112:115], v[36:39], v[48:51], v[112:115]
    ds_read_b64_tr_b16 v[48:49], v9 offset:64
    ds_read_b64_tr_b16 v[50:51], v9 offset:1344
    v_mfma_f32_16x16x32_bf16 v[96:99], v[32:35], v[52:55], v[96:99]
    v_mfma_f32_16x16x32_bf16 v[116:119], v[36:39], v[52:55], v[116:119]
    ds_read_b64_tr_b16 v[52:53], v10 offset:96
    ds_read_b64_tr_b16 v[54:55], v10 offset:1376
    v_mfma_f32_16x16x32_bf16 v[100:103], v[32:35], v[56:59], v[100:103]
    v_mfma_f32_16x16x32_bf16 v[120:123], v[36:39], v[56:59], v[120:123]
    ds_read_b64_tr_b16 v[56:57], v9 offset:128
    ds_read_b64_tr_b16 v[58:59], v9 offset:1408
    s_waitcnt vmcnt(0) lgkmcnt(0)
    s_barrier
    v_mfma_f32_16x16x32_bf16 v[84:87], v[24:27], v[40:43], v[84:87]
    ds_read_b128 v[32:35], v7 offset:8192
    ds_read_b128 v[36:39], v7 offset:9216
    v_mfma_f32_16x16x32_bf16 v[104:107], v[28:31], v[40:43], v[104:107]
    ds_read_b64_tr_b16 v[40:41], v9 offset:10240
    ds_read_b64_tr_b16 v[42:43], v9 offset:11520
    v_mfma_f32_16x16x32_bf16 v[88:91], v[24:27], v[44:47], v[88:91]
    v_mfma_f32_16x16x32_bf16 v[108:111], v[28:31], v[44:47], v[108:111]
    ds_read_b64_tr_b16 v[44:45], v10 offset:10272
    ds_read_b64_tr_b16 v[46:47], v10 offset:11552
    v_mfma_f32_16x16x32_bf16 v[92:95], v[24:27], v[48:51], v[92:95]
    v_mfma_f32_16x16x32_bf16 v[112:115], v[28:31], v[48:51], v[112:115]
    ds_read_b64_tr_b16 v[48:49], v9 offset:10304
    ds_read_b64_tr_b16 v[50:51], v9 offset:11584
    v_mfma_f32_16x16x32_bf16 v[96:99], v[24:27], v[52:55], v[96:99]
    v_mfma_f32_16x16x32_bf16 v[116:119], v[28:31], v[52:55], v[116:119]
    ds_read_b64_tr_b16 v[52:53], v10 offset:10336
    ds_read_b64_tr_b16 v[54:55], v10 offset:11616
    v_mfma_f32_16x16x32_bf16 v[100:103], v[24:27], v[56:59], v[100:103]
    v_mfma_f32_16x16x32_bf16 v[120:123], v[28:31], v[56:59], v[120:123]
    ds_read_b64_tr_b16 v[56:57], v9 offset:10368
    ds_read_b64_tr_b16 v[58:59], v9 offset:11648
    s_waitcnt lgkmcnt(0)
    buffer_load_dword v126, v125, s[60:63], 0 offen sc1
    v_mfma_f32_16x16x32_bf16 v[84:87], v[32:35], v[40:43], v[84:87]
    v_mfma_f32_16x16x32_bf16 v[104:107], v[36:39], v[40:43], v[104:107]
    v_mfma_f32_16x16x32_bf16 v[88:91], v[32:35], v[44:47], v[88:91]
    v_mfma_f32_16x16x32_bf16 v[108:111], v[36:39], v[44:47], v[108:111]
    v_mfma_f32_16x16x32_bf16 v[92:95], v[32:35], v[48:51], v[92:95]
    v_mfma_f32_16x16x32_bf16 v[112:115], v[36:39], v[48:51], v[112:115]
    v_mfma_f32_16x16x32_bf16 v[96:99], v[32:35], v[52:55], v[96:99]
    v_mfma_f32_16x16x32_bf16 v[116:119], v[36:39], v[52:55], v[116:119]
    v_mfma_f32_16x16x32_bf16 v[100:103], v[32:35], v[56:59], v[100:103]
    v_mfma_f32_16x16x32_bf16 v[120:123], v[36:39], v[56:59], v[120:123]
    s_nop 4
    v_cvt_pk_bf16_f32 v13, v84, v85
    v_cvt_pk_bf16_f32 v60, v86, v87
    v_lshlrev_b32 v14, 16, v13
    v_lshlrev_b32 v61, 16, v60
    v_and_b32 v13, s85, v13
    v_and_b32 v60, s85, v60
    v_min_f32 v15, 0, v14
    v_min_f32 v62, 0, v61
    v_min_f32 v16, 0, v13
    v_min_f32 v63, 0, v60
    v_mul_f32 v15, s84, v15
    v_mul_f32 v62, s84, v62
    v_mul_f32 v16, s84, v16
    v_mul_f32 v63, s84, v63
    v_exp_f32 v15, v15
    v_exp_f32 v62, v62
    v_exp_f32 v16, v16
    v_exp_f32 v63, v63
    v_max_f32 v14, 0, v14
    v_max_f32 v61, 0, v61
    v_max_f32 v13, 0, v13
    v_max_f32 v60, 0, v60
    v_add_f32 v14, v14, v15
    v_add_f32 v61, v61, v62
    v_add_f32 v13, v13, v16
    v_add_f32 v60, v60, v63
    v_cvt_pk_bf16_f32 v13, v14, v13
    v_cvt_pk_bf16_f32 v60, v61, v60
    v_lshlrev_b32 v14, 16, v13
    v_lshlrev_b32 v61, 16, v60
    v_and_b32 v13, s85, v13
    v_and_b32 v60, s85, v60
    v_add_f32 v14, s86, v14
    v_add_f32 v61, s86, v61
    v_add_f32 v13, s86, v13
    v_add_f32 v60, s86, v60
    v_cvt_pk_bf16_f32 v24, v14, v13
    v_cvt_pk_bf16_f32 v25, v61, v60
    v_cvt_pk_bf16_f32 v13, v104, v105
    v_cvt_pk_bf16_f32 v60, v106, v107
    v_lshlrev_b32 v14, 16, v13
    v_lshlrev_b32 v61, 16, v60
    v_and_b32 v13, s85, v13
    v_and_b32 v60, s85, v60
    v_min_f32 v15, 0, v14
    v_min_f32 v62, 0, v61
    v_min_f32 v16, 0, v13
    v_min_f32 v63, 0, v60
    v_mul_f32 v15, s84, v15
    v_mul_f32 v62, s84, v62
    v_mul_f32 v16, s84, v16
    v_mul_f32 v63, s84, v63
    v_exp_f32 v15, v15
    v_exp_f32 v62, v62
    v_exp_f32 v16, v16
    v_exp_f32 v63, v63
    v_max_f32 v14, 0, v14
    v_max_f32 v61, 0, v61
    v_max_f32 v13, 0, v13
    v_max_f32 v60, 0, v60
    v_add_f32 v14, v14, v15
    v_add_f32 v61, v61, v62
    v_add_f32 v13, v13, v16
    v_add_f32 v60, v60, v63
    v_cvt_pk_bf16_f32 v13, v14, v13
    v_cvt_pk_bf16_f32 v60, v61, v60
    v_lshlrev_b32 v14, 16, v13
    v_lshlrev_b32 v61, 16, v60
    v_and_b32 v13, s85, v13
    v_and_b32 v60, s85, v60
    v_add_f32 v14, s86, v14
    v_add_f32 v61, s86, v61
    v_add_f32 v13, s86, v13
    v_add_f32 v60, s86, v60
    v_cvt_pk_bf16_f32 v26, v14, v13
    v_cvt_pk_bf16_f32 v27, v61, v60
    v_cvt_pk_bf16_f32 v13, v88, v89
    v_cvt_pk_bf16_f32 v60, v90, v91
    v_lshlrev_b32 v14, 16, v13
    v_lshlrev_b32 v61, 16, v60
    v_and_b32 v13, s85, v13
    v_and_b32 v60, s85, v60
    v_min_f32 v15, 0, v14
    v_min_f32 v62, 0, v61
    v_min_f32 v16, 0, v13
    v_min_f32 v63, 0, v60
    v_mul_f32 v15, s84, v15
    v_mul_f32 v62, s84, v62
    v_mul_f32 v16, s84, v16
    v_mul_f32 v63, s84, v63
    v_exp_f32 v15, v15
    v_exp_f32 v62, v62
    v_exp_f32 v16, v16
    v_exp_f32 v63, v63
    v_max_f32 v14, 0, v14
    v_max_f32 v61, 0, v61
    v_max_f32 v13, 0, v13
    v_max_f32 v60, 0, v60
    v_add_f32 v14, v14, v15
    v_add_f32 v61, v61, v62
    v_add_f32 v13, v13, v16
    v_add_f32 v60, v60, v63
    v_cvt_pk_bf16_f32 v13, v14, v13
    v_cvt_pk_bf16_f32 v60, v61, v60
    v_lshlrev_b32 v14, 16, v13
    v_lshlrev_b32 v61, 16, v60
    v_and_b32 v13, s85, v13
    v_and_b32 v60, s85, v60
    v_add_f32 v14, s86, v14
    v_add_f32 v61, s86, v61
    v_add_f32 v13, s86, v13
    v_add_f32 v60, s86, v60
    v_cvt_pk_bf16_f32 v28, v14, v13
    v_cvt_pk_bf16_f32 v29, v61, v60
    v_cvt_pk_bf16_f32 v13, v108, v109
    v_cvt_pk_bf16_f32 v60, v110, v111
    v_lshlrev_b32 v14, 16, v13
    v_lshlrev_b32 v61, 16, v60
    v_and_b32 v13, s85, v13
    v_and_b32 v60, s85, v60
    v_min_f32 v15, 0, v14
    v_min_f32 v62, 0, v61
    v_min_f32 v16, 0, v13
    v_min_f32 v63, 0, v60
    v_mul_f32 v15, s84, v15
    v_mul_f32 v62, s84, v62
    v_mul_f32 v16, s84, v16
    v_mul_f32 v63, s84, v63
    v_exp_f32 v15, v15
    v_exp_f32 v62, v62
    v_exp_f32 v16, v16
    v_exp_f32 v63, v63
    v_max_f32 v14, 0, v14
    v_max_f32 v61, 0, v61
    v_max_f32 v13, 0, v13
    v_max_f32 v60, 0, v60
    v_add_f32 v14, v14, v15
    v_add_f32 v61, v61, v62
    v_add_f32 v13, v13, v16
    v_add_f32 v60, v60, v63
    v_cvt_pk_bf16_f32 v13, v14, v13
    v_cvt_pk_bf16_f32 v60, v61, v60
    v_lshlrev_b32 v14, 16, v13
    v_lshlrev_b32 v61, 16, v60
    v_and_b32 v13, s85, v13
    v_and_b32 v60, s85, v60
    v_add_f32 v14, s86, v14
    v_add_f32 v61, s86, v61
    v_add_f32 v13, s86, v13
    v_add_f32 v60, s86, v60
    v_cvt_pk_bf16_f32 v30, v14, v13
    v_cvt_pk_bf16_f32 v31, v61, v60
    v_cvt_pk_bf16_f32 v13, v92, v93
    v_cvt_pk_bf16_f32 v60, v94, v95
    v_lshlrev_b32 v14, 16, v13
    v_lshlrev_b32 v61, 16, v60
    v_and_b32 v13, s85, v13
    v_and_b32 v60, s85, v60
    v_min_f32 v15, 0, v14
    v_min_f32 v62, 0, v61
    v_min_f32 v16, 0, v13
    v_min_f32 v63, 0, v60
    v_mul_f32 v15, s84, v15
    v_mul_f32 v62, s84, v62
    v_mul_f32 v16, s84, v16
    v_mul_f32 v63, s84, v63
    v_exp_f32 v15, v15
    v_exp_f32 v62, v62
    v_exp_f32 v16, v16
    v_exp_f32 v63, v63
    v_max_f32 v14, 0, v14
    v_max_f32 v61, 0, v61
    v_max_f32 v13, 0, v13
    v_max_f32 v60, 0, v60
    v_add_f32 v14, v14, v15
    v_add_f32 v61, v61, v62
    v_add_f32 v13, v13, v16
    v_add_f32 v60, v60, v63
    v_cvt_pk_bf16_f32 v13, v14, v13
    v_cvt_pk_bf16_f32 v60, v61, v60
    v_lshlrev_b32 v14, 16, v13
    v_lshlrev_b32 v61, 16, v60
    v_and_b32 v13, s85, v13
    v_and_b32 v60, s85, v60
    v_add_f32 v14, s86, v14
    v_add_f32 v61, s86, v61
    v_add_f32 v13, s86, v13
    v_add_f32 v60, s86, v60
    v_cvt_pk_bf16_f32 v32, v14, v13
    v_cvt_pk_bf16_f32 v33, v61, v60
    v_cvt_pk_bf16_f32 v13, v112, v113
    v_cvt_pk_bf16_f32 v60, v114, v115
    v_lshlrev_b32 v14, 16, v13
    v_lshlrev_b32 v61, 16, v60
    v_and_b32 v13, s85, v13
    v_and_b32 v60, s85, v60
    v_min_f32 v15, 0, v14
    v_min_f32 v62, 0, v61
    v_min_f32 v16, 0, v13
    v_min_f32 v63, 0, v60
    v_mul_f32 v15, s84, v15
    v_mul_f32 v62, s84, v62
    v_mul_f32 v16, s84, v16
    v_mul_f32 v63, s84, v63
    v_exp_f32 v15, v15
    v_exp_f32 v62, v62
    v_exp_f32 v16, v16
    v_exp_f32 v63, v63
    v_max_f32 v14, 0, v14
    v_max_f32 v61, 0, v61
    v_max_f32 v13, 0, v13
    v_max_f32 v60, 0, v60
    v_add_f32 v14, v14, v15
    v_add_f32 v61, v61, v62
    v_add_f32 v13, v13, v16
    v_add_f32 v60, v60, v63
    v_cvt_pk_bf16_f32 v13, v14, v13
    v_cvt_pk_bf16_f32 v60, v61, v60
    v_lshlrev_b32 v14, 16, v13
    v_lshlrev_b32 v61, 16, v60
    v_and_b32 v13, s85, v13
    v_and_b32 v60, s85, v60
    v_add_f32 v14, s86, v14
    v_add_f32 v61, s86, v61
    v_add_f32 v13, s86, v13
    v_add_f32 v60, s86, v60
    v_cvt_pk_bf16_f32 v34, v14, v13
    v_cvt_pk_bf16_f32 v35, v61, v60
    v_cvt_pk_bf16_f32 v36, v92, v93
    v_cvt_pk_bf16_f32 v37, v94, v95
    v_cvt_pk_bf16_f32 v38, v112, v113
    v_cvt_pk_bf16_f32 v39, v114, v115
    v_cvt_pk_bf16_f32 v40, v96, v97
    v_cvt_pk_bf16_f32 v41, v98, v99
    v_cvt_pk_bf16_f32 v42, v116, v117
    v_cvt_pk_bf16_f32 v43, v118, v119
    v_cvt_pk_bf16_f32 v44, v100, v101
    v_cvt_pk_bf16_f32 v45, v102, v103
    v_cvt_pk_bf16_f32 v46, v120, v121
    v_cvt_pk_bf16_f32 v47, v122, v123
    v_mov_b32 v4, 0x3f803f80
    v_mov_b32 v5, 0x3f803f80
    v_mov_b32 v6, 0x3f803f80
    v_mov_b32 v7, 0x3f803f80
    s_nop 1
    v_mfma_f32_16x16x32_bf16 v[48:51], v[24:27], v[36:39], 0
    v_mfma_f32_16x16x32_bf16 v[52:55], v[24:27], v[40:43], 0
    v_mfma_f32_16x16x32_bf16 v[56:59], v[28:31], v[36:39], 0
    v_mfma_f32_16x16x32_bf16 v[60:63], v[28:31], v[40:43], 0
    v_mfma_f32_16x16x32_bf16 v[64:67], v[28:31], v[44:47], 0
    v_mfma_f32_16x16x32_bf16 v[68:71], v[32:35], v[40:43], 0
    v_mfma_f32_16x16x32_bf16 v[72:75], v[32:35], v[44:47], 0
    v_mfma_f32_16x16x32_bf16 v[76:79], v[24:27], v[4:7], 0
    v_mfma_f32_16x16x32_bf16 v[80:83], v[28:31], v[4:7], 0
    v_mfma_f32_16x16x32_bf16 v[84:87], v[32:35], v[4:7], 0
    s_mul_i32 s4, s3, 10240
    v_lshlrev_b32 v13, 6, v3
    v_lshl_add_u32 v13, v2, 4, v13
    v_add_u32 v13, s4, v13
    s_barrier
    s_nop 3
    ds_write_b128 v13, v[48:51] offset:0
    ds_write_b128 v13, v[52:55] offset:1024
    ds_write_b128 v13, v[56:59] offset:2048
    ds_write_b128 v13, v[60:63] offset:3072
    ds_write_b128 v13, v[64:67] offset:4096
    ds_write_b128 v13, v[68:71] offset:5120
    ds_write_b128 v13, v[72:75] offset:6144
    ds_write_b128 v13, v[76:79] offset:7168
    ds_write_b128 v13, v[80:83] offset:8192
    ds_write_b128 v13, v[84:87] offset:9216
    s_waitcnt lgkmcnt(0)
    s_barrier
    v_and_b32 v13, 0x7fffffff, v20
    v_and_b32 v14, 0x7fffffff, v21
    v_and_b32 v15, 0x7fffffff, v22
    v_and_b32 v16, 0x7fffffff, v23
    ds_read_b32 v32, v13 offset:0
    ds_read_b32 v33, v13 offset:10240
    ds_read_b32 v34, v13 offset:20480
    ds_read_b32 v35, v13 offset:30720
    ds_read_b32 v36, v14 offset:0
    ds_read_b32 v37, v14 offset:10240
    ds_read_b32 v38, v14 offset:20480
    ds_read_b32 v39, v14 offset:30720
    ds_read_b32 v40, v15 offset:0
    ds_read_b32 v41, v15 offset:10240
    ds_read_b32 v42, v15 offset:20480
    ds_read_b32 v43, v15 offset:30720
    ds_read_b32 v44, v16 offset:0
    ds_read_b32 v45, v16 offset:10240
    ds_read_b32 v46, v16 offset:20480
    ds_read_b32 v47, v16 offset:30720
    v_lshlrev_b32 v17, 2, v0
    v_and_b32 v18, 0x80000000, v20
    v_lshrrev_b32 v18, 1, v18
    v_add3_u32 v20, v17, v18, 0
    v_and_b32 v18, 0x80000000, v21
    v_lshrrev_b32 v18, 1, v18
    v_add3_u32 v21, v17, v18, 0
    v_add_u32 v21, 2048, v21
    v_and_b32 v18, 0x80000000, v22
    v_lshrrev_b32 v18, 1, v18
    v_add3_u32 v22, v17, v18, 0
    v_add_u32 v22, 4096, v22
    v_and_b32 v18, 0x80000000, v23
    v_lshrrev_b32 v18, 1, v18
    v_add3_u32 v23, v17, v18, 0
    v_add_u32 v23, 6144, v23
    s_waitcnt vmcnt(0)
KV_SPIN:
    v_readfirstlane_b32 s5, v126
    s_cmp_lg_u32 s5, 0
    s_cbranch_scc1 KV_GO
    s_sleep 4
    buffer_load_dword v126, v125, s[60:63], 0 offen sc1
    s_waitcnt vmcnt(0)
    s_branch KV_SPIN
KV_GO:
    s_waitcnt lgkmcnt(12)
    v_add_f32 v32, v32, v33
    v_add_f32 v34, v34, v35
    v_add_f32 v32, v32, v34
    buffer_atomic_add_f32 v32, v20, s[52:55], s15 offen
    s_waitcnt lgkmcnt(8)
    v_add_f32 v36, v36, v37
    v_add_f32 v38, v38, v39
    v_add_f32 v36, v36, v38
    buffer_atomic_add_f32 v36, v21, s[52:55], s15 offen
    s_waitcnt lgkmcnt(4)
    v_add_f32 v40, v40, v41
    v_add_f32 v42, v42, v43
    v_add_f32 v40, v40, v42
    buffer_atomic_add_f32 v40, v22, s[52:55], s15 offen
    s_waitcnt lgkmcnt(0)
    v_add_f32 v44, v44, v45
    v_add_f32 v46, v46, v47
    v_add_f32 v44, v44, v46
    buffer_atomic_add_f32 v44, v23, s[52:55], s15 offen
    s_mov_b32 s60, s38
    s_and_b32 s61, s39, 0xffff
    s_mov_b32 s62, 256
    s_mov_b32 s63, 0x00020000
    s_waitcnt vmcnt(0)
    s_barrier
    s_cmp_lg_u32 s3, 0
    s_cbranch_scc1 SIG_KV
    s_mov_b64 exec, 1
    v_mov_b32 v13, 1
    v_mov_b32 v14, 32
    buffer_atomic_add v13, v14, s[60:63], 0 offen sc1
    s_mov_b64 exec, -1
SIG_KV:
    s_and_b32 s4, s2, 7
    s_lshr_b32 s5, s2, 3
    s_and_b32 s14, s4, 1
    s_lshl_b32 s14, s14, 1
    s_and_b32 s6, s5, 1
    s_add_u32 s14, s14, s6
    s_lshr_b32 s10, s4, 1
    s_lshl_b32 s10, s10, 3
    s_lshr_b32 s6, s5, 1
    s_add_u32 s10, s10, s6
    s_mul_i32 s8, s14, 320
    s_mov_b32 s44, s20
    s_and_b32 s45, s21, 0xffff
    s_mov_b32 s46, 819200
    s_mov_b32 s47, 0x00020000
    s_mov_b32 s48, s40
    s_and_b32 s49, s41, 0xffff
    s_mov_b32 s50, 4194304
    s_mov_b32 s51, 0x00020000
    s_add_u32 s52, s40, 4194304
    s_addc_u32 s53, s41, 0
    s_and_b32 s53, s53, 0xffff
    s_mov_b32 s54, 64768
    s_mov_b32 s55, 0x00020000
    s_mov_b32 s56, s36
    s_and_b32 s57, s37, 0xffff
    s_mov_b32 s58, 5242880
    s_mov_b32 s59, 0x00020000
    s_mul_i32 s4, s3, 160
    s_mov_b32 s5, 3277
    s_mov_b32 s6, 1280
    s_mov_b32 s7, 368640
    v_add_u32 v9, s4, v1
    v_mul_u32_u24 v10, s5, v9
    v_lshrrev_b32 v10, 16, v10
    v_mul_u32_u24 v11, 20, v10
    v_sub_u32 v11, v9, v11
    v_bfe_u32 v12, v10, 2, 1
    v_lshlrev_b32 v12, 1, v12
    v_xor_b32 v11, v11, v12
    v_lshrrev_b32 v12, 5, v10
    v_mul_u32_u24 v10, s6, v10
    v_mad_u32_u24 v10, v12, s7, v10
    v_lshl_add_u32 v10, v11, 4, v10
    v_add_u32 v4, s8, v10
    v_add_u32 v9, s4, v1
    v_add_u32 v9, 64, v9
    v_mul_u32_u24 v10, s5, v9
    v_lshrrev_b32 v10, 16, v10
    v_mul_u32_u24 v11, 20, v10
    v_sub_u32 v11, v9, v11
    v_bfe_u32 v12, v10, 2, 1
    v_lshlrev_b32 v12, 1, v12
    v_xor_b32 v11, v11, v12
    v_lshrrev_b32 v12, 5, v10
    v_mul_u32_u24 v10, s6, v10
    v_mad_u32_u24 v10, v12, s7, v10
    v_lshl_add_u32 v10, v11, 4, v10
    v_add_u32 v5, s8, v10
    v_add_u32 v9, s4, v1
    v_add_u32 v9, 128, v9
    v_mul_u32_u24 v10, s5, v9
    v_lshrrev_b32 v10, 16, v10
    v_mul_u32_u24 v11, 20, v10
    v_sub_u32 v11, v9, v11
    v_bfe_u32 v12, v10, 2, 1
    v_lshlrev_b32 v12, 1, v12
    v_xor_b32 v11, v11, v12
    v_lshrrev_b32 v12, 5, v10
    v_mul_u32_u24 v10, s6, v10
    v_mad_u32_u24 v10, v12, s7, v10
    v_lshl_add_u32 v10, v11, 4, v10
    v_add_u32 v6, s8, v10
    s_mul_i32 s12, s3, 2560
    s_mov_b32 s90, -1
    s_mov_b32 s91, 0
    s_barrier
    s_add_u32 m0, s12, 0
    s_mov_b32 s13, 0
    buffer_load_dwordx4 v4, s[44:47], s13 offen lds
    s_add_u32 m0, s12, 1024
    s_nop 0
    buffer_load_dwordx4 v5, s[44:47], s13 offen lds
    s_add_u32 m0, s12, 2048
    s_mov_b64 exec, s[90:91]
    buffer_load_dwordx4 v6, s[44:47], s13 offen lds
    s_mov_b64 exec, -1
    s_add_u32 m0, s12, 20480
    s_mov_b32 s13, 40960
    buffer_load_dwordx4 v4, s[44:47], s13 offen lds
    s_add_u32 m0, s12, 21504
    s_nop 0
    buffer_load_dwordx4 v5, s[44:47], s13 offen lds
    s_add_u32 m0, s12, 22528
    s_mov_b64 exec, s[90:91]
    buffer_load_dwordx4 v6, s[44:47], s13 offen lds
    s_mov_b64 exec, -1
    v_lshrrev_b32 v9, 2, v3
    v_lshl_add_u32 v9, v2, 2, v9
    s_movk_i32 s5, 320
    v_mul_u32_u24 v9, s5, v9
    v_and_b32 v10, 3, v3
    v_lshl_add_u32 v9, v10, 3, v9
    s_mul_i32 s5, s89, 10240
    v_add_u32 v9, s5, v9
    v_and_b32 v10, 1, v2
    v_lshlrev_b32 v10, 5, v10
    v_add_u32 v7, v9, v10
    v_sub_u32 v8, v9, v10
    s_mul_i32 s5, s89, 16192
    s_add_u32 s5, s5, 40960
    v_lshl_add_u32 v11, v2, 4, s5
    s_add_u32 s5, s5, 4032
    v_mov_b32 v12, s5
    v_cmp_gt_u32 s[6:7], 3, v2
    v_add_u32 v9, 0, v3
    v_cmp_gt_u32 vcc, 20, v9
    v_mul_u32_u24 v10, 48, v9
    v_add_u32 v10, v10, v11
    s_and_b64 vcc, vcc, s[6:7]
    s_nop 1
    v_cndmask_b32 v16, v12, v10, vcc
    v_add_u32 v9, 16, v3
    v_cmp_gt_u32 vcc, 20, v9
    v_mul_u32_u24 v10, 48, v9
    v_add_u32 v10, v10, v11
    s_and_b64 vcc, vcc, s[6:7]
    s_nop 1
    v_cndmask_b32 v17, v12, v10, vcc
    v_add_u32 v9, -4, v3
    v_cmp_gt_u32 vcc, 20, v9
    v_mul_u32_u24 v10, 48, v9
    v_add_u32 v10, v10, v11
    v_add_u32 v10, 1008, v10
    s_and_b64 vcc, vcc, s[6:7]
    s_nop 1
    v_cndmask_b32 v18, v12, v10, vcc
    v_add_u32 v9, 12, v3
    v_cmp_gt_u32 vcc, 20, v9
    v_mul_u32_u24 v10, 48, v9
    v_add_u32 v10, v10, v11
    v_add_u32 v10, 1008, v10
    s_and_b64 vcc, vcc, s[6:7]
    s_nop 1
    v_cndmask_b32 v19, v12, v10, vcc
    v_add_u32 v9, -8, v3
    v_cmp_gt_u32 vcc, 20, v9
    v_mul_u32_u24 v10, 48, v9
    v_add_u32 v10, v10, v11
    v_add_u32 v10, 2016, v10
    s_and_b64 vcc, vcc, s[6:7]
    s_nop 1
    v_cndmask_b32 v20, v12, v10, vcc
    v_add_u32 v9, 8, v3
    v_cmp_gt_u32 vcc, 20, v9
    v_mul_u32_u24 v10, 48, v9
    v_add_u32 v10, v10, v11
    v_add_u32 v10, 2016, v10
    s_and_b64 vcc, vcc, s[6:7]
    s_nop 1
    v_cndmask_b32 v21, v12, v10, vcc
    v_add_u32 v9, -12, v3
    v_cmp_gt_u32 vcc, 20, v9
    v_mul_u32_u24 v10, 48, v9
    v_add_u32 v10, v10, v11
    v_add_u32 v10, 3024, v10
    s_and_b64 vcc, vcc, s[6:7]
    s_nop 1
    v_cndmask_b32 v22, v12, v10, vcc
    v_add_u32 v9, 4, v3
    v_cmp_gt_u32 vcc, 20, v9
    v_mul_u32_u24 v10, 48, v9
    v_add_u32 v10, v10, v11
    v_add_u32 v10, 3024, v10
    s_and_b64 vcc, vcc, s[6:7]
    s_nop 1
    v_cndmask_b32 v23, v12, v10, vcc
    v_add_u32 v10, 960, v11
    v_cndmask_b32 v24, v12, v10, s[6:7]
    v_add_u32 v10, 1968, v11
    v_cndmask_b32 v25, v12, v10, s[6:7]
    v_add_u32 v10, 2976, v11
    v_cndmask_b32 v26, v12, v10, s[6:7]
    v_add_u32 v10, 3984, v11
    v_cndmask_b32 v27, v12, v10, s[6:7]
    s_mov_b32 s64, 0xffff0000
    s_mov_b32 s65, -1
    s_mov_b32 s66, 0
    s_mov_b32 s67, -1
    s_mov_b32 s68, 0
    s_mov_b32 s69, 0xffff0000
    s_lshl_b32 s4, s10, 2
    s_add_u32 s4, s4, s88
    s_lshl_b32 s11, s4, 15
    s_lshl_b32 s4, s89, 14
    s_add_u32 s11, s11, s4
    v_lshlrev_b32 v15, 4, v1
    v_mov_b32 v10, 32
    s_lshr_b32 s5, s10, 1
    s_lshl_b32 s5, s5, 2
    s_add_u32 s5, s5, 128
    v_mov_b32 v11, s5
    s_cmp_lg_u32 s3, 0
    s_cbranch_scc1 G2_GO
G2_SPIN:
    buffer_load_dword v9, v10, s[60:63], 0 offen sc1
    buffer_load_dword v12, v11, s[60:63], 0 offen sc1
    s_waitcnt vmcnt(0)
    v_readfirstlane_b32 s5, v9
    v_readfirstlane_b32 s6, v12
    s_lshl_b32 s6, s6, 5
    s_min_u32 s5, s5, s6
    s_cmp_ge_u32 s5, 128
    s_cbranch_scc1 G2_GO
    s_sleep 4
    s_branch G2_SPIN
G2_GO:
    s_barrier
    v_lshlrev_b32 v9, 4, v0
    s_mov_b32 s13, 0
    buffer_load_dwordx4 v[68:71], v9, s[52:55], s13 offen sc1
    s_mov_b32 s13, 8192
    buffer_load_dwordx4 v[72:75], v9, s[52:55], s13 offen sc1
    s_mov_b32 s13, 16384
    buffer_load_dwordx4 v[76:79], v9, s[52:55], s13 offen sc1
    s_mov_b32 s13, 24576
    buffer_load_dwordx4 v[80:83], v9, s[52:55], s13 offen sc1
    s_mov_b32 s13, 32768
    buffer_load_dwordx4 v[84:87], v9, s[52:55], s13 offen sc1
    s_mov_b32 s13, 40960
    buffer_load_dwordx4 v[88:91], v9, s[52:55], s13 offen sc1
    s_mov_b32 s13, 49152
    buffer_load_dwordx4 v[92:95], v9, s[52:55], s13 offen sc1
    s_mov_b32 s13, 57344
    buffer_load_dwordx4 v[96:99], v9, s[52:55], s13 offen sc1
    s_add_u32 s5, s11, 0
    buffer_load_dwordx4 v[100:103], v15, s[48:51], s5 offen offset:0 sc1
    buffer_load_dwordx4 v[104:107], v15, s[48:51], s5 offen offset:1024 sc1
    buffer_load_dwordx4 v[108:111], v15, s[48:51], s5 offen offset:2048 sc1
    buffer_load_dwordx4 v[112:115], v15, s[48:51], s5 offen offset:3072 sc1
    s_add_u32 s5, s11, 4096
    buffer_load_dwordx4 v[52:55], v15, s[48:51], s5 offen offset:0 sc1
    buffer_load_dwordx4 v[56:59], v15, s[48:51], s5 offen offset:1024 sc1
    buffer_load_dwordx4 v[60:63], v15, s[48:51], s5 offen offset:2048 sc1
    buffer_load_dwordx4 v[64:67], v15, s[48:51], s5 offen offset:3072 sc1
    v_lshlrev_b32 v9, 3, v0
    v_add_u32 v9, 40960, v9
    s_waitcnt vmcnt(15)
    v_cvt_pk_bf16_f32 v68, v68, v69
    v_cvt_pk_bf16_f32 v69, v70, v71
    ds_write_b64 v9, v[68:69] offset:0
    s_waitcnt vmcnt(14)
    v_cvt_pk_bf16_f32 v72, v72, v73
    v_cvt_pk_bf16_f32 v73, v74, v75
    ds_write_b64 v9, v[72:73] offset:4096
    s_waitcnt vmcnt(13)
    v_cvt_pk_bf16_f32 v76, v76, v77
    v_cvt_pk_bf16_f32 v77, v78, v79
    ds_write_b64 v9, v[76:77] offset:8192
    s_waitcnt vmcnt(12)
    v_cvt_pk_bf16_f32 v80, v80, v81
    v_cvt_pk_bf16_f32 v81, v82, v83
    ds_write_b64 v9, v[80:81] offset:12288
    s_waitcnt vmcnt(11)
    v_cvt_pk_bf16_f32 v84, v84, v85
    v_cvt_pk_bf16_f32 v85, v86, v87
    ds_write_b64 v9, v[84:85] offset:16384
    s_waitcnt vmcnt(10)
    v_cvt_pk_bf16_f32 v88, v88, v89
    v_cvt_pk_bf16_f32 v89, v90, v91
    ds_write_b64 v9, v[88:89] offset:20480
    s_waitcnt vmcnt(9)
    v_cvt_pk_bf16_f32 v92, v92, v93
    v_cvt_pk_bf16_f32 v93, v94, v95
    ds_write_b64 v9, v[92:93] offset:24576
    s_waitcnt vmcnt(8)
    v_cvt_pk_bf16_f32 v96, v96, v97
    v_cvt_pk_bf16_f32 v97, v98, v99
    ds_write_b64 v9, v[96:97] offset:28672
    s_waitcnt vmcnt(4) lgkmcnt(0)
    v_mov_b32 v68, v100
    v_mov_b32 v69, v101
    v_mov_b32 v70, v102
    v_mov_b32 v71, v103
    v_mov_b32 v72, v104
    v_mov_b32 v73, v105
    v_mov_b32 v74, v106
    v_mov_b32 v75, v107
    v_mov_b32 v76, v108
    v_mov_b32 v77, v109
    v_mov_b32 v78, v110
    v_mov_b32 v79, v111
    v_mov_b32 v80, v112
    v_mov_b32 v81, v113
    v_mov_b32 v82, v114
    v_mov_b32 v83, v115
    s_barrier
    ds_read_b128 v[84:87], v24 offset:0
    ds_read_b128 v[88:91], v25 offset:0
    ds_read_b128 v[92:95], v26 offset:0
    ds_read_b128 v[96:99], v27 offset:0
    s_waitcnt lgkmcnt(3)
    v_mfma_f32_16x16x32_bf16 v[100:103], v[84:87], v[68:71], 0
    s_waitcnt lgkmcnt(2)
    v_mfma_f32_16x16x32_bf16 v[104:107], v[88:91], v[72:75], 0
    s_waitcnt lgkmcnt(1)
    v_mfma_f32_16x16x32_bf16 v[108:111], v[92:95], v[76:79], 0
    s_waitcnt lgkmcnt(0)
    v_mfma_f32_16x16x32_bf16 v[112:115], v[96:99], v[80:83], 0
    ds_read_b128 v[84:87], v16 offset:0
    ds_read_b128 v[88:91], v17 offset:0
    ds_read_b128 v[92:95], v18 offset:0
    ds_read_b128 v[96:99], v19 offset:0
    s_nop 3
    v_cvt_pk_bf16_f32 v9, v100, v100
    v_cvt_pk_bf16_f32 v10, v104, v104
    v_cvt_pk_bf16_f32 v11, v108, v108
    v_cvt_pk_bf16_f32 v12, v112, v112
    v_lshlrev_b32 v9, 16, v9
    v_lshlrev_b32 v10, 16, v10
    v_lshlrev_b32 v11, 16, v11
    v_lshlrev_b32 v12, 16, v12
    v_add_f32 v9, s86, v9
    v_add_f32 v10, s86, v10
    v_add_f32 v11, s86, v11
    v_add_f32 v12, s86, v12
    v_cvt_pk_bf16_f32 v9, v9, v9
    v_cvt_pk_bf16_f32 v10, v10, v10
    v_cvt_pk_bf16_f32 v11, v11, v11
    v_cvt_pk_bf16_f32 v12, v12, v12
    v_lshlrev_b32 v9, 16, v9
    v_lshlrev_b32 v10, 16, v10
    v_lshlrev_b32 v11, 16, v11
    v_lshlrev_b32 v12, 16, v12
    v_rcp_f32 v120, v9
    v_rcp_f32 v121, v10
    v_rcp_f32 v122, v11
    v_rcp_f32 v123, v12
    s_waitcnt lgkmcnt(3)
    v_mfma_f32_16x16x32_bf16 v[100:103], v[84:87], v[68:71], 0
    s_waitcnt lgkmcnt(2)
    v_mfma_f32_16x16x32_bf16 v[104:107], v[88:91], v[68:71], 0
    s_waitcnt lgkmcnt(1)
    v_mfma_f32_16x16x32_bf16 v[104:107], v[92:95], v[72:75], v[104:107]
    s_waitcnt lgkmcnt(0)
    v_mfma_f32_16x16x32_bf16 v[108:111], v[96:99], v[72:75], 0
    ds_read_b128 v[84:87], v20 offset:0
    ds_read_b128 v[88:91], v21 offset:0
    ds_read_b128 v[92:95], v22 offset:0
    ds_read_b128 v[96:99], v23 offset:0
    s_waitcnt lgkmcnt(3)
    v_mfma_f32_16x16x32_bf16 v[108:111], v[84:87], v[76:79], v[108:111]
    s_waitcnt lgkmcnt(2)
    v_mfma_f32_16x16x32_bf16 v[112:115], v[88:91], v[76:79], 0
    s_waitcnt lgkmcnt(1)
    v_mfma_f32_16x16x32_bf16 v[112:115], v[92:95], v[80:83], v[112:115]
    s_waitcnt lgkmcnt(0)
    v_mfma_f32_16x16x32_bf16 v[116:119], v[96:99], v[80:83], 0
    s_add_u32 s5, s11, 8192
    buffer_load_dwordx4 v[68:71], v15, s[48:51], s5 offen offset:0 sc1
    buffer_load_dwordx4 v[72:75], v15, s[48:51], s5 offen offset:1024 sc1
    buffer_load_dwordx4 v[76:79], v15, s[48:51], s5 offen offset:2048 sc1
    buffer_load_dwordx4 v[80:83], v15, s[48:51], s5 offen offset:3072 sc1
    s_nop 3
    v_cvt_pk_bf16_f32 v9, v100, v101
    v_cvt_pk_bf16_f32 v10, v102, v103
    v_lshlrev_b32 v11, 16, v9
    v_and_b32 v9, s85, v9
    v_lshlrev_b32 v12, 16, v10
    v_and_b32 v10, s85, v10
    v_mul_f32 v11, v11, v120
    v_mul_f32 v9, v9, v120
    v_mul_f32 v12, v12, v120
    v_mul_f32 v10, v10, v120
    v_cvt_pk_bf16_f32 v28, v11, v9
    v_cvt_pk_bf16_f32 v29, v12, v10
    v_cndmask_b32 v124, v120, v121, s[64:65]
    v_cvt_pk_bf16_f32 v9, v104, v105
    v_cvt_pk_bf16_f32 v10, v106, v107
    v_lshlrev_b32 v11, 16, v9
    v_and_b32 v9, s85, v9
    v_lshlrev_b32 v12, 16, v10
    v_and_b32 v10, s85, v10
    v_mul_f32 v11, v11, v124
    v_mul_f32 v9, v9, v124
    v_mul_f32 v12, v12, v124
    v_mul_f32 v10, v10, v124
    v_cvt_pk_bf16_f32 v30, v11, v9
    v_cvt_pk_bf16_f32 v31, v12, v10
    v_cndmask_b32 v124, v121, v122, s[66:67]
    v_cvt_pk_bf16_f32 v9, v108, v109
    v_cvt_pk_bf16_f32 v10, v110, v111
    v_lshlrev_b32 v11, 16, v9
    v_and_b32 v9, s85, v9
    v_lshlrev_b32 v12, 16, v10
    v_and_b32 v10, s85, v10
    v_mul_f32 v11, v11, v124
    v_mul_f32 v9, v9, v124
    v_mul_f32 v12, v12, v124
    v_mul_f32 v10, v10, v124
    v_cvt_pk_bf16_f32 v32, v11, v9
    v_cvt_pk_bf16_f32 v33, v12, v10
    v_cndmask_b32 v124, v122, v123, s[68:69]
    v_cvt_pk_bf16_f32 v9, v112, v113
    v_cvt_pk_bf16_f32 v10, v114, v115
    v_lshlrev_b32 v11, 16, v9
    v_and_b32 v9, s85, v9
    v_lshlrev_b32 v12, 16, v10
    v_and_b32 v10, s85, v10
    v_mul_f32 v11, v11, v124
    v_mul_f32 v9, v9, v124
    v_mul_f32 v12, v12, v124
    v_mul_f32 v10, v10, v124
    v_cvt_pk_bf16_f32 v34, v11, v9
    v_cvt_pk_bf16_f32 v35, v12, v10
    v_cvt_pk_bf16_f32 v9, v116, v117
    v_cvt_pk_bf16_f32 v10, v118, v119
    v_lshlrev_b32 v11, 16, v9
    v_and_b32 v9, s85, v9
    v_lshlrev_b32 v12, 16, v10
    v_and_b32 v10, s85, v10
    v_mul_f32 v11, v11, v123
    v_mul_f32 v9, v9, v123
    v_mul_f32 v12, v12, v123
    v_mul_f32 v10, v10, v123
    v_cvt_pk_bf16_f32 v36, v11, v9
    v_cvt_pk_bf16_f32 v37, v12, v10
    ds_read_b128 v[84:87], v24 offset:4048
    ds_read_b128 v[88:91], v25 offset:4048
    ds_read_b128 v[92:95], v26 offset:4048
    ds_read_b128 v[96:99], v27 offset:4048
    s_waitcnt vmcnt(4)
    s_waitcnt lgkmcnt(3)
    v_mfma_f32_16x16x32_bf16 v[100:103], v[84:87], v[52:55], 0
    s_waitcnt lgkmcnt(2)
    v_mfma_f32_16x16x32_bf16 v[104:107], v[88:91], v[56:59], 0
    s_waitcnt lgkmcnt(1)
    v_mfma_f32_16x16x32_bf16 v[108:111], v[92:95], v[60:63], 0
    s_waitcnt lgkmcnt(0)
    v_mfma_f32_16x16x32_bf16 v[112:115], v[96:99], v[64:67], 0
    ds_read_b128 v[84:87], v16 offset:4048
    ds_read_b128 v[88:91], v17 offset:4048
    ds_read_b128 v[92:95], v18 offset:4048
    ds_read_b128 v[96:99], v19 offset:4048
    s_nop 3
    v_cvt_pk_bf16_f32 v9, v100, v100
    v_cvt_pk_bf16_f32 v10, v104, v104
    v_cvt_pk_bf16_f32 v11, v108, v108
    v_cvt_pk_bf16_f32 v12, v112, v112
    v_lshlrev_b32 v9, 16, v9
    v_lshlrev_b32 v10, 16, v10
    v_lshlrev_b32 v11, 16, v11
    v_lshlrev_b32 v12, 16, v12
    v_add_f32 v9, s86, v9
    v_add_f32 v10, s86, v10
    v_add_f32 v11, s86, v11
    v_add_f32 v12, s86, v12
    v_cvt_pk_bf16_f32 v9, v9, v9
    v_cvt_pk_bf16_f32 v10, v10, v10
    v_cvt_pk_bf16_f32 v11, v11, v11
    v_cvt_pk_bf16_f32 v12, v12, v12
    v_lshlrev_b32 v9, 16, v9
    v_lshlrev_b32 v10, 16, v10
    v_lshlrev_b32 v11, 16, v11
    v_lshlrev_b32 v12, 16, v12
    v_rcp_f32 v120, v9
    v_rcp_f32 v121, v10
    v_rcp_f32 v122, v11
    v_rcp_f32 v123, v12
    s_waitcnt lgkmcnt(3)
    v_mfma_f32_16x16x32_bf16 v[100:103], v[84:87], v[52:55], 0
    s_waitcnt lgkmcnt(2)
    v_mfma_f32_16x16x32_bf16 v[104:107], v[88:91], v[52:55], 0
    s_waitcnt lgkmcnt(1)
    v_mfma_f32_16x16x32_bf16 v[104:107], v[92:95], v[56:59], v[104:107]
    s_waitcnt lgkmcnt(0)
    v_mfma_f32_16x16x32_bf16 v[108:111], v[96:99], v[56:59], 0
    ds_read_b128 v[84:87], v20 offset:4048
    ds_read_b128 v[88:91], v21 offset:4048
    ds_read_b128 v[92:95], v22 offset:4048
    ds_read_b128 v[96:99], v23 offset:4048
    s_waitcnt lgkmcnt(3)
    v_mfma_f32_16x16x32_bf16 v[108:111], v[84:87], v[60:63], v[108:111]
    s_waitcnt lgkmcnt(2)
    v_mfma_f32_16x16x32_bf16 v[112:115], v[88:91], v[60:63], 0
    s_waitcnt lgkmcnt(1)
    v_mfma_f32_16x16x32_bf16 v[112:115], v[92:95], v[64:67], v[112:115]
    s_waitcnt lgkmcnt(0)
    v_mfma_f32_16x16x32_bf16 v[116:119], v[96:99], v[64:67], 0
    s_nop 4
    s_nop 3
    v_cvt_pk_bf16_f32 v9, v100, v101
    v_cvt_pk_bf16_f32 v10, v102, v103
    v_lshlrev_b32 v11, 16, v9
    v_and_b32 v9, s85, v9
    v_lshlrev_b32 v12, 16, v10
    v_and_b32 v10, s85, v10
    v_mul_f32 v11, v11, v120
    v_mul_f32 v9, v9, v120
    v_mul_f32 v12, v12, v120
    v_mul_f32 v10, v10, v120
    v_cvt_pk_bf16_f32 v38, v11, v9
    v_cvt_pk_bf16_f32 v39, v12, v10
    v_cndmask_b32 v124, v120, v121, s[64:65]
    v_cvt_pk_bf16_f32 v9, v104, v105
    v_cvt_pk_bf16_f32 v10, v106, v107
    v_lshlrev_b32 v11, 16, v9
    v_and_b32 v9, s85, v9
    v_lshlrev_b32 v12, 16, v10
    v_and_b32 v10, s85, v10
    v_mul_f32 v11, v11, v124
    v_mul_f32 v9, v9, v124
    v_mul_f32 v12, v12, v124
    v_mul_f32 v10, v10, v124
    v_cvt_pk_bf16_f32 v40, v11, v9
    v_cvt_pk_bf16_f32 v41, v12, v10
    v_cndmask_b32 v124, v121, v122, s[66:67]
    v_cvt_pk_bf16_f32 v9, v108, v109
    v_cvt_pk_bf16_f32 v10, v110, v111
    v_lshlrev_b32 v11, 16, v9
    v_and_b32 v9, s85, v9
    v_lshlrev_b32 v12, 16, v10
    v_and_b32 v10, s85, v10
    v_mul_f32 v11, v11, v124
    v_mul_f32 v9, v9, v124
    v_mul_f32 v12, v12, v124
    v_mul_f32 v10, v10, v124
    v_cvt_pk_bf16_f32 v42, v11, v9
    v_cvt_pk_bf16_f32 v43, v12, v10
    v_cndmask_b32 v124, v122, v123, s[68:69]
    v_cvt_pk_bf16_f32 v9, v112, v113
    v_cvt_pk_bf16_f32 v10, v114, v115
    v_lshlrev_b32 v11, 16, v9
    v_and_b32 v9, s85, v9
    v_lshlrev_b32 v12, 16, v10
    v_and_b32 v10, s85, v10
    v_mul_f32 v11, v11, v124
    v_mul_f32 v9, v9, v124
    v_mul_f32 v12, v12, v124
    v_mul_f32 v10, v10, v124
    v_cvt_pk_bf16_f32 v44, v11, v9
    v_cvt_pk_bf16_f32 v45, v12, v10
    v_cvt_pk_bf16_f32 v9, v116, v117
    v_cvt_pk_bf16_f32 v10, v118, v119
    v_lshlrev_b32 v11, 16, v9
    v_and_b32 v9, s85, v9
    v_lshlrev_b32 v12, 16, v10
    v_and_b32 v10, s85, v10
    v_mul_f32 v11, v11, v123
    v_mul_f32 v9, v9, v123
    v_mul_f32 v12, v12, v123
    v_mul_f32 v10, v10, v123
    v_cvt_pk_bf16_f32 v46, v11, v9
    v_cvt_pk_bf16_f32 v47, v12, v10
    ds_read_b128 v[84:87], v24 offset:8096
    ds_read_b128 v[88:91], v25 offset:8096
    ds_read_b128 v[92:95], v26 offset:8096
    ds_read_b128 v[96:99], v27 offset:8096
    s_waitcnt vmcnt(0)
    s_waitcnt lgkmcnt(3)
    v_mfma_f32_16x16x32_bf16 v[100:103], v[84:87], v[68:71], 0
    s_waitcnt lgkmcnt(2)
    v_mfma_f32_16x16x32_bf16 v[104:107], v[88:91], v[72:75], 0
    s_waitcnt lgkmcnt(1)
    v_mfma_f32_16x16x32_bf16 v[108:111], v[92:95], v[76:79], 0
    s_waitcnt lgkmcnt(0)
    v_mfma_f32_16x16x32_bf16 v[112:115], v[96:99], v[80:83], 0
    ds_read_b128 v[84:87], v16 offset:8096
    ds_read_b128 v[88:91], v17 offset:8096
    ds_read_b128 v[92:95], v18 offset:8096
    ds_read_b128 v[96:99], v19 offset:8096
    s_nop 3
    v_cvt_pk_bf16_f32 v9, v100, v100
    v_cvt_pk_bf16_f32 v10, v104, v104
    v_cvt_pk_bf16_f32 v11, v108, v108
    v_cvt_pk_bf16_f32 v12, v112, v112
    v_lshlrev_b32 v9, 16, v9
    v_lshlrev_b32 v10, 16, v10
    v_lshlrev_b32 v11, 16, v11
    v_lshlrev_b32 v12, 16, v12
    v_add_f32 v9, s86, v9
    v_add_f32 v10, s86, v10
    v_add_f32 v11, s86, v11
    v_add_f32 v12, s86, v12
    v_cvt_pk_bf16_f32 v9, v9, v9
    v_cvt_pk_bf16_f32 v10, v10, v10
    v_cvt_pk_bf16_f32 v11, v11, v11
    v_cvt_pk_bf16_f32 v12, v12, v12
    v_lshlrev_b32 v9, 16, v9
    v_lshlrev_b32 v10, 16, v10
    v_lshlrev_b32 v11, 16, v11
    v_lshlrev_b32 v12, 16, v12
    v_rcp_f32 v120, v9
    v_rcp_f32 v121, v10
    v_rcp_f32 v122, v11
    v_rcp_f32 v123, v12
    s_waitcnt lgkmcnt(3)
    v_mfma_f32_16x16x32_bf16 v[100:103], v[84:87], v[68:71], 0
    s_waitcnt lgkmcnt(2)
    v_mfma_f32_16x16x32_bf16 v[104:107], v[88:91], v[68:71], 0
    s_waitcnt lgkmcnt(1)
    v_mfma_f32_16x16x32_bf16 v[104:107], v[92:95], v[72:75], v[104:107]
    s_waitcnt lgkmcnt(0)
    v_mfma_f32_16x16x32_bf16 v[108:111], v[96:99], v[72:75], 0
    ds_read_b128 v[84:87], v20 offset:8096
    ds_read_b128 v[88:91], v21 offset:8096
    ds_read_b128 v[92:95], v22 offset:8096
    ds_read_b128 v[96:99], v23 offset:8096
    s_waitcnt lgkmcnt(3)
    v_mfma_f32_16x16x32_bf16 v[108:111], v[84:87], v[76:79], v[108:111]
    s_waitcnt lgkmcnt(2)
    v_mfma_f32_16x16x32_bf16 v[112:115], v[88:91], v[76:79], 0
    s_waitcnt lgkmcnt(1)
    v_mfma_f32_16x16x32_bf16 v[112:115], v[92:95], v[80:83], v[112:115]
    s_waitcnt lgkmcnt(0)
    v_mfma_f32_16x16x32_bf16 v[116:119], v[96:99], v[80:83], 0
    s_add_u32 s5, s11, 12288
    buffer_load_dwordx4 v[68:71], v15, s[48:51], s5 offen offset:0 sc1
    buffer_load_dwordx4 v[72:75], v15, s[48:51], s5 offen offset:1024 sc1
    buffer_load_dwordx4 v[76:79], v15, s[48:51], s5 offen offset:2048 sc1
    buffer_load_dwordx4 v[80:83], v15, s[48:51], s5 offen offset:3072 sc1
    s_nop 3
    v_cvt_pk_bf16_f32 v9, v100, v101
    v_cvt_pk_bf16_f32 v10, v102, v103
    v_lshlrev_b32 v11, 16, v9
    v_and_b32 v9, s85, v9
    v_lshlrev_b32 v12, 16, v10
    v_and_b32 v10, s85, v10
    v_mul_f32 v11, v11, v120
    v_mul_f32 v9, v9, v120
    v_mul_f32 v12, v12, v120
    v_mul_f32 v10, v10, v120
    v_cvt_pk_bf16_f32 v48, v11, v9
    v_cvt_pk_bf16_f32 v49, v12, v10
    v_cndmask_b32 v124, v120, v121, s[64:65]
    v_cvt_pk_bf16_f32 v9, v104, v105
    v_cvt_pk_bf16_f32 v10, v106, v107
    v_lshlrev_b32 v11, 16, v9
    v_and_b32 v9, s85, v9
    v_lshlrev_b32 v12, 16, v10
    v_and_b32 v10, s85, v10
    v_mul_f32 v11, v11, v124
    v_mul_f32 v9, v9, v124
    v_mul_f32 v12, v12, v124
    v_mul_f32 v10, v10, v124
    v_cvt_pk_bf16_f32 v50, v11, v9
    v_cvt_pk_bf16_f32 v51, v12, v10
    v_cndmask_b32 v124, v121, v122, s[66:67]
    v_cvt_pk_bf16_f32 v9, v108, v109
    v_cvt_pk_bf16_f32 v10, v110, v111
    v_lshlrev_b32 v11, 16, v9
    v_and_b32 v9, s85, v9
    v_lshlrev_b32 v12, 16, v10
    v_and_b32 v10, s85, v10
    v_mul_f32 v11, v11, v124
    v_mul_f32 v9, v9, v124
    v_mul_f32 v12, v12, v124
    v_mul_f32 v10, v10, v124
    v_cvt_pk_bf16_f32 v52, v11, v9
    v_cvt_pk_bf16_f32 v53, v12, v10
    v_cndmask_b32 v124, v122, v123, s[68:69]
    v_cvt_pk_bf16_f32 v9, v112, v113
    v_cvt_pk_bf16_f32 v10, v114, v115
    v_lshlrev_b32 v11, 16, v9
    v_and_b32 v9, s85, v9
    v_lshlrev_b32 v12, 16, v10
    v_and_b32 v10, s85, v10
    v_mul_f32 v11, v11, v124
    v_mul_f32 v9, v9, v124
    v_mul_f32 v12, v12, v124
    v_mul_f32 v10, v10, v124
    v_cvt_pk_bf16_f32 v54, v11, v9
    v_cvt_pk_bf16_f32 v55, v12, v10
    v_cvt_pk_bf16_f32 v9, v116, v117
    v_cvt_pk_bf16_f32 v10, v118, v119
    v_lshlrev_b32 v11, 16, v9
    v_and_b32 v9, s85, v9
    v_lshlrev_b32 v12, 16, v10
    v_and_b32 v10, s85, v10
    v_mul_f32 v11, v11, v123
    v_mul_f32 v9, v9, v123
    v_mul_f32 v12, v12, v123
    v_mul_f32 v10, v10, v123
    v_cvt_pk_bf16_f32 v56, v11, v9
    v_cvt_pk_bf16_f32 v57, v12, v10
    ds_read_b128 v[84:87], v24 offset:12144
    ds_read_b128 v[88:91], v25 offset:12144
    ds_read_b128 v[92:95], v26 offset:12144
    ds_read_b128 v[96:99], v27 offset:12144
    s_waitcnt vmcnt(0)
    s_waitcnt lgkmcnt(3)
    v_mfma_f32_16x16x32_bf16 v[100:103], v[84:87], v[68:71], 0
    s_waitcnt lgkmcnt(2)
    v_mfma_f32_16x16x32_bf16 v[104:107], v[88:91], v[72:75], 0
    s_waitcnt lgkmcnt(1)
    v_mfma_f32_16x16x32_bf16 v[108:111], v[92:95], v[76:79], 0
    s_waitcnt lgkmcnt(0)
    v_mfma_f32_16x16x32_bf16 v[112:115], v[96:99], v[80:83], 0
    ds_read_b128 v[84:87], v16 offset:12144
    ds_read_b128 v[88:91], v17 offset:12144
    ds_read_b128 v[92:95], v18 offset:12144
    ds_read_b128 v[96:99], v19 offset:12144
    s_nop 3
    v_cvt_pk_bf16_f32 v9, v100, v100
    v_cvt_pk_bf16_f32 v10, v104, v104
    v_cvt_pk_bf16_f32 v11, v108, v108
    v_cvt_pk_bf16_f32 v12, v112, v112
    v_lshlrev_b32 v9, 16, v9
    v_lshlrev_b32 v10, 16, v10
    v_lshlrev_b32 v11, 16, v11
    v_lshlrev_b32 v12, 16, v12
    v_add_f32 v9, s86, v9
    v_add_f32 v10, s86, v10
    v_add_f32 v11, s86, v11
    v_add_f32 v12, s86, v12
    v_cvt_pk_bf16_f32 v9, v9, v9
    v_cvt_pk_bf16_f32 v10, v10, v10
    v_cvt_pk_bf16_f32 v11, v11, v11
    v_cvt_pk_bf16_f32 v12, v12, v12
    v_lshlrev_b32 v9, 16, v9
    v_lshlrev_b32 v10, 16, v10
    v_lshlrev_b32 v11, 16, v11
    v_lshlrev_b32 v12, 16, v12
    v_rcp_f32 v120, v9
    v_rcp_f32 v121, v10
    v_rcp_f32 v122, v11
    v_rcp_f32 v123, v12
    s_waitcnt lgkmcnt(3)
    v_mfma_f32_16x16x32_bf16 v[100:103], v[84:87], v[68:71], 0
    s_waitcnt lgkmcnt(2)
    v_mfma_f32_16x16x32_bf16 v[104:107], v[88:91], v[68:71], 0
    s_waitcnt lgkmcnt(1)
    v_mfma_f32_16x16x32_bf16 v[104:107], v[92:95], v[72:75], v[104:107]
    s_waitcnt lgkmcnt(0)
    v_mfma_f32_16x16x32_bf16 v[108:111], v[96:99], v[72:75], 0
    ds_read_b128 v[84:87], v20 offset:12144
    ds_read_b128 v[88:91], v21 offset:12144
    ds_read_b128 v[92:95], v22 offset:12144
    ds_read_b128 v[96:99], v23 offset:12144
    s_waitcnt lgkmcnt(3)
    v_mfma_f32_16x16x32_bf16 v[108:111], v[84:87], v[76:79], v[108:111]
    s_waitcnt lgkmcnt(2)
    v_mfma_f32_16x16x32_bf16 v[112:115], v[88:91], v[76:79], 0
    s_waitcnt lgkmcnt(1)
    v_mfma_f32_16x16x32_bf16 v[112:115], v[92:95], v[80:83], v[112:115]
    s_waitcnt lgkmcnt(0)
    v_mfma_f32_16x16x32_bf16 v[116:119], v[96:99], v[80:83], 0
    s_nop 4
    s_nop 3
    v_cvt_pk_bf16_f32 v9, v100, v101
    v_cvt_pk_bf16_f32 v10, v102, v103
    v_lshlrev_b32 v11, 16, v9
    v_and_b32 v9, s85, v9
    v_lshlrev_b32 v12, 16, v10
    v_and_b32 v10, s85, v10
    v_mul_f32 v11, v11, v120
    v_mul_f32 v9, v9, v120
    v_mul_f32 v12, v12, v120
    v_mul_f32 v10, v10, v120
    v_cvt_pk_bf16_f32 v58, v11, v9
    v_cvt_pk_bf16_f32 v59, v12, v10
    v_cndmask_b32 v124, v120, v121, s[64:65]
    v_cvt_pk_bf16_f32 v9, v104, v105
    v_cvt_pk_bf16_f32 v10, v106, v107
    v_lshlrev_b32 v11, 16, v9
    v_and_b32 v9, s85, v9
    v_lshlrev_b32 v12, 16, v10
    v_and_b32 v10, s85, v10
    v_mul_f32 v11, v11, v124
    v_mul_f32 v9, v9, v124
    v_mul_f32 v12, v12, v124
    v_mul_f32 v10, v10, v124
    v_cvt_pk_bf16_f32 v60, v11, v9
    v_cvt_pk_bf16_f32 v61, v12, v10
    v_cndmask_b32 v124, v121, v122, s[66:67]
    v_cvt_pk_bf16_f32 v9, v108, v109
    v_cvt_pk_bf16_f32 v10, v110, v111
    v_lshlrev_b32 v11, 16, v9
    v_and_b32 v9, s85, v9
    v_lshlrev_b32 v12, 16, v10
    v_and_b32 v10, s85, v10
    v_mul_f32 v11, v11, v124
    v_mul_f32 v9, v9, v124
    v_mul_f32 v12, v12, v124
    v_mul_f32 v10, v10, v124
    v_cvt_pk_bf16_f32 v62, v11, v9
    v_cvt_pk_bf16_f32 v63, v12, v10
    v_cndmask_b32 v124, v122, v123, s[68:69]
    v_cvt_pk_bf16_f32 v9, v112, v113
    v_cvt_pk_bf16_f32 v10, v114, v115
    v_lshlrev_b32 v11, 16, v9
    v_and_b32 v9, s85, v9
    v_lshlrev_b32 v12, 16, v10
    v_and_b32 v10, s85, v10
    v_mul_f32 v11, v11, v124
    v_mul_f32 v9, v9, v124
    v_mul_f32 v12, v12, v124
    v_mul_f32 v10, v10, v124
    v_cvt_pk_bf16_f32 v64, v11, v9
    v_cvt_pk_bf16_f32 v65, v12, v10
    v_cvt_pk_bf16_f32 v9, v116, v117
    v_cvt_pk_bf16_f32 v10, v118, v119
    v_lshlrev_b32 v11, 16, v9
    v_and_b32 v9, s85, v9
    v_lshlrev_b32 v12, 16, v10
    v_and_b32 v10, s85, v10
    v_mul_f32 v11, v11, v123
    v_mul_f32 v9, v9, v123
    v_mul_f32 v12, v12, v123
    v_mul_f32 v10, v10, v123
    v_cvt_pk_bf16_f32 v66, v11, v9
    v_cvt_pk_bf16_f32 v67, v12, v10
    s_barrier
    s_add_u32 m0, s12, 40960
    s_mov_b32 s13, 81920
    buffer_load_dwordx4 v4, s[44:47], s13 offen lds
    s_add_u32 m0, s12, 41984
    s_nop 0
    buffer_load_dwordx4 v5, s[44:47], s13 offen lds
    s_add_u32 m0, s12, 43008
    s_mov_b64 exec, s[90:91]
    buffer_load_dwordx4 v6, s[44:47], s13 offen lds
    s_mov_b64 exec, -1
    s_waitcnt vmcnt(6)
    s_barrier
    ds_read_b64_tr_b16 v[108:109], v7 offset:0
    ds_read_b64_tr_b16 v[110:111], v7 offset:5120
    ds_read_b64_tr_b16 v[112:113], v8 offset:32
    ds_read_b64_tr_b16 v[114:115], v8 offset:5152
    ds_read_b64_tr_b16 v[116:117], v7 offset:64
    ds_read_b64_tr_b16 v[118:119], v7 offset:5184
    ds_read_b64_tr_b16 v[120:121], v8 offset:96
    ds_read_b64_tr_b16 v[122:123], v8 offset:5216
    s_waitcnt lgkmcnt(6)
    v_mfma_f32_16x16x32_bf16 v[68:71], v[108:111], v[28:31], 0
    ds_read_b64_tr_b16 v[108:109], v7 offset:128
    ds_read_b64_tr_b16 v[110:111], v7 offset:5248
    s_waitcnt lgkmcnt(6)
    v_mfma_f32_16x16x32_bf16 v[72:75], v[112:115], v[28:31], 0
    ds_read_b64_tr_b16 v[112:113], v8 offset:160
    ds_read_b64_tr_b16 v[114:115], v8 offset:5280
    s_waitcnt lgkmcnt(6)
    v_mfma_f32_16x16x32_bf16 v[76:79], v[116:119], v[28:31], 0
    ds_read_b64_tr_b16 v[116:117], v7 offset:192
    ds_read_b64_tr_b16 v[118:119], v7 offset:5312
    s_waitcnt lgkmcnt(6)
    v_mfma_f32_16x16x32_bf16 v[80:83], v[120:123], v[28:31], 0
    ds_read_b64_tr_b16 v[120:121], v8 offset:224
    ds_read_b64_tr_b16 v[122:123], v8 offset:5344
    s_waitcnt lgkmcnt(6)
    v_mfma_f32_16x16x32_bf16 v[84:87], v[108:111], v[28:31], 0
    ds_read_b64_tr_b16 v[108:109], v7 offset:256
    ds_read_b64_tr_b16 v[110:111], v7 offset:5376
    s_waitcnt lgkmcnt(6)
    v_mfma_f32_16x16x32_bf16 v[88:91], v[112:115], v[28:31], 0
    ds_read_b64_tr_b16 v[112:113], v8 offset:288
    ds_read_b64_tr_b16 v[114:115], v8 offset:5408
    s_waitcnt lgkmcnt(6)
    v_mfma_f32_16x16x32_bf16 v[92:95], v[116:119], v[28:31], 0
    s_waitcnt lgkmcnt(4)
    v_mfma_f32_16x16x32_bf16 v[96:99], v[120:123], v[28:31], 0
    s_waitcnt lgkmcnt(2)
    v_mfma_f32_16x16x32_bf16 v[100:103], v[108:111], v[28:31], 0
    s_waitcnt lgkmcnt(0)
    v_mfma_f32_16x16x32_bf16 v[104:107], v[112:115], v[28:31], 0
    s_waitcnt vmcnt(3)
    s_barrier
    ds_read_b64_tr_b16 v[108:109], v7 offset:20480
    ds_read_b64_tr_b16 v[110:111], v7 offset:25600
    ds_read_b64_tr_b16 v[112:113], v8 offset:20512
    ds_read_b64_tr_b16 v[114:115], v8 offset:25632
    ds_read_b64_tr_b16 v[116:117], v7 offset:20544
    ds_read_b64_tr_b16 v[118:119], v7 offset:25664
    ds_read_b64_tr_b16 v[120:121], v8 offset:20576
    ds_read_b64_tr_b16 v[122:123], v8 offset:25696
    s_waitcnt lgkmcnt(6)
    v_mfma_f32_16x16x32_bf16 v[68:71], v[108:111], v[32:35], v[68:71]
    ds_read_b64_tr_b16 v[108:109], v7 offset:20608
    ds_read_b64_tr_b16 v[110:111], v7 offset:25728
    s_waitcnt lgkmcnt(6)
    v_mfma_f32_16x16x32_bf16 v[72:75], v[112:115], v[32:35], v[72:75]
    ds_read_b64_tr_b16 v[112:113], v8 offset:20640
    ds_read_b64_tr_b16 v[114:115], v8 offset:25760
    s_waitcnt lgkmcnt(6)
    v_mfma_f32_16x16x32_bf16 v[76:79], v[116:119], v[32:35], v[76:79]
    s_add_u32 m0, s12, 0
    s_mov_b32 s13, 122880
    buffer_load_dwordx4 v4, s[44:47], s13 offen lds
    ds_read_b64_tr_b16 v[116:117], v7 offset:20672
    ds_read_b64_tr_b16 v[118:119], v7 offset:25792
    s_waitcnt lgkmcnt(6)
    v_mfma_f32_16x16x32_bf16 v[80:83], v[120:123], v[32:35], v[80:83]
    ds_read_b64_tr_b16 v[120:121], v8 offset:20704
    ds_read_b64_tr_b16 v[122:123], v8 offset:25824
    s_waitcnt lgkmcnt(6)
    v_mfma_f32_16x16x32_bf16 v[84:87], v[108:111], v[32:35], v[84:87]
    ds_read_b64_tr_b16 v[108:109], v7 offset:20736
    ds_read_b64_tr_b16 v[110:111], v7 offset:25856
    s_waitcnt lgkmcnt(6)
    v_mfma_f32_16x16x32_bf16 v[88:91], v[112:115], v[32:35], v[88:91]
    s_add_u32 m0, s12, 1024
    s_nop 0
    buffer_load_dwordx4 v5, s[44:47], s13 offen lds
    ds_read_b64_tr_b16 v[112:113], v8 offset:20768
    ds_read_b64_tr_b16 v[114:115], v8 offset:25888
    s_waitcnt lgkmcnt(6)
    v_mfma_f32_16x16x32_bf16 v[92:95], v[116:119], v[32:35], v[92:95]
    s_waitcnt lgkmcnt(4)
    v_mfma_f32_16x16x32_bf16 v[96:99], v[120:123], v[32:35], v[96:99]
    s_waitcnt lgkmcnt(2)
    v_mfma_f32_16x16x32_bf16 v[100:103], v[108:111], v[32:35], v[100:103]
    s_add_u32 m0, s12, 2048
    s_mov_b64 exec, s[90:91]
    buffer_load_dwordx4 v6, s[44:47], s13 offen lds
    s_mov_b64 exec, -1
    s_waitcnt lgkmcnt(0)
    v_mfma_f32_16x16x32_bf16 v[104:107], v[112:115], v[32:35], v[104:107]
    s_waitcnt vmcnt(3)
    s_barrier
    ds_read_b64_tr_b16 v[108:109], v7 offset:40960
    ds_read_b64_tr_b16 v[110:111], v7 offset:46080
    ds_read_b64_tr_b16 v[112:113], v8 offset:40992
    ds_read_b64_tr_b16 v[114:115], v8 offset:46112
    ds_read_b64_tr_b16 v[116:117], v7 offset:41024
    ds_read_b64_tr_b16 v[118:119], v7 offset:46144
    ds_read_b64_tr_b16 v[120:121], v8 offset:41056
    ds_read_b64_tr_b16 v[122:123], v8 offset:46176
    s_waitcnt lgkmcnt(6)
    v_mfma_f32_16x16x32_bf16 v[68:71], v[108:111], v[36:39], v[68:71]
    ds_read_b64_tr_b16 v[108:109], v7 offset:41088
    ds_read_b64_tr_b16 v[110:111], v7 offset:46208
    s_waitcnt lgkmcnt(6)
    v_mfma_f32_16x16x32_bf16 v[72:75], v[112:115], v[36:39], v[72:75]
    ds_read_b64_tr_b16 v[112:113], v8 offset:41120
    ds_read_b64_tr_b16 v[114:115], v8 offset:46240
    s_waitcnt lgkmcnt(6)
    v_mfma_f32_16x16x32_bf16 v[76:79], v[116:119], v[36:39], v[76:79]
    s_add_u32 m0, s12, 20480
    s_mov_b32 s13, 163840
    buffer_load_dwordx4 v4, s[44:47], s13 offen lds
    ds_read_b64_tr_b16 v[116:117], v7 offset:41152
    ds_read_b64_tr_b16 v[118:119], v7 offset:46272
    s_waitcnt lgkmcnt(6)
    v_mfma_f32_16x16x32_bf16 v[80:83], v[120:123], v[36:39], v[80:83]
    ds_read_b64_tr_b16 v[120:121], v8 offset:41184
    ds_read_b64_tr_b16 v[122:123], v8 offset:46304
    s_waitcnt lgkmcnt(6)
    v_mfma_f32_16x16x32_bf16 v[84:87], v[108:111], v[36:39], v[84:87]
    ds_read_b64_tr_b16 v[108:109], v7 offset:41216
    ds_read_b64_tr_b16 v[110:111], v7 offset:46336
    s_waitcnt lgkmcnt(6)
    v_mfma_f32_16x16x32_bf16 v[88:91], v[112:115], v[36:39], v[88:91]
    s_add_u32 m0, s12, 21504
    s_nop 0
    buffer_load_dwordx4 v5, s[44:47], s13 offen lds
    ds_read_b64_tr_b16 v[112:113], v8 offset:41248
    ds_read_b64_tr_b16 v[114:115], v8 offset:46368
    s_waitcnt lgkmcnt(6)
    v_mfma_f32_16x16x32_bf16 v[92:95], v[116:119], v[36:39], v[92:95]
    s_waitcnt lgkmcnt(4)
    v_mfma_f32_16x16x32_bf16 v[96:99], v[120:123], v[36:39], v[96:99]
    s_waitcnt lgkmcnt(2)
    v_mfma_f32_16x16x32_bf16 v[100:103], v[108:111], v[36:39], v[100:103]
    s_add_u32 m0, s12, 22528
    s_mov_b64 exec, s[90:91]
    buffer_load_dwordx4 v6, s[44:47], s13 offen lds
    s_mov_b64 exec, -1
    s_waitcnt lgkmcnt(0)
    v_mfma_f32_16x16x32_bf16 v[104:107], v[112:115], v[36:39], v[104:107]
    s_waitcnt vmcnt(3)
    s_barrier
    ds_read_b64_tr_b16 v[108:109], v7 offset:0
    ds_read_b64_tr_b16 v[110:111], v7 offset:5120
    ds_read_b64_tr_b16 v[112:113], v8 offset:32
    ds_read_b64_tr_b16 v[114:115], v8 offset:5152
    ds_read_b64_tr_b16 v[116:117], v7 offset:64
    ds_read_b64_tr_b16 v[118:119], v7 offset:5184
    ds_read_b64_tr_b16 v[120:121], v8 offset:96
    ds_read_b64_tr_b16 v[122:123], v8 offset:5216
    s_waitcnt lgkmcnt(6)
    v_mfma_f32_16x16x32_bf16 v[68:71], v[108:111], v[40:43], v[68:71]
    ds_read_b64_tr_b16 v[108:109], v7 offset:128
    ds_read_b64_tr_b16 v[110:111], v7 offset:5248
    s_waitcnt lgkmcnt(6)
    v_mfma_f32_16x16x32_bf16 v[72:75], v[112:115], v[40:43], v[72:75]
    ds_read_b64_tr_b16 v[112:113], v8 offset:160
    ds_read_b64_tr_b16 v[114:115], v8 offset:5280
    s_waitcnt lgkmcnt(6)
    v_mfma_f32_16x16x32_bf16 v[76:79], v[116:119], v[40:43], v[76:79]
    s_add_u32 m0, s12, 40960
    s_mov_b32 s13, 204800
    buffer_load_dwordx4 v4, s[44:47], s13 offen lds
    ds_read_b64_tr_b16 v[116:117], v7 offset:192
    ds_read_b64_tr_b16 v[118:119], v7 offset:5312
    s_waitcnt lgkmcnt(6)
    v_mfma_f32_16x16x32_bf16 v[80:83], v[120:123], v[40:43], v[80:83]
    ds_read_b64_tr_b16 v[120:121], v8 offset:224
    ds_read_b64_tr_b16 v[122:123], v8 offset:5344
    s_waitcnt lgkmcnt(6)
    v_mfma_f32_16x16x32_bf16 v[84:87], v[108:111], v[40:43], v[84:87]
    ds_read_b64_tr_b16 v[108:109], v7 offset:256
    ds_read_b64_tr_b16 v[110:111], v7 offset:5376
    s_waitcnt lgkmcnt(6)
    v_mfma_f32_16x16x32_bf16 v[88:91], v[112:115], v[40:43], v[88:91]
    s_add_u32 m0, s12, 41984
    s_nop 0
    buffer_load_dwordx4 v5, s[44:47], s13 offen lds
    ds_read_b64_tr_b16 v[112:113], v8 offset:288
    ds_read_b64_tr_b16 v[114:115], v8 offset:5408
    s_waitcnt lgkmcnt(6)
    v_mfma_f32_16x16x32_bf16 v[92:95], v[116:119], v[40:43], v[92:95]
    s_waitcnt lgkmcnt(4)
    v_mfma_f32_16x16x32_bf16 v[96:99], v[120:123], v[40:43], v[96:99]
    s_waitcnt lgkmcnt(2)
    v_mfma_f32_16x16x32_bf16 v[100:103], v[108:111], v[40:43], v[100:103]
    s_add_u32 m0, s12, 43008
    s_mov_b64 exec, s[90:91]
    buffer_load_dwordx4 v6, s[44:47], s13 offen lds
    s_mov_b64 exec, -1
    s_waitcnt lgkmcnt(0)
    v_mfma_f32_16x16x32_bf16 v[104:107], v[112:115], v[40:43], v[104:107]
    s_waitcnt vmcnt(3)
    s_barrier
    ds_read_b64_tr_b16 v[108:109], v7 offset:20480
    ds_read_b64_tr_b16 v[110:111], v7 offset:25600
    ds_read_b64_tr_b16 v[112:113], v8 offset:20512
    ds_read_b64_tr_b16 v[114:115], v8 offset:25632
    ds_read_b64_tr_b16 v[116:117], v7 offset:20544
    ds_read_b64_tr_b16 v[118:119], v7 offset:25664
    ds_read_b64_tr_b16 v[120:121], v8 offset:20576
    ds_read_b64_tr_b16 v[122:123], v8 offset:25696
    s_waitcnt lgkmcnt(6)
    v_mfma_f32_16x16x32_bf16 v[68:71], v[108:111], v[44:47], v[68:71]
    ds_read_b64_tr_b16 v[108:109], v7 offset:20608
    ds_read_b64_tr_b16 v[110:111], v7 offset:25728
    s_waitcnt lgkmcnt(6)
    v_mfma_f32_16x16x32_bf16 v[72:75], v[112:115], v[44:47], v[72:75]
    ds_read_b64_tr_b16 v[112:113], v8 offset:20640
    ds_read_b64_tr_b16 v[114:115], v8 offset:25760
    s_waitcnt lgkmcnt(6)
    v_mfma_f32_16x16x32_bf16 v[76:79], v[116:119], v[44:47], v[76:79]
    s_add_u32 m0, s12, 0
    s_mov_b32 s13, 245760
    buffer_load_dwordx4 v4, s[44:47], s13 offen lds
    ds_read_b64_tr_b16 v[116:117], v7 offset:20672
    ds_read_b64_tr_b16 v[118:119], v7 offset:25792
    s_waitcnt lgkmcnt(6)
    v_mfma_f32_16x16x32_bf16 v[80:83], v[120:123], v[44:47], v[80:83]
    ds_read_b64_tr_b16 v[120:121], v8 offset:20704
    ds_read_b64_tr_b16 v[122:123], v8 offset:25824
    s_waitcnt lgkmcnt(6)
    v_mfma_f32_16x16x32_bf16 v[84:87], v[108:111], v[44:47], v[84:87]
    ds_read_b64_tr_b16 v[108:109], v7 offset:20736
    ds_read_b64_tr_b16 v[110:111], v7 offset:25856
    s_waitcnt lgkmcnt(6)
    v_mfma_f32_16x16x32_bf16 v[88:91], v[112:115], v[44:47], v[88:91]
    s_add_u32 m0, s12, 1024
    s_nop 0
    buffer_load_dwordx4 v5, s[44:47], s13 offen lds
    ds_read_b64_tr_b16 v[112:113], v8 offset:20768
    ds_read_b64_tr_b16 v[114:115], v8 offset:25888
    s_waitcnt lgkmcnt(6)
    v_mfma_f32_16x16x32_bf16 v[92:95], v[116:119], v[44:47], v[92:95]
    s_waitcnt lgkmcnt(4)
    v_mfma_f32_16x16x32_bf16 v[96:99], v[120:123], v[44:47], v[96:99]
    s_waitcnt lgkmcnt(2)
    v_mfma_f32_16x16x32_bf16 v[100:103], v[108:111], v[44:47], v[100:103]
    s_add_u32 m0, s12, 2048
    s_mov_b64 exec, s[90:91]
    buffer_load_dwordx4 v6, s[44:47], s13 offen lds
    s_mov_b64 exec, -1
    s_waitcnt lgkmcnt(0)
    v_mfma_f32_16x16x32_bf16 v[104:107], v[112:115], v[44:47], v[104:107]
    s_waitcnt vmcnt(3)
    s_barrier
    ds_read_b64_tr_b16 v[108:109], v7 offset:40960
    ds_read_b64_tr_b16 v[110:111], v7 offset:46080
    ds_read_b64_tr_b16 v[112:113], v8 offset:40992
    ds_read_b64_tr_b16 v[114:115], v8 offset:46112
    ds_read_b64_tr_b16 v[116:117], v7 offset:41024
    ds_read_b64_tr_b16 v[118:119], v7 offset:46144
    ds_read_b64_tr_b16 v[120:121], v8 offset:41056
    ds_read_b64_tr_b16 v[122:123], v8 offset:46176
    s_waitcnt lgkmcnt(6)
    v_mfma_f32_16x16x32_bf16 v[68:71], v[108:111], v[48:51], v[68:71]
    ds_read_b64_tr_b16 v[108:109], v7 offset:41088
    ds_read_b64_tr_b16 v[110:111], v7 offset:46208
    s_waitcnt lgkmcnt(6)
    v_mfma_f32_16x16x32_bf16 v[72:75], v[112:115], v[48:51], v[72:75]
    ds_read_b64_tr_b16 v[112:113], v8 offset:41120
    ds_read_b64_tr_b16 v[114:115], v8 offset:46240
    s_waitcnt lgkmcnt(6)
    v_mfma_f32_16x16x32_bf16 v[76:79], v[116:119], v[48:51], v[76:79]
    s_add_u32 m0, s12, 20480
    s_mov_b32 s13, 286720
    buffer_load_dwordx4 v4, s[44:47], s13 offen lds
    ds_read_b64_tr_b16 v[116:117], v7 offset:41152
    ds_read_b64_tr_b16 v[118:119], v7 offset:46272
    s_waitcnt lgkmcnt(6)
    v_mfma_f32_16x16x32_bf16 v[80:83], v[120:123], v[48:51], v[80:83]
    ds_read_b64_tr_b16 v[120:121], v8 offset:41184
    ds_read_b64_tr_b16 v[122:123], v8 offset:46304
    s_waitcnt lgkmcnt(6)
    v_mfma_f32_16x16x32_bf16 v[84:87], v[108:111], v[48:51], v[84:87]
    ds_read_b64_tr_b16 v[108:109], v7 offset:41216
    ds_read_b64_tr_b16 v[110:111], v7 offset:46336
    s_waitcnt lgkmcnt(6)
    v_mfma_f32_16x16x32_bf16 v[88:91], v[112:115], v[48:51], v[88:91]
    s_add_u32 m0, s12, 21504
    s_nop 0
    buffer_load_dwordx4 v5, s[44:47], s13 offen lds
    ds_read_b64_tr_b16 v[112:113], v8 offset:41248
    ds_read_b64_tr_b16 v[114:115], v8 offset:46368
    s_waitcnt lgkmcnt(6)
    v_mfma_f32_16x16x32_bf16 v[92:95], v[116:119], v[48:51], v[92:95]
    s_waitcnt lgkmcnt(4)
    v_mfma_f32_16x16x32_bf16 v[96:99], v[120:123], v[48:51], v[96:99]
    s_waitcnt lgkmcnt(2)
    v_mfma_f32_16x16x32_bf16 v[100:103], v[108:111], v[48:51], v[100:103]
    s_add_u32 m0, s12, 22528
    s_mov_b64 exec, s[90:91]
    buffer_load_dwordx4 v6, s[44:47], s13 offen lds
    s_mov_b64 exec, -1
    s_waitcnt lgkmcnt(0)
    v_mfma_f32_16x16x32_bf16 v[104:107], v[112:115], v[48:51], v[104:107]
    s_waitcnt vmcnt(3)
    s_barrier
    ds_read_b64_tr_b16 v[108:109], v7 offset:0
    ds_read_b64_tr_b16 v[110:111], v7 offset:5120
    ds_read_b64_tr_b16 v[112:113], v8 offset:32
    ds_read_b64_tr_b16 v[114:115], v8 offset:5152
    ds_read_b64_tr_b16 v[116:117], v7 offset:64
    ds_read_b64_tr_b16 v[118:119], v7 offset:5184
    ds_read_b64_tr_b16 v[120:121], v8 offset:96
    ds_read_b64_tr_b16 v[122:123], v8 offset:5216
    s_waitcnt lgkmcnt(6)
    v_mfma_f32_16x16x32_bf16 v[68:71], v[108:111], v[52:55], v[68:71]
    ds_read_b64_tr_b16 v[108:109], v7 offset:128
    ds_read_b64_tr_b16 v[110:111], v7 offset:5248
    s_waitcnt lgkmcnt(6)
    v_mfma_f32_16x16x32_bf16 v[72:75], v[112:115], v[52:55], v[72:75]
    ds_read_b64_tr_b16 v[112:113], v8 offset:160
    ds_read_b64_tr_b16 v[114:115], v8 offset:5280
    s_waitcnt lgkmcnt(6)
    v_mfma_f32_16x16x32_bf16 v[76:79], v[116:119], v[52:55], v[76:79]
    s_add_u32 m0, s12, 40960
    s_mov_b32 s13, 327680
    buffer_load_dwordx4 v4, s[44:47], s13 offen lds
    ds_read_b64_tr_b16 v[116:117], v7 offset:192
    ds_read_b64_tr_b16 v[118:119], v7 offset:5312
    s_waitcnt lgkmcnt(6)
    v_mfma_f32_16x16x32_bf16 v[80:83], v[120:123], v[52:55], v[80:83]
    ds_read_b64_tr_b16 v[120:121], v8 offset:224
    ds_read_b64_tr_b16 v[122:123], v8 offset:5344
    s_waitcnt lgkmcnt(6)
    v_mfma_f32_16x16x32_bf16 v[84:87], v[108:111], v[52:55], v[84:87]
    ds_read_b64_tr_b16 v[108:109], v7 offset:256
    ds_read_b64_tr_b16 v[110:111], v7 offset:5376
    s_waitcnt lgkmcnt(6)
    v_mfma_f32_16x16x32_bf16 v[88:91], v[112:115], v[52:55], v[88:91]
    s_add_u32 m0, s12, 41984
    s_nop 0
    buffer_load_dwordx4 v5, s[44:47], s13 offen lds
    ds_read_b64_tr_b16 v[112:113], v8 offset:288
    ds_read_b64_tr_b16 v[114:115], v8 offset:5408
    s_waitcnt lgkmcnt(6)
    v_mfma_f32_16x16x32_bf16 v[92:95], v[116:119], v[52:55], v[92:95]
    s_waitcnt lgkmcnt(4)
    v_mfma_f32_16x16x32_bf16 v[96:99], v[120:123], v[52:55], v[96:99]
    s_waitcnt lgkmcnt(2)
    v_mfma_f32_16x16x32_bf16 v[100:103], v[108:111], v[52:55], v[100:103]
    s_add_u32 m0, s12, 43008
    s_mov_b64 exec, s[90:91]
    buffer_load_dwordx4 v6, s[44:47], s13 offen lds
    s_mov_b64 exec, -1
    s_waitcnt lgkmcnt(0)
    v_mfma_f32_16x16x32_bf16 v[104:107], v[112:115], v[52:55], v[104:107]
    s_waitcnt vmcnt(3)
    s_barrier
    ds_read_b64_tr_b16 v[108:109], v7 offset:20480
    ds_read_b64_tr_b16 v[110:111], v7 offset:25600
    ds_read_b64_tr_b16 v[112:113], v8 offset:20512
    ds_read_b64_tr_b16 v[114:115], v8 offset:25632
    ds_read_b64_tr_b16 v[116:117], v7 offset:20544
    ds_read_b64_tr_b16 v[118:119], v7 offset:25664
    ds_read_b64_tr_b16 v[120:121], v8 offset:20576
    ds_read_b64_tr_b16 v[122:123], v8 offset:25696
    s_waitcnt lgkmcnt(6)
    v_mfma_f32_16x16x32_bf16 v[68:71], v[108:111], v[56:59], v[68:71]
    ds_read_b64_tr_b16 v[108:109], v7 offset:20608
    ds_read_b64_tr_b16 v[110:111], v7 offset:25728
    s_waitcnt lgkmcnt(6)
    v_mfma_f32_16x16x32_bf16 v[72:75], v[112:115], v[56:59], v[72:75]
    ds_read_b64_tr_b16 v[112:113], v8 offset:20640
    ds_read_b64_tr_b16 v[114:115], v8 offset:25760
    s_waitcnt lgkmcnt(6)
    v_mfma_f32_16x16x32_bf16 v[76:79], v[116:119], v[56:59], v[76:79]
    s_add_u32 m0, s12, 0
    s_mov_b32 s13, 368640
    buffer_load_dwordx4 v4, s[44:47], s13 offen lds
    ds_read_b64_tr_b16 v[116:117], v7 offset:20672
    ds_read_b64_tr_b16 v[118:119], v7 offset:25792
    s_waitcnt lgkmcnt(6)
    v_mfma_f32_16x16x32_bf16 v[80:83], v[120:123], v[56:59], v[80:83]
    ds_read_b64_tr_b16 v[120:121], v8 offset:20704
    ds_read_b64_tr_b16 v[122:123], v8 offset:25824
    s_waitcnt lgkmcnt(6)
    v_mfma_f32_16x16x32_bf16 v[84:87], v[108:111], v[56:59], v[84:87]
    ds_read_b64_tr_b16 v[108:109], v7 offset:20736
    ds_read_b64_tr_b16 v[110:111], v7 offset:25856
    s_waitcnt lgkmcnt(6)
    v_mfma_f32_16x16x32_bf16 v[88:91], v[112:115], v[56:59], v[88:91]
    s_add_u32 m0, s12, 1024
    s_nop 0
    buffer_load_dwordx4 v5, s[44:47], s13 offen lds
    ds_read_b64_tr_b16 v[112:113], v8 offset:20768
    ds_read_b64_tr_b16 v[114:115], v8 offset:25888
    s_waitcnt lgkmcnt(6)
    v_mfma_f32_16x16x32_bf16 v[92:95], v[116:119], v[56:59], v[92:95]
    s_waitcnt lgkmcnt(4)
    v_mfma_f32_16x16x32_bf16 v[96:99], v[120:123], v[56:59], v[96:99]
    s_waitcnt lgkmcnt(2)
    v_mfma_f32_16x16x32_bf16 v[100:103], v[108:111], v[56:59], v[100:103]
    s_add_u32 m0, s12, 2048
    s_mov_b64 exec, s[90:91]
    buffer_load_dwordx4 v6, s[44:47], s13 offen lds
    s_mov_b64 exec, -1
    s_waitcnt lgkmcnt(0)
    v_mfma_f32_16x16x32_bf16 v[104:107], v[112:115], v[56:59], v[104:107]
    s_waitcnt vmcnt(3)
    s_barrier
    ds_read_b64_tr_b16 v[108:109], v7 offset:40960
    ds_read_b64_tr_b16 v[110:111], v7 offset:46080
    ds_read_b64_tr_b16 v[112:113], v8 offset:40992
    ds_read_b64_tr_b16 v[114:115], v8 offset:46112
    ds_read_b64_tr_b16 v[116:117], v7 offset:41024
    ds_read_b64_tr_b16 v[118:119], v7 offset:46144
    ds_read_b64_tr_b16 v[120:121], v8 offset:41056
    ds_read_b64_tr_b16 v[122:123], v8 offset:46176
    s_waitcnt lgkmcnt(6)
    v_mfma_f32_16x16x32_bf16 v[68:71], v[108:111], v[60:63], v[68:71]
    ds_read_b64_tr_b16 v[108:109], v7 offset:41088
    ds_read_b64_tr_b16 v[110:111], v7 offset:46208
    s_waitcnt lgkmcnt(6)
    v_mfma_f32_16x16x32_bf16 v[72:75], v[112:115], v[60:63], v[72:75]
    ds_read_b64_tr_b16 v[112:113], v8 offset:41120
    ds_read_b64_tr_b16 v[114:115], v8 offset:46240
    s_waitcnt lgkmcnt(6)
    v_mfma_f32_16x16x32_bf16 v[76:79], v[116:119], v[60:63], v[76:79]
    ds_read_b64_tr_b16 v[116:117], v7 offset:41152
    ds_read_b64_tr_b16 v[118:119], v7 offset:46272
    s_waitcnt lgkmcnt(6)
    v_mfma_f32_16x16x32_bf16 v[80:83], v[120:123], v[60:63], v[80:83]
    ds_read_b64_tr_b16 v[120:121], v8 offset:41184
    ds_read_b64_tr_b16 v[122:123], v8 offset:46304
    s_waitcnt lgkmcnt(6)
    v_mfma_f32_16x16x32_bf16 v[84:87], v[108:111], v[60:63], v[84:87]
    ds_read_b64_tr_b16 v[108:109], v7 offset:41216
    ds_read_b64_tr_b16 v[110:111], v7 offset:46336
    s_waitcnt lgkmcnt(6)
    v_mfma_f32_16x16x32_bf16 v[88:91], v[112:115], v[60:63], v[88:91]
    ds_read_b64_tr_b16 v[112:113], v8 offset:41248
    ds_read_b64_tr_b16 v[114:115], v8 offset:46368
    s_waitcnt lgkmcnt(6)
    v_mfma_f32_16x16x32_bf16 v[92:95], v[116:119], v[60:63], v[92:95]
    s_waitcnt lgkmcnt(4)
    v_mfma_f32_16x16x32_bf16 v[96:99], v[120:123], v[60:63], v[96:99]
    s_waitcnt lgkmcnt(2)
    v_mfma_f32_16x16x32_bf16 v[100:103], v[108:111], v[60:63], v[100:103]
    s_waitcnt lgkmcnt(0)
    v_mfma_f32_16x16x32_bf16 v[104:107], v[112:115], v[60:63], v[104:107]
    s_waitcnt vmcnt(0)
    s_barrier
    ds_read_b64_tr_b16 v[108:109], v7 offset:0
    ds_read_b64_tr_b16 v[110:111], v7 offset:5120
    ds_read_b64_tr_b16 v[112:113], v8 offset:32
    ds_read_b64_tr_b16 v[114:115], v8 offset:5152
    ds_read_b64_tr_b16 v[116:117], v7 offset:64
    ds_read_b64_tr_b16 v[118:119], v7 offset:5184
    ds_read_b64_tr_b16 v[120:121], v8 offset:96
    ds_read_b64_tr_b16 v[122:123], v8 offset:5216
    s_waitcnt lgkmcnt(6)
    v_mfma_f32_16x16x32_bf16 v[68:71], v[108:111], v[64:67], v[68:71]
    ds_read_b64_tr_b16 v[108:109], v7 offset:128
    ds_read_b64_tr_b16 v[110:111], v7 offset:5248
    s_waitcnt lgkmcnt(6)
    v_mfma_f32_16x16x32_bf16 v[72:75], v[112:115], v[64:67], v[72:75]
    ds_read_b64_tr_b16 v[112:113], v8 offset:160
    ds_read_b64_tr_b16 v[114:115], v8 offset:5280
    s_waitcnt lgkmcnt(6)
    v_mfma_f32_16x16x32_bf16 v[76:79], v[116:119], v[64:67], v[76:79]
    ds_read_b64_tr_b16 v[116:117], v7 offset:192
    ds_read_b64_tr_b16 v[118:119], v7 offset:5312
    s_waitcnt lgkmcnt(6)
    v_mfma_f32_16x16x32_bf16 v[80:83], v[120:123], v[64:67], v[80:83]
    ds_read_b64_tr_b16 v[120:121], v8 offset:224
    ds_read_b64_tr_b16 v[122:123], v8 offset:5344
    s_waitcnt lgkmcnt(6)
    v_mfma_f32_16x16x32_bf16 v[84:87], v[108:111], v[64:67], v[84:87]
    ds_read_b64_tr_b16 v[108:109], v7 offset:256
    ds_read_b64_tr_b16 v[110:111], v7 offset:5376
    s_waitcnt lgkmcnt(6)
    v_mfma_f32_16x16x32_bf16 v[88:91], v[112:115], v[64:67], v[88:91]
    ds_read_b64_tr_b16 v[112:113], v8 offset:288
    ds_read_b64_tr_b16 v[114:115], v8 offset:5408
    s_waitcnt lgkmcnt(6)
    v_mfma_f32_16x16x32_bf16 v[92:95], v[116:119], v[64:67], v[92:95]
    s_waitcnt lgkmcnt(4)
    v_mfma_f32_16x16x32_bf16 v[96:99], v[120:123], v[64:67], v[96:99]
    s_waitcnt lgkmcnt(2)
    v_mfma_f32_16x16x32_bf16 v[100:103], v[108:111], v[64:67], v[100:103]
    s_waitcnt lgkmcnt(0)
    v_mfma_f32_16x16x32_bf16 v[104:107], v[112:115], v[64:67], v[104:107]
    s_lshl_b32 s4, s3, 13
    s_xor_b32 s5, s3, 4
    s_lshl_b32 s5, s5, 13
    v_lshl_add_u32 v9, v1, 4, s4
    v_lshl_add_u32 v10, v1, 4, s5
    s_barrier
    s_nop 2
    s_cmp_lg_u32 s89, 0
    s_cbranch_scc1 G2_X1
    ds_write_b128 v9, v[88:91] offset:0
    ds_write_b128 v9, v[92:95] offset:1024
    ds_write_b128 v9, v[96:99] offset:2048
    ds_write_b128 v9, v[100:103] offset:3072
    ds_write_b128 v9, v[104:107] offset:4096
    s_branch G2_X2
G2_X1:
    ds_write_b128 v9, v[68:71] offset:0
    ds_write_b128 v9, v[72:75] offset:1024
    ds_write_b128 v9, v[76:79] offset:2048
    ds_write_b128 v9, v[80:83] offset:3072
    ds_write_b128 v9, v[84:87] offset:4096
    v_mov_b32 v68, v88
    v_mov_b32 v69, v89
    v_mov_b32 v70, v90
    v_mov_b32 v71, v91
    v_mov_b32 v72, v92
    v_mov_b32 v73, v93
    v_mov_b32 v74, v94
    v_mov_b32 v75, v95
    v_mov_b32 v76, v96
    v_mov_b32 v77, v97
    v_mov_b32 v78, v98
    v_mov_b32 v79, v99
    v_mov_b32 v80, v100
    v_mov_b32 v81, v101
    v_mov_b32 v82, v102
    v_mov_b32 v83, v103
    v_mov_b32 v84, v104
    v_mov_b32 v85, v105
    v_mov_b32 v86, v106
    v_mov_b32 v87, v107
G2_X2:
    s_waitcnt lgkmcnt(0)
    s_barrier
    ds_read_b128 v[88:91], v10 offset:0
    ds_read_b128 v[92:95], v10 offset:1024
    ds_read_b128 v[96:99], v10 offset:2048
    ds_read_b128 v[100:103], v10 offset:3072
    ds_read_b128 v[104:107], v10 offset:4096
    s_movk_i32 s6, 176
    v_mul_u32_u24 v11, s6, v3
    v_lshl_add_u32 v11, v2, 3, v11
    s_add_u32 s4, s4, 5120
    v_add_u32 v11, s4, v11
    s_mov_b32 s13, 6554
    s_lshl_b32 s7, s10, 6
    s_lshl_b32 s5, s88, 4
    s_add_u32 s7, s7, s5
    s_mul_i32 s7, s7, 2560
    s_add_u32 s7, s7, s8
    s_mul_i32 s5, s89, 160
    s_add_u32 s7, s7, s5
    s_movk_i32 s5, 2560
    v_add_u32 v12, 0, v1
    v_mul_u32_u24 v13, s13, v12
    v_lshrrev_b32 v13, 16, v13
    v_mul_u32_u24 v14, 10, v13
    v_sub_u32 v14, v12, v14
    v_lshlrev_b32 v14, 4, v14
    v_mad_u32_u24 v16, v13, s6, v14
    v_add_u32 v16, s4, v16
    v_mad_u32_u24 v19, v13, s5, v14
    v_add_u32 v12, 64, v1
    v_mul_u32_u24 v13, s13, v12
    v_lshrrev_b32 v13, 16, v13
    v_mul_u32_u24 v14, 10, v13
    v_sub_u32 v14, v12, v14
    v_lshlrev_b32 v14, 4, v14
    v_mad_u32_u24 v17, v13, s6, v14
    v_add_u32 v17, s4, v17
    v_mad_u32_u24 v20, v13, s5, v14
    v_add_u32 v12, 128, v1
    v_mul_u32_u24 v13, s13, v12
    v_lshrrev_b32 v13, 16, v13
    v_mul_u32_u24 v14, 10, v13
    v_sub_u32 v14, v12, v14
    v_lshlrev_b32 v14, 4, v14
    v_mad_u32_u24 v18, v13, s6, v14
    v_add_u32 v18, s4, v18
    v_mad_u32_u24 v21, v13, s5, v14
    s_waitcnt lgkmcnt(4)
    v_add_f32 v68, v68, v88
    v_add_f32 v69, v69, v89
    v_add_f32 v70, v70, v90
    v_add_f32 v71, v71, v91
    v_cvt_pk_bf16_f32 v28, v68, v69
    v_cvt_pk_bf16_f32 v29, v70, v71
    s_waitcnt lgkmcnt(3)
    v_add_f32 v72, v72, v92
    v_add_f32 v73, v73, v93
    v_add_f32 v74, v74, v94
    v_add_f32 v75, v75, v95
    v_cvt_pk_bf16_f32 v30, v72, v73
    v_cvt_pk_bf16_f32 v31, v74, v75
    s_waitcnt lgkmcnt(2)
    v_add_f32 v76, v76, v96
    v_add_f32 v77, v77, v97
    v_add_f32 v78, v78, v98
    v_add_f32 v79, v79, v99
    v_cvt_pk_bf16_f32 v32, v76, v77
    v_cvt_pk_bf16_f32 v33, v78, v79
    s_waitcnt lgkmcnt(1)
    v_add_f32 v80, v80, v100
    v_add_f32 v81, v81, v101
    v_add_f32 v82, v82, v102
    v_add_f32 v83, v83, v103
    v_cvt_pk_bf16_f32 v34, v80, v81
    v_cvt_pk_bf16_f32 v35, v82, v83
    s_waitcnt lgkmcnt(0)
    v_add_f32 v84, v84, v104
    v_add_f32 v85, v85, v105
    v_add_f32 v86, v86, v106
    v_add_f32 v87, v87, v107
    v_cvt_pk_bf16_f32 v36, v84, v85
    v_cvt_pk_bf16_f32 v37, v86, v87
    ds_write_b64 v11, v[28:29] offset:0
    ds_write_b64 v11, v[30:31] offset:32
    ds_write_b64 v11, v[32:33] offset:64
    ds_write_b64 v11, v[34:35] offset:96
    ds_write_b64 v11, v[36:37] offset:128
    s_waitcnt lgkmcnt(0)
    ds_read_b128 v[40:43], v16
    ds_read_b128 v[44:47], v17
    ds_read_b128 v[48:51], v18
    s_waitcnt lgkmcnt(2)
    buffer_store_dwordx4 v[40:43], v19, s[56:59], s7 offen
    s_waitcnt lgkmcnt(1)
    buffer_store_dwordx4 v[44:47], v20, s[56:59], s7 offen
    s_waitcnt lgkmcnt(0)
    s_mov_b64 exec, s[90:91]
    buffer_store_dwordx4 v[48:51], v21, s[56:59], s7 offen
    s_mov_b64 exec, -1
    s_endpgm
K1_Q:
    s_setprio 3
    s_sub_u32 s4, s2, 128
    s_lshr_b32 s5, s4, 3
    s_and_b32 s4, s4, 7
    s_lshr_b32 s10, s4, 1
    s_lshl_b32 s10, s10, 2
    s_and_b32 s6, s5, 3
    s_add_u32 s10, s10, s6
    s_and_b32 s4, s4, 1
    s_lshl_b32 s4, s4, 1
    s_lshr_b32 s5, s5, 2
    s_add_u32 s14, s5, s4
    s_mul_i32 s8, s14, 320
    s_mov_b32 s9, s8
    s_mov_b32 s44, s16
    s_and_b32 s45, s17, 0xffff
    s_mov_b32 s46, 2621440
    s_mov_b32 s47, 0x00020000
    s_mov_b32 s48, s18
    s_and_b32 s49, s19, 0xffff
    s_mov_b32 s50, 2457600
    s_mov_b32 s51, 0x00020000
    s_and_b32 s88, s3, 3
    s_lshr_b32 s89, s3, 2
    s_mov_b32 s90, 0xffff
    s_mov_b32 s91, 0
    v_lshrrev_b32 v13, 2, v1
    v_lshrrev_b32 v14, 4, v1
    v_sub_u32 v14, 0, v14
    v_xor_b32 v14, v14, v1
    v_and_b32 v14, 3, v14
    s_lshl_b32 s4, s10, 7
    s_lshl_b32 s5, s3, 4
    s_add_u32 s4, s4, s5
    v_add_u32 v13, s4, v13
    s_movk_i32 s5, 1280
    v_mul_u32_u24 v13, s5, v13
    v_lshl_add_u32 v4, v14, 4, v13
    s_mul_i32 s4, s3, 80
    s_mov_b32 s5, 3277
    s_mov_b32 s6, 3840
    v_add_u32 v13, s4, v1
    v_mul_u32_u24 v14, s5, v13
    v_lshrrev_b32 v14, 16, v14
    v_mul_u32_u24 v15, 20, v14
    v_sub_u32 v15, v13, v15
    v_bfe_u32 v16, v14, 3, 1
    v_lshlrev_b32 v16, 1, v16
    v_xor_b32 v15, v15, v16
    v_cmp_le_u32 vcc, 10, v15
    v_mul_u32_u24 v14, s6, v14
    v_cndmask_b32 v16, 0, 1, vcc
    v_mul_u32_u24 v17, 10, v16
    v_sub_u32 v15, v15, v17
    v_mul_u32_u24 v16, 160, v16
    v_cmp_gt_u32 vcc, 5, v15
    v_mov_b32 v17, s9
    v_mov_b32 v18, s8
    v_lshl_add_u32 v14, v15, 4, v14
    v_cndmask_b32 v17, v17, v18, vcc
    v_add3_u32 v5, v14, v16, v17
    v_add_u32 v13, s4, v1
    v_add_u32 v13, 64, v13
    v_mul_u32_u24 v14, s5, v13
    v_lshrrev_b32 v14, 16, v14
    v_mul_u32_u24 v15, 20, v14
    v_sub_u32 v15, v13, v15
    v_bfe_u32 v16, v14, 3, 1
    v_lshlrev_b32 v16, 1, v16
    v_xor_b32 v15, v15, v16
    v_cmp_le_u32 vcc, 10, v15
    v_mul_u32_u24 v14, s6, v14
    v_cndmask_b32 v16, 0, 1, vcc
    v_mul_u32_u24 v17, 10, v16
    v_sub_u32 v15, v15, v17
    v_mul_u32_u24 v16, 160, v16
    v_cmp_gt_u32 vcc, 5, v15
    v_mov_b32 v17, s9
    v_mov_b32 v18, s8
    v_lshl_add_u32 v14, v15, 4, v14
    v_cndmask_b32 v17, v17, v18, vcc
    v_add3_u32 v6, v14, v16, v17
    s_mul_i32 s12, s3, 1280
    buffer_load_dwordx4 v[60:63], v4, s[44:47], 0 offen offset:0
    buffer_load_dwordx4 v[64:67], v4, s[44:47], 0 offen offset:64
    s_add_u32 m0, s12, 0
    s_mov_b32 s13, 0
    buffer_load_dwordx4 v5, s[48:51], s13 offen lds
    s_add_u32 m0, s12, 1024
    s_mov_b64 exec, s[90:91]
    buffer_load_dwordx4 v6, s[48:51], s13 offen lds
    s_mov_b64 exec, -1
    buffer_load_dwordx4 v[68:71], v4, s[44:47], 0 offen offset:128
    s_add_u32 m0, s12, 10240
    s_mov_b32 s13, 122880
    buffer_load_dwordx4 v5, s[48:51], s13 offen lds
    s_add_u32 m0, s12, 11264
    s_mov_b64 exec, s[90:91]
    buffer_load_dwordx4 v6, s[48:51], s13 offen lds
    s_mov_b64 exec, -1
    s_lshl_b32 s5, s3, 10
    s_add_u32 s5, s5, 61440
    v_lshl_add_u32 v8, v1, 4, s5
    v_lshrrev_b32 v13, 2, v3
    v_lshl_add_u32 v13, v2, 3, v13
    s_movk_i32 s5, 320
    v_mul_u32_u24 v13, s5, v13
    v_and_b32 v14, 3, v3
    v_lshl_add_u32 v13, v14, 3, v13
    s_mul_i32 s5, s89, 160
    v_add_u32 v13, s5, v13
    v_and_b32 v14, 1, v2
    v_lshlrev_b32 v14, 5, v14
    s_cmp_eq_u32 s89, 0
    s_cselect_b32 s5, 1, -1
    v_mul_lo_u32 v14, v14, s5
    v_add_u32 v9, v13, v14
    v_sub_u32 v10, v13, v14
    v_lshrrev_b32 v13, 2, v3
    v_sub_u32 v13, 0, v13
    v_xor_b32 v13, v13, v2
    v_and_b32 v13, 3, v13
    v_lshlrev_b32 v13, 4, v13
    v_lshl_add_u32 v13, v3, 6, v13
    s_lshl_b32 s5, s88, 11
    s_add_u32 s5, s5, 61440
    v_add_u32 v7, s5, v13
    s_waitcnt vmcnt(5)
    ds_write_b128 v8, v[60:63] offset:0
    ds_write_b128 v8, v[64:67] offset:8192
    buffer_load_dwordx4 v[72:75], v4, s[44:47], 0 offen offset:192
    s_add_u32 m0, s12, 20480
    s_mov_b32 s13, 245760
    buffer_load_dwordx4 v5, s[48:51], s13 offen lds
    s_add_u32 m0, s12, 21504
    s_mov_b64 exec, s[90:91]
    buffer_load_dwordx4 v6, s[48:51], s13 offen lds
    s_mov_b64 exec, -1
    s_waitcnt vmcnt(6) lgkmcnt(0)
    s_barrier
    ds_read_b128 v[24:27], v7 offset:0
    ds_read_b128 v[28:31], v7 offset:1024
    ds_read_b64_tr_b16 v[40:41], v9 offset:0
    ds_read_b64_tr_b16 v[42:43], v9 offset:1280
    ds_read_b64_tr_b16 v[44:45], v10 offset:32
    ds_read_b64_tr_b16 v[46:47], v10 offset:1312
    ds_read_b64_tr_b16 v[48:49], v9 offset:64
    ds_read_b64_tr_b16 v[50:51], v9 offset:1344
    ds_read_b64_tr_b16 v[52:53], v10 offset:96
    ds_read_b64_tr_b16 v[54:55], v10 offset:1376
    ds_read_b64_tr_b16 v[56:57], v9 offset:128
    ds_read_b64_tr_b16 v[58:59], v9 offset:1408
    s_waitcnt vmcnt(3) lgkmcnt(0)
    s_barrier
    v_mfma_f32_16x16x32_bf16 v[84:87], v[40:43], v[24:27], 0
    ds_write_b128 v8, v[68:71] offset:0
    v_mfma_f32_16x16x32_bf16 v[104:107], v[40:43], v[28:31], 0
    ds_read_b128 v[32:35], v7 offset:8192
    ds_read_b128 v[36:39], v7 offset:9216
    ds_read_b64_tr_b16 v[40:41], v9 offset:10240
    ds_read_b64_tr_b16 v[42:43], v9 offset:11520
    v_mfma_f32_16x16x32_bf16 v[88:91], v[44:47], v[24:27], 0
    buffer_load_dwordx4 v[76:79], v4, s[44:47], 0 offen offset:256
    v_mfma_f32_16x16x32_bf16 v[108:111], v[44:47], v[28:31], 0
    s_add_u32 m0, s12, 30720
    s_mov_b32 s13, 368640
    buffer_load_dwordx4 v5, s[48:51], s13 offen lds
    ds_read_b64_tr_b16 v[44:45], v10 offset:10272
    ds_read_b64_tr_b16 v[46:47], v10 offset:11552
    v_mfma_f32_16x16x32_bf16 v[92:95], v[48:51], v[24:27], 0
    s_add_u32 m0, s12, 31744
    s_mov_b64 exec, s[90:91]
    buffer_load_dwordx4 v6, s[48:51], s13 offen lds
    s_mov_b64 exec, -1
    v_mfma_f32_16x16x32_bf16 v[112:115], v[48:51], v[28:31], 0
    buffer_load_dwordx4 v[80:83], v4, s[44:47], 0 offen offset:320
    ds_read_b64_tr_b16 v[48:49], v9 offset:10304
    ds_read_b64_tr_b16 v[50:51], v9 offset:11584
    v_mfma_f32_16x16x32_bf16 v[96:99], v[52:55], v[24:27], 0
    s_add_u32 m0, s12, 40960
    s_mov_b32 s13, 491520
    buffer_load_dwordx4 v5, s[48:51], s13 offen lds
    v_mfma_f32_16x16x32_bf16 v[116:119], v[52:55], v[28:31], 0
    s_add_u32 m0, s12, 41984
    s_mov_b64 exec, s[90:91]
    buffer_load_dwordx4 v6, s[48:51], s13 offen lds
    s_mov_b64 exec, -1
    ds_read_b64_tr_b16 v[52:53], v10 offset:10336
    ds_read_b64_tr_b16 v[54:55], v10 offset:11616
    v_mfma_f32_16x16x32_bf16 v[100:103], v[56:59], v[24:27], 0
    v_mfma_f32_16x16x32_bf16 v[120:123], v[56:59], v[28:31], 0
    ds_read_b64_tr_b16 v[56:57], v9 offset:10368
    ds_read_b64_tr_b16 v[58:59], v9 offset:11648
    s_waitcnt vmcnt(6) lgkmcnt(0)
    s_barrier
    v_mfma_f32_16x16x32_bf16 v[84:87], v[40:43], v[32:35], v[84:87]
    ds_write_b128 v8, v[72:75] offset:8192
    v_mfma_f32_16x16x32_bf16 v[104:107], v[40:43], v[36:39], v[104:107]
    ds_read_b128 v[24:27], v7 offset:0
    ds_read_b128 v[28:31], v7 offset:1024
    ds_read_b64_tr_b16 v[40:41], v9 offset:20480
    ds_read_b64_tr_b16 v[42:43], v9 offset:21760
    v_mfma_f32_16x16x32_bf16 v[88:91], v[44:47], v[32:35], v[88:91]
    buffer_load_dwordx4 v[60:63], v4, s[44:47], 0 offen offset:384
    v_mfma_f32_16x16x32_bf16 v[108:111], v[44:47], v[36:39], v[108:111]
    s_add_u32 m0, s12, 51200
    s_mov_b32 s13, 614400
    buffer_load_dwordx4 v5, s[48:51], s13 offen lds
    ds_read_b64_tr_b16 v[44:45], v10 offset:20512
    ds_read_b64_tr_b16 v[46:47], v10 offset:21792
    v_mfma_f32_16x16x32_bf16 v[92:95], v[48:51], v[32:35], v[92:95]
    s_add_u32 m0, s12, 52224
    s_mov_b64 exec, s[90:91]
    buffer_load_dwordx4 v6, s[48:51], s13 offen lds
    s_mov_b64 exec, -1
    v_mfma_f32_16x16x32_bf16 v[112:115], v[48:51], v[36:39], v[112:115]
    buffer_load_dwordx4 v[64:67], v4, s[44:47], 0 offen offset:448
    ds_read_b64_tr_b16 v[48:49], v9 offset:20544
    ds_read_b64_tr_b16 v[50:51], v9 offset:21824
    v_mfma_f32_16x16x32_bf16 v[96:99], v[52:55], v[32:35], v[96:99]
    s_add_u32 m0, s12, 0
    s_mov_b32 s13, 737280
    buffer_load_dwordx4 v5, s[48:51], s13 offen lds
    v_mfma_f32_16x16x32_bf16 v[116:119], v[52:55], v[36:39], v[116:119]
    s_add_u32 m0, s12, 1024
    s_mov_b64 exec, s[90:91]
    buffer_load_dwordx4 v6, s[48:51], s13 offen lds
    s_mov_b64 exec, -1
    ds_read_b64_tr_b16 v[52:53], v10 offset:20576
    ds_read_b64_tr_b16 v[54:55], v10 offset:21856
    v_mfma_f32_16x16x32_bf16 v[100:103], v[56:59], v[32:35], v[100:103]
    v_mfma_f32_16x16x32_bf16 v[120:123], v[56:59], v[36:39], v[120:123]
    ds_read_b64_tr_b16 v[56:57], v9 offset:20608
    ds_read_b64_tr_b16 v[58:59], v9 offset:21888
    s_waitcnt vmcnt(9) lgkmcnt(0)
    s_barrier
    v_mfma_f32_16x16x32_bf16 v[84:87], v[40:43], v[24:27], v[84:87]
    ds_write_b128 v8, v[76:79] offset:0
    v_mfma_f32_16x16x32_bf16 v[104:107], v[40:43], v[28:31], v[104:107]
    ds_read_b128 v[32:35], v7 offset:8192
    ds_read_b128 v[36:39], v7 offset:9216
    ds_read_b64_tr_b16 v[40:41], v9 offset:30720
    ds_read_b64_tr_b16 v[42:43], v9 offset:32000
    v_mfma_f32_16x16x32_bf16 v[88:91], v[44:47], v[24:27], v[88:91]
    buffer_load_dwordx4 v[68:71], v4, s[44:47], 0 offen offset:512
    v_mfma_f32_16x16x32_bf16 v[108:111], v[44:47], v[28:31], v[108:111]
    s_add_u32 m0, s12, 10240
    s_mov_b32 s13, 860160
    buffer_load_dwordx4 v5, s[48:51], s13 offen lds
    ds_read_b64_tr_b16 v[44:45], v10 offset:30752
    ds_read_b64_tr_b16 v[46:47], v10 offset:32032
    v_mfma_f32_16x16x32_bf16 v[92:95], v[48:51], v[24:27], v[92:95]
    s_add_u32 m0, s12, 11264
    s_mov_b64 exec, s[90:91]
    buffer_load_dwordx4 v6, s[48:51], s13 offen lds
    s_mov_b64 exec, -1
    v_mfma_f32_16x16x32_bf16 v[112:115], v[48:51], v[28:31], v[112:115]
    buffer_load_dwordx4 v[72:75], v4, s[44:47], 0 offen offset:576
    ds_read_b64_tr_b16 v[48:49], v9 offset:30784
    ds_read_b64_tr_b16 v[50:51], v9 offset:32064
    v_mfma_f32_16x16x32_bf16 v[96:99], v[52:55], v[24:27], v[96:99]
    s_add_u32 m0, s12, 20480
    s_mov_b32 s13, 983040
    buffer_load_dwordx4 v5, s[48:51], s13 offen lds
    v_mfma_f32_16x16x32_bf16 v[116:119], v[52:55], v[28:31], v[116:119]
    s_add_u32 m0, s12, 21504
    s_mov_b64 exec, s[90:91]
    buffer_load_dwordx4 v6, s[48:51], s13 offen lds
    s_mov_b64 exec, -1
    ds_read_b64_tr_b16 v[52:53], v10 offset:30816
    ds_read_b64_tr_b16 v[54:55], v10 offset:32096
    v_mfma_f32_16x16x32_bf16 v[100:103], v[56:59], v[24:27], v[100:103]
    v_mfma_f32_16x16x32_bf16 v[120:123], v[56:59], v[28:31], v[120:123]
    ds_read_b64_tr_b16 v[56:57], v9 offset:30848
    ds_read_b64_tr_b16 v[58:59], v9 offset:32128
    s_waitcnt vmcnt(12) lgkmcnt(0)
    s_barrier
    v_mfma_f32_16x16x32_bf16 v[84:87], v[40:43], v[32:35], v[84:87]
    ds_write_b128 v8, v[80:83] offset:8192
    v_mfma_f32_16x16x32_bf16 v[104:107], v[40:43], v[36:39], v[104:107]
    ds_read_b128 v[24:27], v7 offset:0
    ds_read_b128 v[28:31], v7 offset:1024
    ds_read_b64_tr_b16 v[40:41], v9 offset:40960
    ds_read_b64_tr_b16 v[42:43], v9 offset:42240
    v_mfma_f32_16x16x32_bf16 v[88:91], v[44:47], v[32:35], v[88:91]
    buffer_load_dwordx4 v[76:79], v4, s[44:47], 0 offen offset:640
    v_mfma_f32_16x16x32_bf16 v[108:111], v[44:47], v[36:39], v[108:111]
    s_add_u32 m0, s12, 30720
    s_mov_b32 s13, 1105920
    buffer_load_dwordx4 v5, s[48:51], s13 offen lds
    ds_read_b64_tr_b16 v[44:45], v10 offset:40992
    ds_read_b64_tr_b16 v[46:47], v10 offset:42272
    v_mfma_f32_16x16x32_bf16 v[92:95], v[48:51], v[32:35], v[92:95]
    s_add_u32 m0, s12, 31744
    s_mov_b64 exec, s[90:91]
    buffer_load_dwordx4 v6, s[48:51], s13 offen lds
    s_mov_b64 exec, -1
    v_mfma_f32_16x16x32_bf16 v[112:115], v[48:51], v[36:39], v[112:115]
    ds_read_b64_tr_b16 v[48:49], v9 offset:41024
    ds_read_b64_tr_b16 v[50:51], v9 offset:42304
    v_mfma_f32_16x16x32_bf16 v[96:99], v[52:55], v[32:35], v[96:99]
    v_mfma_f32_16x16x32_bf16 v[116:119], v[52:55], v[36:39], v[116:119]
    ds_read_b64_tr_b16 v[52:53], v10 offset:41056
    ds_read_b64_tr_b16 v[54:55], v10 offset:42336
    v_mfma_f32_16x16x32_bf16 v[100:103], v[56:59], v[32:35], v[100:103]
    v_mfma_f32_16x16x32_bf16 v[120:123], v[56:59], v[36:39], v[120:123]
    ds_read_b64_tr_b16 v[56:57], v9 offset:41088
    ds_read_b64_tr_b16 v[58:59], v9 offset:42368
    s_waitcnt vmcnt(12) lgkmcnt(0)
    s_barrier
    v_mfma_f32_16x16x32_bf16 v[84:87], v[40:43], v[24:27], v[84:87]
    ds_write_b128 v8, v[60:63] offset:0
    v_mfma_f32_16x16x32_bf16 v[104:107], v[40:43], v[28:31], v[104:107]
    ds_read_b128 v[32:35], v7 offset:8192
    ds_read_b128 v[36:39], v7 offset:9216
    ds_read_b64_tr_b16 v[40:41], v9 offset:51200
    ds_read_b64_tr_b16 v[42:43], v9 offset:52480
    v_mfma_f32_16x16x32_bf16 v[88:91], v[44:47], v[24:27], v[88:91]
    buffer_load_dwordx4 v[80:83], v4, s[44:47], 0 offen offset:704
    v_mfma_f32_16x16x32_bf16 v[108:111], v[44:47], v[28:31], v[108:111]
    s_add_u32 m0, s12, 40960
    s_mov_b32 s13, 1228800
    buffer_load_dwordx4 v5, s[48:51], s13 offen lds
    ds_read_b64_tr_b16 v[44:45], v10 offset:51232
    ds_read_b64_tr_b16 v[46:47], v10 offset:52512
    v_mfma_f32_16x16x32_bf16 v[92:95], v[48:51], v[24:27], v[92:95]
    s_add_u32 m0, s12, 41984
    s_mov_b64 exec, s[90:91]
    buffer_load_dwordx4 v6, s[48:51], s13 offen lds
    s_mov_b64 exec, -1
    v_mfma_f32_16x16x32_bf16 v[112:115], v[48:51], v[28:31], v[112:115]
    ds_read_b64_tr_b16 v[48:49], v9 offset:51264
    ds_read_b64_tr_b16 v[50:51], v9 offset:52544
    v_mfma_f32_16x16x32_bf16 v[96:99], v[52:55], v[24:27], v[96:99]
    v_mfma_f32_16x16x32_bf16 v[116:119], v[52:55], v[28:31], v[116:119]
    ds_read_b64_tr_b16 v[52:53], v10 offset:51296
    ds_read_b64_tr_b16 v[54:55], v10 offset:52576
    v_mfma_f32_16x16x32_bf16 v[100:103], v[56:59], v[24:27], v[100:103]
    v_mfma_f32_16x16x32_bf16 v[120:123], v[56:59], v[28:31], v[120:123]
    ds_read_b64_tr_b16 v[56:57], v9 offset:51328
    ds_read_b64_tr_b16 v[58:59], v9 offset:52608
    s_waitcnt vmcnt(12) lgkmcnt(0)
    s_barrier
    v_mfma_f32_16x16x32_bf16 v[84:87], v[40:43], v[32:35], v[84:87]
    ds_write_b128 v8, v[64:67] offset:8192
    v_mfma_f32_16x16x32_bf16 v[104:107], v[40:43], v[36:39], v[104:107]
    ds_read_b128 v[24:27], v7 offset:0
    ds_read_b128 v[28:31], v7 offset:1024
    ds_read_b64_tr_b16 v[40:41], v9 offset:0
    ds_read_b64_tr_b16 v[42:43], v9 offset:1280
    v_mfma_f32_16x16x32_bf16 v[88:91], v[44:47], v[32:35], v[88:91]
    buffer_load_dwordx4 v[60:63], v4, s[44:47], 0 offen offset:768
    v_mfma_f32_16x16x32_bf16 v[108:111], v[44:47], v[36:39], v[108:111]
    s_add_u32 m0, s12, 51200
    s_mov_b32 s13, 1351680
    buffer_load_dwordx4 v5, s[48:51], s13 offen lds
    ds_read_b64_tr_b16 v[44:45], v10 offset:32
    ds_read_b64_tr_b16 v[46:47], v10 offset:1312
    v_mfma_f32_16x16x32_bf16 v[92:95], v[48:51], v[32:35], v[92:95]
    s_add_u32 m0, s12, 52224
    s_mov_b64 exec, s[90:91]
    buffer_load_dwordx4 v6, s[48:51], s13 offen lds
    s_mov_b64 exec, -1
    v_mfma_f32_16x16x32_bf16 v[112:115], v[48:51], v[36:39], v[112:115]
    ds_read_b64_tr_b16 v[48:49], v9 offset:64
    ds_read_b64_tr_b16 v[50:51], v9 offset:1344
    v_mfma_f32_16x16x32_bf16 v[96:99], v[52:55], v[32:35], v[96:99]
    v_mfma_f32_16x16x32_bf16 v[116:119], v[52:55], v[36:39], v[116:119]
    ds_read_b64_tr_b16 v[52:53], v10 offset:96
    ds_read_b64_tr_b16 v[54:55], v10 offset:1376
    v_mfma_f32_16x16x32_bf16 v[100:103], v[56:59], v[32:35], v[100:103]
    v_mfma_f32_16x16x32_bf16 v[120:123], v[56:59], v[36:39], v[120:123]
    ds_read_b64_tr_b16 v[56:57], v9 offset:128
    ds_read_b64_tr_b16 v[58:59], v9 offset:1408
    s_waitcnt vmcnt(12) lgkmcnt(0)
    s_barrier
    v_mfma_f32_16x16x32_bf16 v[84:87], v[40:43], v[24:27], v[84:87]
    ds_write_b128 v8, v[68:71] offset:0
    v_mfma_f32_16x16x32_bf16 v[104:107], v[40:43], v[28:31], v[104:107]
    ds_read_b128 v[32:35], v7 offset:8192
    ds_read_b128 v[36:39], v7 offset:9216
    ds_read_b64_tr_b16 v[40:41], v9 offset:10240
    ds_read_b64_tr_b16 v[42:43], v9 offset:11520
    v_mfma_f32_16x16x32_bf16 v[88:91], v[44:47], v[24:27], v[88:91]
    buffer_load_dwordx4 v[64:67], v4, s[44:47], 0 offen offset:832
    v_mfma_f32_16x16x32_bf16 v[108:111], v[44:47], v[28:31], v[108:111]
    s_add_u32 m0, s12, 0
    s_mov_b32 s13, 1474560
    buffer_load_dwordx4 v5, s[48:51], s13 offen lds
    ds_read_b64_tr_b16 v[44:45], v10 offset:10272
    ds_read_b64_tr_b16 v[46:47], v10 offset:11552
    v_mfma_f32_16x16x32_bf16 v[92:95], v[48:51], v[24:27], v[92:95]
    s_add_u32 m0, s12, 1024
    s_mov_b64 exec, s[90:91]
    buffer_load_dwordx4 v6, s[48:51], s13 offen lds
    s_mov_b64 exec, -1
    v_mfma_f32_16x16x32_bf16 v[112:115], v[48:51], v[28:31], v[112:115]
    ds_read_b64_tr_b16 v[48:49], v9 offset:10304
    ds_read_b64_tr_b16 v[50:51], v9 offset:11584
    v_mfma_f32_16x16x32_bf16 v[96:99], v[52:55], v[24:27], v[96:99]
    v_mfma_f32_16x16x32_bf16 v[116:119], v[52:55], v[28:31], v[116:119]
    ds_read_b64_tr_b16 v[52:53], v10 offset:10336
    ds_read_b64_tr_b16 v[54:55], v10 offset:11616
    v_mfma_f32_16x16x32_bf16 v[100:103], v[56:59], v[24:27], v[100:103]
    v_mfma_f32_16x16x32_bf16 v[120:123], v[56:59], v[28:31], v[120:123]
    ds_read_b64_tr_b16 v[56:57], v9 offset:10368
    ds_read_b64_tr_b16 v[58:59], v9 offset:11648
    s_waitcnt vmcnt(12) lgkmcnt(0)
    s_barrier
    v_mfma_f32_16x16x32_bf16 v[84:87], v[40:43], v[32:35], v[84:87]
    ds_write_b128 v8, v[72:75] offset:8192
    v_mfma_f32_16x16x32_bf16 v[104:107], v[40:43], v[36:39], v[104:107]
    ds_read_b128 v[24:27], v7 offset:0
    ds_read_b128 v[28:31], v7 offset:1024
    ds_read_b64_tr_b16 v[40:41], v9 offset:20480
    ds_read_b64_tr_b16 v[42:43], v9 offset:21760
    v_mfma_f32_16x16x32_bf16 v[88:91], v[44:47], v[32:35], v[88:91]
    buffer_load_dwordx4 v[68:71], v4, s[44:47], 0 offen offset:896
    v_mfma_f32_16x16x32_bf16 v[108:111], v[44:47], v[36:39], v[108:111]
    s_add_u32 m0, s12, 10240
    s_mov_b32 s13, 1597440
    buffer_load_dwordx4 v5, s[48:51], s13 offen lds
    ds_read_b64_tr_b16 v[44:45], v10 offset:20512
    ds_read_b64_tr_b16 v[46:47], v10 offset:21792
    v_mfma_f32_16x16x32_bf16 v[92:95], v[48:51], v[32:35], v[92:95]
    s_add_u32 m0, s12, 11264
    s_mov_b64 exec, s[90:91]
    buffer_load_dwordx4 v6, s[48:51], s13 offen lds
    s_mov_b64 exec, -1
    v_mfma_f32_16x16x32_bf16 v[112:115], v[48:51], v[36:39], v[112:115]
    ds_read_b64_tr_b16 v[48:49], v9 offset:20544
    ds_read_b64_tr_b16 v[50:51], v9 offset:21824
    v_mfma_f32_16x16x32_bf16 v[96:99], v[52:55], v[32:35], v[96:99]
    v_mfma_f32_16x16x32_bf16 v[116:119], v[52:55], v[36:39], v[116:119]
    ds_read_b64_tr_b16 v[52:53], v10 offset:20576
    ds_read_b64_tr_b16 v[54:55], v10 offset:21856
    v_mfma_f32_16x16x32_bf16 v[100:103], v[56:59], v[32:35], v[100:103]
    v_mfma_f32_16x16x32_bf16 v[120:123], v[56:59], v[36:39], v[120:123]
    ds_read_b64_tr_b16 v[56:57], v9 offset:20608
    ds_read_b64_tr_b16 v[58:59], v9 offset:21888
    s_waitcnt vmcnt(12) lgkmcnt(0)
    s_barrier
    v_mfma_f32_16x16x32_bf16 v[84:87], v[40:43], v[24:27], v[84:87]
    ds_write_b128 v8, v[76:79] offset:0
    v_mfma_f32_16x16x32_bf16 v[104:107], v[40:43], v[28:31], v[104:107]
    ds_read_b128 v[32:35], v7 offset:8192
    ds_read_b128 v[36:39], v7 offset:9216
    ds_read_b64_tr_b16 v[40:41], v9 offset:30720
    ds_read_b64_tr_b16 v[42:43], v9 offset:32000
    v_mfma_f32_16x16x32_bf16 v[88:91], v[44:47], v[24:27], v[88:91]
    buffer_load_dwordx4 v[72:75], v4, s[44:47], 0 offen offset:960
    v_mfma_f32_16x16x32_bf16 v[108:111], v[44:47], v[28:31], v[108:111]
    s_add_u32 m0, s12, 20480
    s_mov_b32 s13, 1720320
    buffer_load_dwordx4 v5, s[48:51], s13 offen lds
    ds_read_b64_tr_b16 v[44:45], v10 offset:30752
    ds_read_b64_tr_b16 v[46:47], v10 offset:32032
    v_mfma_f32_16x16x32_bf16 v[92:95], v[48:51], v[24:27], v[92:95]
    s_add_u32 m0, s12, 21504
    s_mov_b64 exec, s[90:91]
    buffer_load_dwordx4 v6, s[48:51], s13 offen lds
    s_mov_b64 exec, -1
    v_mfma_f32_16x16x32_bf16 v[112:115], v[48:51], v[28:31], v[112:115]
    ds_read_b64_tr_b16 v[48:49], v9 offset:30784
    ds_read_b64_tr_b16 v[50:51], v9 offset:32064
    v_mfma_f32_16x16x32_bf16 v[96:99], v[52:55], v[24:27], v[96:99]
    v_mfma_f32_16x16x32_bf16 v[116:119], v[52:55], v[28:31], v[116:119]
    ds_read_b64_tr_b16 v[52:53], v10 offset:30816
    ds_read_b64_tr_b16 v[54:55], v10 offset:32096
    v_mfma_f32_16x16x32_bf16 v[100:103], v[56:59], v[24:27], v[100:103]
    v_mfma_f32_16x16x32_bf16 v[120:123], v[56:59], v[28:31], v[120:123]
    ds_read_b64_tr_b16 v[56:57], v9 offset:30848
    ds_read_b64_tr_b16 v[58:59], v9 offset:32128
    s_waitcnt vmcnt(12) lgkmcnt(0)
    s_barrier
    v_mfma_f32_16x16x32_bf16 v[84:87], v[40:43], v[32:35], v[84:87]
    ds_write_b128 v8, v[80:83] offset:8192
    v_mfma_f32_16x16x32_bf16 v[104:107], v[40:43], v[36:39], v[104:107]
    ds_read_b128 v[24:27], v7 offset:0
    ds_read_b128 v[28:31], v7 offset:1024
    ds_read_b64_tr_b16 v[40:41], v9 offset:40960
    ds_read_b64_tr_b16 v[42:43], v9 offset:42240
    v_mfma_f32_16x16x32_bf16 v[88:91], v[44:47], v[32:35], v[88:91]
    buffer_load_dwordx4 v[76:79], v4, s[44:47], 0 offen offset:1024
    v_mfma_f32_16x16x32_bf16 v[108:111], v[44:47], v[36:39], v[108:111]
    s_add_u32 m0, s12, 30720
    s_mov_b32 s13, 1843200
    buffer_load_dwordx4 v5, s[48:51], s13 offen lds
    ds_read_b64_tr_b16 v[44:45], v10 offset:40992
    ds_read_b64_tr_b16 v[46:47], v10 offset:42272
    v_mfma_f32_16x16x32_bf16 v[92:95], v[48:51], v[32:35], v[92:95]
    s_add_u32 m0, s12, 31744
    s_mov_b64 exec, s[90:91]
    buffer_load_dwordx4 v6, s[48:51], s13 offen lds
    s_mov_b64 exec, -1
    v_mfma_f32_16x16x32_bf16 v[112:115], v[48:51], v[36:39], v[112:115]
    ds_read_b64_tr_b16 v[48:49], v9 offset:41024
    ds_read_b64_tr_b16 v[50:51], v9 offset:42304
    v_mfma_f32_16x16x32_bf16 v[96:99], v[52:55], v[32:35], v[96:99]
    v_mfma_f32_16x16x32_bf16 v[116:119], v[52:55], v[36:39], v[116:119]
    ds_read_b64_tr_b16 v[52:53], v10 offset:41056
    ds_read_b64_tr_b16 v[54:55], v10 offset:42336
    v_mfma_f32_16x16x32_bf16 v[100:103], v[56:59], v[32:35], v[100:103]
    v_mfma_f32_16x16x32_bf16 v[120:123], v[56:59], v[36:39], v[120:123]
    ds_read_b64_tr_b16 v[56:57], v9 offset:41088
    ds_read_b64_tr_b16 v[58:59], v9 offset:42368
    s_waitcnt vmcnt(12) lgkmcnt(0)
    s_barrier
    v_mfma_f32_16x16x32_bf16 v[84:87], v[40:43], v[24:27], v[84:87]
    ds_write_b128 v8, v[60:63] offset:0
    v_mfma_f32_16x16x32_bf16 v[104:107], v[40:43], v[28:31], v[104:107]
    ds_read_b128 v[32:35], v7 offset:8192
    ds_read_b128 v[36:39], v7 offset:9216
    ds_read_b64_tr_b16 v[40:41], v9 offset:51200
    ds_read_b64_tr_b16 v[42:43], v9 offset:52480
    v_mfma_f32_16x16x32_bf16 v[88:91], v[44:47], v[24:27], v[88:91]
    buffer_load_dwordx4 v[80:83], v4, s[44:47], 0 offen offset:1088
    v_mfma_f32_16x16x32_bf16 v[108:111], v[44:47], v[28:31], v[108:111]
    s_add_u32 m0, s12, 40960
    s_mov_b32 s13, 1966080
    buffer_load_dwordx4 v5, s[48:51], s13 offen lds
    ds_read_b64_tr_b16 v[44:45], v10 offset:51232
    ds_read_b64_tr_b16 v[46:47], v10 offset:52512
    v_mfma_f32_16x16x32_bf16 v[92:95], v[48:51], v[24:27], v[92:95]
    s_add_u32 m0, s12, 41984
    s_mov_b64 exec, s[90:91]
    buffer_load_dwordx4 v6, s[48:51], s13 offen lds
    s_mov_b64 exec, -1
    v_mfma_f32_16x16x32_bf16 v[112:115], v[48:51], v[28:31], v[112:115]
    ds_read_b64_tr_b16 v[48:49], v9 offset:51264
    ds_read_b64_tr_b16 v[50:51], v9 offset:52544
    v_mfma_f32_16x16x32_bf16 v[96:99], v[52:55], v[24:27], v[96:99]
    v_mfma_f32_16x16x32_bf16 v[116:119], v[52:55], v[28:31], v[116:119]
    ds_read_b64_tr_b16 v[52:53], v10 offset:51296
    ds_read_b64_tr_b16 v[54:55], v10 offset:52576
    v_mfma_f32_16x16x32_bf16 v[100:103], v[56:59], v[24:27], v[100:103]
    v_mfma_f32_16x16x32_bf16 v[120:123], v[56:59], v[28:31], v[120:123]
    ds_read_b64_tr_b16 v[56:57], v9 offset:51328
    ds_read_b64_tr_b16 v[58:59], v9 offset:52608
    s_waitcnt vmcnt(12) lgkmcnt(0)
    s_barrier
    v_mfma_f32_16x16x32_bf16 v[84:87], v[40:43], v[32:35], v[84:87]
    ds_write_b128 v8, v[64:67] offset:8192
    v_mfma_f32_16x16x32_bf16 v[104:107], v[40:43], v[36:39], v[104:107]
    ds_read_b128 v[24:27], v7 offset:0
    ds_read_b128 v[28:31], v7 offset:1024
    ds_read_b64_tr_b16 v[40:41], v9 offset:0
    ds_read_b64_tr_b16 v[42:43], v9 offset:1280
    v_mfma_f32_16x16x32_bf16 v[88:91], v[44:47], v[32:35], v[88:91]
    buffer_load_dwordx4 v[60:63], v4, s[44:47], 0 offen offset:1152
    v_mfma_f32_16x16x32_bf16 v[108:111], v[44:47], v[36:39], v[108:111]
    s_add_u32 m0, s12, 51200
    s_mov_b32 s13, 2088960
    buffer_load_dwordx4 v5, s[48:51], s13 offen lds
    ds_read_b64_tr_b16 v[44:45], v10 offset:32
    ds_read_b64_tr_b16 v[46:47], v10 offset:1312
    v_mfma_f32_16x16x32_bf16 v[92:95], v[48:51], v[32:35], v[92:95]
    s_add_u32 m0, s12, 52224
    s_mov_b64 exec, s[90:91]
    buffer_load_dwordx4 v6, s[48:51], s13 offen lds
    s_mov_b64 exec, -1
    v_mfma_f32_16x16x32_bf16 v[112:115], v[48:51], v[36:39], v[112:115]
    ds_read_b64_tr_b16 v[48:49], v9 offset:64
    ds_read_b64_tr_b16 v[50:51], v9 offset:1344
    v_mfma_f32_16x16x32_bf16 v[96:99], v[52:55], v[32:35], v[96:99]
    v_mfma_f32_16x16x32_bf16 v[116:119], v[52:55], v[36:39], v[116:119]
    ds_read_b64_tr_b16 v[52:53], v10 offset:96
    ds_read_b64_tr_b16 v[54:55], v10 offset:1376
    v_mfma_f32_16x16x32_bf16 v[100:103], v[56:59], v[32:35], v[100:103]
    v_mfma_f32_16x16x32_bf16 v[120:123], v[56:59], v[36:39], v[120:123]
    ds_read_b64_tr_b16 v[56:57], v9 offset:128
    ds_read_b64_tr_b16 v[58:59], v9 offset:1408
    s_waitcnt vmcnt(12) lgkmcnt(0)
    s_barrier
    v_mfma_f32_16x16x32_bf16 v[84:87], v[40:43], v[24:27], v[84:87]
    ds_write_b128 v8, v[68:71] offset:0
    v_mfma_f32_16x16x32_bf16 v[104:107], v[40:43], v[28:31], v[104:107]
    ds_read_b128 v[32:35], v7 offset:8192
    ds_read_b128 v[36:39], v7 offset:9216
    ds_read_b64_tr_b16 v[40:41], v9 offset:10240
    ds_read_b64_tr_b16 v[42:43], v9 offset:11520
    v_mfma_f32_16x16x32_bf16 v[88:91], v[44:47], v[24:27], v[88:91]
    buffer_load_dwordx4 v[64:67], v4, s[44:47], 0 offen offset:1216
    v_mfma_f32_16x16x32_bf16 v[108:111], v[44:47], v[28:31], v[108:111]
    s_add_u32 m0, s12, 0
    s_mov_b32 s13, 2211840
    buffer_load_dwordx4 v5, s[48:51], s13 offen lds
    ds_read_b64_tr_b16 v[44:45], v10 offset:10272
    ds_read_b64_tr_b16 v[46:47], v10 offset:11552
    v_mfma_f32_16x16x32_bf16 v[92:95], v[48:51], v[24:27], v[92:95]
    s_add_u32 m0, s12, 1024
    s_mov_b64 exec, s[90:91]
    buffer_load_dwordx4 v6, s[48:51], s13 offen lds
    s_mov_b64 exec, -1
    v_mfma_f32_16x16x32_bf16 v[112:115], v[48:51], v[28:31], v[112:115]
    ds_read_b64_tr_b16 v[48:49], v9 offset:10304
    ds_read_b64_tr_b16 v[50:51], v9 offset:11584
    v_mfma_f32_16x16x32_bf16 v[96:99], v[52:55], v[24:27], v[96:99]
    v_mfma_f32_16x16x32_bf16 v[116:119], v[52:55], v[28:31], v[116:119]
    ds_read_b64_tr_b16 v[52:53], v10 offset:10336
    ds_read_b64_tr_b16 v[54:55], v10 offset:11616
    v_mfma_f32_16x16x32_bf16 v[100:103], v[56:59], v[24:27], v[100:103]
    v_mfma_f32_16x16x32_bf16 v[120:123], v[56:59], v[28:31], v[120:123]
    ds_read_b64_tr_b16 v[56:57], v9 offset:10368
    ds_read_b64_tr_b16 v[58:59], v9 offset:11648
    s_waitcnt vmcnt(12) lgkmcnt(0)
    s_barrier
    v_mfma_f32_16x16x32_bf16 v[84:87], v[40:43], v[32:35], v[84:87]
    ds_write_b128 v8, v[72:75] offset:8192
    v_mfma_f32_16x16x32_bf16 v[104:107], v[40:43], v[36:39], v[104:107]
    ds_read_b128 v[24:27], v7 offset:0
    ds_read_b128 v[28:31], v7 offset:1024
    ds_read_b64_tr_b16 v[40:41], v9 offset:20480
    ds_read_b64_tr_b16 v[42:43], v9 offset:21760
    v_mfma_f32_16x16x32_bf16 v[88:91], v[44:47], v[32:35], v[88:91]
    s_add_u32 m0, s12, 10240
    s_mov_b32 s13, 2334720
    buffer_load_dwordx4 v5, s[48:51], s13 offen lds
    v_mfma_f32_16x16x32_bf16 v[108:111], v[44:47], v[36:39], v[108:111]
    s_add_u32 m0, s12, 11264
    s_mov_b64 exec, s[90:91]
    buffer_load_dwordx4 v6, s[48:51], s13 offen lds
    s_mov_b64 exec, -1
    ds_read_b64_tr_b16 v[44:45], v10 offset:20512
    ds_read_b64_tr_b16 v[46:47], v10 offset:21792
    v_mfma_f32_16x16x32_bf16 v[92:95], v[48:51], v[32:35], v[92:95]
    v_mfma_f32_16x16x32_bf16 v[112:115], v[48:51], v[36:39], v[112:115]
    ds_read_b64_tr_b16 v[48:49], v9 offset:20544
    ds_read_b64_tr_b16 v[50:51], v9 offset:21824
    v_mfma_f32_16x16x32_bf16 v[96:99], v[52:55], v[32:35], v[96:99]
    v_mfma_f32_16x16x32_bf16 v[116:119], v[52:55], v[36:39], v[116:119]
    ds_read_b64_tr_b16 v[52:53], v10 offset:20576
    ds_read_b64_tr_b16 v[54:55], v10 offset:21856
    v_mfma_f32_16x16x32_bf16 v[100:103], v[56:59], v[32:35], v[100:103]
    v_mfma_f32_16x16x32_bf16 v[120:123], v[56:59], v[36:39], v[120:123]
    ds_read_b64_tr_b16 v[56:57], v9 offset:20608
    ds_read_b64_tr_b16 v[58:59], v9 offset:21888
    s_waitcnt vmcnt(11) lgkmcnt(0)
    s_barrier
    v_mfma_f32_16x16x32_bf16 v[84:87], v[40:43], v[24:27], v[84:87]
    ds_write_b128 v8, v[76:79] offset:0
    v_mfma_f32_16x16x32_bf16 v[104:107], v[40:43], v[28:31], v[104:107]
    ds_read_b128 v[32:35], v7 offset:8192
    ds_read_b128 v[36:39], v7 offset:9216
    ds_read_b64_tr_b16 v[40:41], v9 offset:30720
    ds_read_b64_tr_b16 v[42:43], v9 offset:32000
    v_mfma_f32_16x16x32_bf16 v[88:91], v[44:47], v[24:27], v[88:91]
    v_mfma_f32_16x16x32_bf16 v[108:111], v[44:47], v[28:31], v[108:111]
    ds_read_b64_tr_b16 v[44:45], v10 offset:30752
    ds_read_b64_tr_b16 v[46:47], v10 offset:32032
    v_mfma_f32_16x16x32_bf16 v[92:95], v[48:51], v[24:27], v[92:95]
    v_mfma_f32_16x16x32_bf16 v[112:115], v[48:51], v[28:31], v[112:115]
    ds_read_b64_tr_b16 v[48:49], v9 offset:30784
    ds_read_b64_tr_b16 v[50:51], v9 offset:32064
    v_mfma_f32_16x16x32_bf16 v[96:99], v[52:55], v[24:27], v[96:99]
    v_mfma_f32_16x16x32_bf16 v[116:119], v[52:55], v[28:31], v[116:119]
    ds_read_b64_tr_b16 v[52:53], v10 offset:30816
    ds_read_b64_tr_b16 v[54:55], v10 offset:32096
    v_mfma_f32_16x16x32_bf16 v[100:103], v[56:59], v[24:27], v[100:103]
    v_mfma_f32_16x16x32_bf16 v[120:123], v[56:59], v[28:31], v[120:123]
    ds_read_b64_tr_b16 v[56:57], v9 offset:30848
    ds_read_b64_tr_b16 v[58:59], v9 offset:32128
    s_waitcnt vmcnt(8) lgkmcnt(0)
    s_barrier
    v_mfma_f32_16x16x32_bf16 v[84:87], v[40:43], v[32:35], v[84:87]
    ds_write_b128 v8, v[80:83] offset:8192
    v_mfma_f32_16x16x32_bf16 v[104:107], v[40:43], v[36:39], v[104:107]
    ds_read_b128 v[24:27], v7 offset:0
    ds_read_b128 v[28:31], v7 offset:1024
    ds_read_b64_tr_b16 v[40:41], v9 offset:40960
    ds_read_b64_tr_b16 v[42:43], v9 offset:42240
    v_mfma_f32_16x16x32_bf16 v[88:91], v[44:47], v[32:35], v[88:91]
    v_mfma_f32_16x16x32_bf16 v[108:111], v[44:47], v[36:39], v[108:111]
    ds_read_b64_tr_b16 v[44:45], v10 offset:40992
    ds_read_b64_tr_b16 v[46:47], v10 offset:42272
    v_mfma_f32_16x16x32_bf16 v[92:95], v[48:51], v[32:35], v[92:95]
    v_mfma_f32_16x16x32_bf16 v[112:115], v[48:51], v[36:39], v[112:115]
    ds_read_b64_tr_b16 v[48:49], v9 offset:41024
    ds_read_b64_tr_b16 v[50:51], v9 offset:42304
    v_mfma_f32_16x16x32_bf16 v[96:99], v[52:55], v[32:35], v[96:99]
    v_mfma_f32_16x16x32_bf16 v[116:119], v[52:55], v[36:39], v[116:119]
    ds_read_b64_tr_b16 v[52:53], v10 offset:41056
    ds_read_b64_tr_b16 v[54:55], v10 offset:42336
    v_mfma_f32_16x16x32_bf16 v[100:103], v[56:59], v[32:35], v[100:103]
    v_mfma_f32_16x16x32_bf16 v[120:123], v[56:59], v[36:39], v[120:123]
    ds_read_b64_tr_b16 v[56:57], v9 offset:41088
    ds_read_b64_tr_b16 v[58:59], v9 offset:42368
    s_waitcnt vmcnt(5) lgkmcnt(0)
    s_barrier
    v_mfma_f32_16x16x32_bf16 v[84:87], v[40:43], v[24:27], v[84:87]
    ds_write_b128 v8, v[60:63] offset:0
    v_mfma_f32_16x16x32_bf16 v[104:107], v[40:43], v[28:31], v[104:107]
    ds_read_b128 v[32:35], v7 offset:8192
    ds_read_b128 v[36:39], v7 offset:9216
    ds_read_b64_tr_b16 v[40:41], v9 offset:51200
    ds_read_b64_tr_b16 v[42:43], v9 offset:52480
    v_mfma_f32_16x16x32_bf16 v[88:91], v[44:47], v[24:27], v[88:91]
    v_mfma_f32_16x16x32_bf16 v[108:111], v[44:47], v[28:31], v[108:111]
    ds_read_b64_tr_b16 v[44:45], v10 offset:51232
    ds_read_b64_tr_b16 v[46:47], v10 offset:52512
    v_mfma_f32_16x16x32_bf16 v[92:95], v[48:51], v[24:27], v[92:95]
    v_mfma_f32_16x16x32_bf16 v[112:115], v[48:51], v[28:31], v[112:115]
    ds_read_b64_tr_b16 v[48:49], v9 offset:51264
    ds_read_b64_tr_b16 v[50:51], v9 offset:52544
    v_mfma_f32_16x16x32_bf16 v[96:99], v[52:55], v[24:27], v[96:99]
    v_mfma_f32_16x16x32_bf16 v[116:119], v[52:55], v[28:31], v[116:119]
    ds_read_b64_tr_b16 v[52:53], v10 offset:51296
    ds_read_b64_tr_b16 v[54:55], v10 offset:52576
    v_mfma_f32_16x16x32_bf16 v[100:103], v[56:59], v[24:27], v[100:103]
    v_mfma_f32_16x16x32_bf16 v[120:123], v[56:59], v[28:31], v[120:123]
    ds_read_b64_tr_b16 v[56:57], v9 offset:51328
    ds_read_b64_tr_b16 v[58:59], v9 offset:52608
    s_waitcnt vmcnt(2) lgkmcnt(0)
    s_barrier
    v_mfma_f32_16x16x32_bf16 v[84:87], v[40:43], v[32:35], v[84:87]
    ds_write_b128 v8, v[64:67] offset:8192
    v_mfma_f32_16x16x32_bf16 v[104:107], v[40:43], v[36:39], v[104:107]
    ds_read_b128 v[24:27], v7 offset:0
    ds_read_b128 v[28:31], v7 offset:1024
    ds_read_b64_tr_b16 v[40:41], v9 offset:0
    ds_read_b64_tr_b16 v[42:43], v9 offset:1280
    v_mfma_f32_16x16x32_bf16 v[88:91], v[44:47], v[32:35], v[88:91]
    v_mfma_f32_16x16x32_bf16 v[108:111], v[44:47], v[36:39], v[108:111]
    ds_read_b64_tr_b16 v[44:45], v10 offset:32
    ds_read_b64_tr_b16 v[46:47], v10 offset:1312
    v_mfma_f32_16x16x32_bf16 v[92:95], v[48:51], v[32:35], v[92:95]
    v_mfma_f32_16x16x32_bf16 v[112:115], v[48:51], v[36:39], v[112:115]
    ds_read_b64_tr_b16 v[48:49], v9 offset:64
    ds_read_b64_tr_b16 v[50:51], v9 offset:1344
    v_mfma_f32_16x16x32_bf16 v[96:99], v[52:55], v[32:35], v[96:99]
    v_mfma_f32_16x16x32_bf16 v[116:119], v[52:55], v[36:39], v[116:119]
    ds_read_b64_tr_b16 v[52:53], v10 offset:96
    ds_read_b64_tr_b16 v[54:55], v10 offset:1376
    v_mfma_f32_16x16x32_bf16 v[100:103], v[56:59], v[32:35], v[100:103]
    v_mfma_f32_16x16x32_bf16 v[120:123], v[56:59], v[36:39], v[120:123]
    ds_read_b64_tr_b16 v[56:57], v9 offset:128
    ds_read_b64_tr_b16 v[58:59], v9 offset:1408
    s_waitcnt vmcnt(0) lgkmcnt(0)
    s_barrier
    v_mfma_f32_16x16x32_bf16 v[84:87], v[40:43], v[24:27], v[84:87]
    ds_read_b128 v[32:35], v7 offset:8192
    ds_read_b128 v[36:39], v7 offset:9216
    v_mfma_f32_16x16x32_bf16 v[104:107], v[40:43], v[28:31], v[104:107]
    ds_read_b64_tr_b16 v[40:41], v9 offset:10240
    ds_read_b64_tr_b16 v[42:43], v9 offset:11520
    v_mfma_f32_16x16x32_bf16 v[88:91], v[44:47], v[24:27], v[88:91]
    v_mfma_f32_16x16x32_bf16 v[108:111], v[44:47], v[28:31], v[108:111]
    ds_read_b64_tr_b16 v[44:45], v10 offset:10272
    ds_read_b64_tr_b16 v[46:47], v10 offset:11552
    v_mfma_f32_16x16x32_bf16 v[92:95], v[48:51], v[24:27], v[92:95]
    v_mfma_f32_16x16x32_bf16 v[112:115], v[48:51], v[28:31], v[112:115]
    ds_read_b64_tr_b16 v[48:49], v9 offset:10304
    ds_read_b64_tr_b16 v[50:51], v9 offset:11584
    v_mfma_f32_16x16x32_bf16 v[96:99], v[52:55], v[24:27], v[96:99]
    v_mfma_f32_16x16x32_bf16 v[116:119], v[52:55], v[28:31], v[116:119]
    ds_read_b64_tr_b16 v[52:53], v10 offset:10336
    ds_read_b64_tr_b16 v[54:55], v10 offset:11616
    v_mfma_f32_16x16x32_bf16 v[100:103], v[56:59], v[24:27], v[100:103]
    v_mfma_f32_16x16x32_bf16 v[120:123], v[56:59], v[28:31], v[120:123]
    ds_read_b64_tr_b16 v[56:57], v9 offset:10368
    ds_read_b64_tr_b16 v[58:59], v9 offset:11648
    s_waitcnt lgkmcnt(0)
    v_mfma_f32_16x16x32_bf16 v[84:87], v[40:43], v[32:35], v[84:87]
    v_mfma_f32_16x16x32_bf16 v[104:107], v[40:43], v[36:39], v[104:107]
    v_mfma_f32_16x16x32_bf16 v[88:91], v[44:47], v[32:35], v[88:91]
    v_mfma_f32_16x16x32_bf16 v[108:111], v[44:47], v[36:39], v[108:111]
    v_mfma_f32_16x16x32_bf16 v[92:95], v[48:51], v[32:35], v[92:95]
    v_mfma_f32_16x16x32_bf16 v[112:115], v[48:51], v[36:39], v[112:115]
    v_mfma_f32_16x16x32_bf16 v[96:99], v[52:55], v[32:35], v[96:99]
    v_mfma_f32_16x16x32_bf16 v[116:119], v[52:55], v[36:39], v[116:119]
    v_mfma_f32_16x16x32_bf16 v[100:103], v[56:59], v[32:35], v[100:103]
    v_mfma_f32_16x16x32_bf16 v[120:123], v[56:59], v[36:39], v[120:123]
    s_mov_b32 s52, s40
    s_and_b32 s53, s41, 0xffff
    s_mov_b32 s54, 4194304
    s_mov_b32 s55, 0x00020000
    s_mul_i32 s4, s3, 5632
    s_movk_i32 s5, 176
    v_mul_u32_u24 v17, s5, v3
    v_add_u32 v17, s4, v17
    v_lshl_add_u32 v18, v2, 4, v17
    v_lshl_add_u32 v17, v2, 3, v17
    s_barrier
    v_cvt_pk_bf16_f32 v13, v84, v85
    v_cvt_pk_bf16_f32 v40, v86, v87
    v_lshlrev_b32 v14, 16, v13
    v_lshlrev_b32 v41, 16, v40
    v_and_b32 v13, s85, v13
    v_and_b32 v40, s85, v40
    v_min_f32 v15, 0, v14
    v_min_f32 v42, 0, v41
    v_min_f32 v16, 0, v13
    v_min_f32 v43, 0, v40
    v_mul_f32 v15, s84, v15
    v_mul_f32 v42, s84, v42
    v_mul_f32 v16, s84, v16
    v_mul_f32 v43, s84, v43
    v_exp_f32 v15, v15
    v_exp_f32 v42, v42
    v_exp_f32 v16, v16
    v_exp_f32 v43, v43
    v_max_f32 v14, 0, v14
    v_max_f32 v41, 0, v41
    v_max_f32 v13, 0, v13
    v_max_f32 v40, 0, v40
    v_add_f32 v14, v14, v15
    v_add_f32 v41, v41, v42
    v_add_f32 v13, v13, v16
    v_add_f32 v40, v40, v43
    v_cvt_pk_bf16_f32 v13, v14, v13
    v_cvt_pk_bf16_f32 v40, v41, v40
    v_lshlrev_b32 v14, 16, v13
    v_lshlrev_b32 v41, 16, v40
    v_and_b32 v13, s85, v13
    v_and_b32 v40, s85, v40
    v_add_f32 v14, s86, v14
    v_add_f32 v41, s86, v41
    v_add_f32 v13, s86, v13
    v_add_f32 v40, s86, v40
    v_cvt_pk_bf16_f32 v24, v14, v13
    v_cvt_pk_bf16_f32 v25, v41, v40
    ds_write_b64 v17, v[24:25] offset:0
    v_cvt_pk_bf16_f32 v13, v88, v89
    v_cvt_pk_bf16_f32 v40, v90, v91
    v_lshlrev_b32 v14, 16, v13
    v_lshlrev_b32 v41, 16, v40
    v_and_b32 v13, s85, v13
    v_and_b32 v40, s85, v40
    v_min_f32 v15, 0, v14
    v_min_f32 v42, 0, v41
    v_min_f32 v16, 0, v13
    v_min_f32 v43, 0, v40
    v_mul_f32 v15, s84, v15
    v_mul_f32 v42, s84, v42
    v_mul_f32 v16, s84, v16
    v_mul_f32 v43, s84, v43
    v_exp_f32 v15, v15
    v_exp_f32 v42, v42
    v_exp_f32 v16, v16
    v_exp_f32 v43, v43
    v_max_f32 v14, 0, v14
    v_max_f32 v41, 0, v41
    v_max_f32 v13, 0, v13
    v_max_f32 v40, 0, v40
    v_add_f32 v14, v14, v15
    v_add_f32 v41, v41, v42
    v_add_f32 v13, v13, v16
    v_add_f32 v40, v40, v43
    v_cvt_pk_bf16_f32 v13, v14, v13
    v_cvt_pk_bf16_f32 v40, v41, v40
    v_lshlrev_b32 v14, 16, v13
    v_lshlrev_b32 v41, 16, v40
    v_and_b32 v13, s85, v13
    v_and_b32 v40, s85, v40
    v_add_f32 v14, s86, v14
    v_add_f32 v41, s86, v41
    v_add_f32 v13, s86, v13
    v_add_f32 v40, s86, v40
    v_cvt_pk_bf16_f32 v26, v14, v13
    v_cvt_pk_bf16_f32 v27, v41, v40
    ds_write_b64 v17, v[26:27] offset:32
    v_cvt_pk_bf16_f32 v13, v92, v93
    v_cvt_pk_bf16_f32 v40, v94, v95
    v_lshlrev_b32 v14, 16, v13
    v_lshlrev_b32 v41, 16, v40
    v_and_b32 v13, s85, v13
    v_and_b32 v40, s85, v40
    v_min_f32 v15, 0, v14
    v_min_f32 v42, 0, v41
    v_min_f32 v16, 0, v13
    v_min_f32 v43, 0, v40
    v_mul_f32 v15, s84, v15
    v_mul_f32 v42, s84, v42
    v_mul_f32 v16, s84, v16
    v_mul_f32 v43, s84, v43
    v_exp_f32 v15, v15
    v_exp_f32 v42, v42
    v_exp_f32 v16, v16
    v_exp_f32 v43, v43
    v_max_f32 v14, 0, v14
    v_max_f32 v41, 0, v41
    v_max_f32 v13, 0, v13
    v_max_f32 v40, 0, v40
    v_add_f32 v14, v14, v15
    v_add_f32 v41, v41, v42
    v_add_f32 v13, v13, v16
    v_add_f32 v40, v40, v43
    v_cvt_pk_bf16_f32 v13, v14, v13
    v_cvt_pk_bf16_f32 v40, v41, v40
    v_lshlrev_b32 v14, 16, v13
    v_lshlrev_b32 v41, 16, v40
    v_and_b32 v13, s85, v13
    v_and_b32 v40, s85, v40
    v_add_f32 v14, s86, v14
    v_add_f32 v41, s86, v41
    v_add_f32 v13, s86, v13
    v_add_f32 v40, s86, v40
    v_cvt_pk_bf16_f32 v28, v14, v13
    v_cvt_pk_bf16_f32 v29, v41, v40
    ds_write_b64 v17, v[28:29] offset:64
    v_cvt_pk_bf16_f32 v13, v96, v97
    v_cvt_pk_bf16_f32 v40, v98, v99
    v_lshlrev_b32 v14, 16, v13
    v_lshlrev_b32 v41, 16, v40
    v_and_b32 v13, s85, v13
    v_and_b32 v40, s85, v40
    v_min_f32 v15, 0, v14
    v_min_f32 v42, 0, v41
    v_min_f32 v16, 0, v13
    v_min_f32 v43, 0, v40
    v_mul_f32 v15, s84, v15
    v_mul_f32 v42, s84, v42
    v_mul_f32 v16, s84, v16
    v_mul_f32 v43, s84, v43
    v_exp_f32 v15, v15
    v_exp_f32 v42, v42
    v_exp_f32 v16, v16
    v_exp_f32 v43, v43
    v_max_f32 v14, 0, v14
    v_max_f32 v41, 0, v41
    v_max_f32 v13, 0, v13
    v_max_f32 v40, 0, v40
    v_add_f32 v14, v14, v15
    v_add_f32 v41, v41, v42
    v_add_f32 v13, v13, v16
    v_add_f32 v40, v40, v43
    v_cvt_pk_bf16_f32 v13, v14, v13
    v_cvt_pk_bf16_f32 v40, v41, v40
    v_lshlrev_b32 v14, 16, v13
    v_lshlrev_b32 v41, 16, v40
    v_and_b32 v13, s85, v13
    v_and_b32 v40, s85, v40
    v_add_f32 v14, s86, v14
    v_add_f32 v41, s86, v41
    v_add_f32 v13, s86, v13
    v_add_f32 v40, s86, v40
    v_cvt_pk_bf16_f32 v30, v14, v13
    v_cvt_pk_bf16_f32 v31, v41, v40
    ds_write_b64 v17, v[30:31] offset:96
    v_cvt_pk_bf16_f32 v13, v100, v101
    v_cvt_pk_bf16_f32 v40, v102, v103
    v_lshlrev_b32 v14, 16, v13
    v_lshlrev_b32 v41, 16, v40
    v_and_b32 v13, s85, v13
    v_and_b32 v40, s85, v40
    v_min_f32 v15, 0, v14
    v_min_f32 v42, 0, v41
    v_min_f32 v16, 0, v13
    v_min_f32 v43, 0, v40
    v_mul_f32 v15, s84, v15
    v_mul_f32 v42, s84, v42
    v_mul_f32 v16, s84, v16
    v_mul_f32 v43, s84, v43
    v_exp_f32 v15, v15
    v_exp_f32 v42, v42
    v_exp_f32 v16, v16
    v_exp_f32 v43, v43
    v_max_f32 v14, 0, v14
    v_max_f32 v41, 0, v41
    v_max_f32 v13, 0, v13
    v_max_f32 v40, 0, v40
    v_add_f32 v14, v14, v15
    v_add_f32 v41, v41, v42
    v_add_f32 v13, v13, v16
    v_add_f32 v40, v40, v43
    v_cvt_pk_bf16_f32 v13, v14, v13
    v_cvt_pk_bf16_f32 v40, v41, v40
    v_lshlrev_b32 v14, 16, v13
    v_lshlrev_b32 v41, 16, v40
    v_and_b32 v13, s85, v13
    v_and_b32 v40, s85, v40
    v_add_f32 v14, s86, v14
    v_add_f32 v41, s86, v41
    v_add_f32 v13, s86, v13
    v_add_f32 v40, s86, v40
    v_cvt_pk_bf16_f32 v24, v14, v13
    v_cvt_pk_bf16_f32 v25, v41, v40
    ds_write_b64 v17, v[24:25] offset:128
    v_cvt_pk_bf16_f32 v13, v104, v105
    v_cvt_pk_bf16_f32 v40, v106, v107
    v_lshlrev_b32 v14, 16, v13
    v_lshlrev_b32 v41, 16, v40
    v_and_b32 v13, s85, v13
    v_and_b32 v40, s85, v40
    v_min_f32 v15, 0, v14
    v_min_f32 v42, 0, v41
    v_min_f32 v16, 0, v13
    v_min_f32 v43, 0, v40
    v_mul_f32 v15, s84, v15
    v_mul_f32 v42, s84, v42
    v_mul_f32 v16, s84, v16
    v_mul_f32 v43, s84, v43
    v_exp_f32 v15, v15
    v_exp_f32 v42, v42
    v_exp_f32 v16, v16
    v_exp_f32 v43, v43
    v_max_f32 v14, 0, v14
    v_max_f32 v41, 0, v41
    v_max_f32 v13, 0, v13
    v_max_f32 v40, 0, v40
    v_add_f32 v14, v14, v15
    v_add_f32 v41, v41, v42
    v_add_f32 v13, v13, v16
    v_add_f32 v40, v40, v43
    v_cvt_pk_bf16_f32 v13, v14, v13
    v_cvt_pk_bf16_f32 v40, v41, v40
    v_lshlrev_b32 v14, 16, v13
    v_lshlrev_b32 v41, 16, v40
    v_and_b32 v13, s85, v13
    v_and_b32 v40, s85, v40
    v_add_f32 v14, s86, v14
    v_add_f32 v41, s86, v41
    v_add_f32 v13, s86, v13
    v_add_f32 v40, s86, v40
    v_cvt_pk_bf16_f32 v26, v14, v13
    v_cvt_pk_bf16_f32 v27, v41, v40
    ds_write_b64 v17, v[26:27] offset:2816
    v_cvt_pk_bf16_f32 v13, v108, v109
    v_cvt_pk_bf16_f32 v40, v110, v111
    v_lshlrev_b32 v14, 16, v13
    v_lshlrev_b32 v41, 16, v40
    v_and_b32 v13, s85, v13
    v_and_b32 v40, s85, v40
    v_min_f32 v15, 0, v14
    v_min_f32 v42, 0, v41
    v_min_f32 v16, 0, v13
    v_min_f32 v43, 0, v40
    v_mul_f32 v15, s84, v15
    v_mul_f32 v42, s84, v42
    v_mul_f32 v16, s84, v16
    v_mul_f32 v43, s84, v43
    v_exp_f32 v15, v15
    v_exp_f32 v42, v42
    v_exp_f32 v16, v16
    v_exp_f32 v43, v43
    v_max_f32 v14, 0, v14
    v_max_f32 v41, 0, v41
    v_max_f32 v13, 0, v13
    v_max_f32 v40, 0, v40
    v_add_f32 v14, v14, v15
    v_add_f32 v41, v41, v42
    v_add_f32 v13, v13, v16
    v_add_f32 v40, v40, v43
    v_cvt_pk_bf16_f32 v13, v14, v13
    v_cvt_pk_bf16_f32 v40, v41, v40
    v_lshlrev_b32 v14, 16, v13
    v_lshlrev_b32 v41, 16, v40
    v_and_b32 v13, s85, v13
    v_and_b32 v40, s85, v40
    v_add_f32 v14, s86, v14
    v_add_f32 v41, s86, v41
    v_add_f32 v13, s86, v13
    v_add_f32 v40, s86, v40
    v_cvt_pk_bf16_f32 v28, v14, v13
    v_cvt_pk_bf16_f32 v29, v41, v40
    ds_write_b64 v17, v[28:29] offset:2848
    v_cvt_pk_bf16_f32 v13, v112, v113
    v_cvt_pk_bf16_f32 v40, v114, v115
    v_lshlrev_b32 v14, 16, v13
    v_lshlrev_b32 v41, 16, v40
    v_and_b32 v13, s85, v13
    v_and_b32 v40, s85, v40
    v_min_f32 v15, 0, v14
    v_min_f32 v42, 0, v41
    v_min_f32 v16, 0, v13
    v_min_f32 v43, 0, v40
    v_mul_f32 v15, s84, v15
    v_mul_f32 v42, s84, v42
    v_mul_f32 v16, s84, v16
    v_mul_f32 v43, s84, v43
    v_exp_f32 v15, v15
    v_exp_f32 v42, v42
    v_exp_f32 v16, v16
    v_exp_f32 v43, v43
    v_max_f32 v14, 0, v14
    v_max_f32 v41, 0, v41
    v_max_f32 v13, 0, v13
    v_max_f32 v40, 0, v40
    v_add_f32 v14, v14, v15
    v_add_f32 v41, v41, v42
    v_add_f32 v13, v13, v16
    v_add_f32 v40, v40, v43
    v_cvt_pk_bf16_f32 v13, v14, v13
    v_cvt_pk_bf16_f32 v40, v41, v40
    v_lshlrev_b32 v14, 16, v13
    v_lshlrev_b32 v41, 16, v40
    v_and_b32 v13, s85, v13
    v_and_b32 v40, s85, v40
    v_add_f32 v14, s86, v14
    v_add_f32 v41, s86, v41
    v_add_f32 v13, s86, v13
    v_add_f32 v40, s86, v40
    v_cvt_pk_bf16_f32 v30, v14, v13
    v_cvt_pk_bf16_f32 v31, v41, v40
    ds_write_b64 v17, v[30:31] offset:2880
    v_cvt_pk_bf16_f32 v13, v116, v117
    v_cvt_pk_bf16_f32 v40, v118, v119
    v_lshlrev_b32 v14, 16, v13
    v_lshlrev_b32 v41, 16, v40
    v_and_b32 v13, s85, v13
    v_and_b32 v40, s85, v40
    v_min_f32 v15, 0, v14
    v_min_f32 v42, 0, v41
    v_min_f32 v16, 0, v13
    v_min_f32 v43, 0, v40
    v_mul_f32 v15, s84, v15
    v_mul_f32 v42, s84, v42
    v_mul_f32 v16, s84, v16
    v_mul_f32 v43, s84, v43
    v_exp_f32 v15, v15
    v_exp_f32 v42, v42
    v_exp_f32 v16, v16
    v_exp_f32 v43, v43
    v_max_f32 v14, 0, v14
    v_max_f32 v41, 0, v41
    v_max_f32 v13, 0, v13
    v_max_f32 v40, 0, v40
    v_add_f32 v14, v14, v15
    v_add_f32 v41, v41, v42
    v_add_f32 v13, v13, v16
    v_add_f32 v40, v40, v43
    v_cvt_pk_bf16_f32 v13, v14, v13
    v_cvt_pk_bf16_f32 v40, v41, v40
    v_lshlrev_b32 v14, 16, v13
    v_lshlrev_b32 v41, 16, v40
    v_and_b32 v13, s85, v13
    v_and_b32 v40, s85, v40
    v_add_f32 v14, s86, v14
    v_add_f32 v41, s86, v41
    v_add_f32 v13, s86, v13
    v_add_f32 v40, s86, v40
    v_cvt_pk_bf16_f32 v24, v14, v13
    v_cvt_pk_bf16_f32 v25, v41, v40
    ds_write_b64 v17, v[24:25] offset:2912
    v_cvt_pk_bf16_f32 v13, v120, v121
    v_cvt_pk_bf16_f32 v40, v122, v123
    v_lshlrev_b32 v14, 16, v13
    v_lshlrev_b32 v41, 16, v40
    v_and_b32 v13, s85, v13
    v_and_b32 v40, s85, v40
    v_min_f32 v15, 0, v14
    v_min_f32 v42, 0, v41
    v_min_f32 v16, 0, v13
    v_min_f32 v43, 0, v40
    v_mul_f32 v15, s84, v15
    v_mul_f32 v42, s84, v42
    v_mul_f32 v16, s84, v16
    v_mul_f32 v43, s84, v43
    v_exp_f32 v15, v15
    v_exp_f32 v42, v42
    v_exp_f32 v16, v16
    v_exp_f32 v43, v43
    v_max_f32 v14, 0, v14
    v_max_f32 v41, 0, v41
    v_max_f32 v13, 0, v13
    v_max_f32 v40, 0, v40
    v_add_f32 v14, v14, v15
    v_add_f32 v41, v41, v42
    v_add_f32 v13, v13, v16
    v_add_f32 v40, v40, v43
    v_cvt_pk_bf16_f32 v13, v14, v13
    v_cvt_pk_bf16_f32 v40, v41, v40
    v_lshlrev_b32 v14, 16, v13
    v_lshlrev_b32 v41, 16, v40
    v_and_b32 v13, s85, v13
    v_and_b32 v40, s85, v40
    v_add_f32 v14, s86, v14
    v_add_f32 v41, s86, v41
    v_add_f32 v13, s86, v13
    v_add_f32 v40, s86, v40
    v_cvt_pk_bf16_f32 v26, v14, v13
    v_cvt_pk_bf16_f32 v27, v41, v40
    ds_write_b64 v17, v[26:27] offset:2944
    s_lshl_b32 s4, s10, 3
    s_lshl_b32 s5, s88, 1
    s_add_u32 s4, s4, s5
    s_lshl_b32 s4, s4, 5
    s_lshl_b32 s5, s14, 3
    s_add_u32 s4, s4, s5
    s_lshl_b32 s5, s89, 2
    s_add_u32 s4, s4, s5
    s_lshl_b32 s4, s4, 10
    v_lshlrev_b32 v19, 4, v1
    v_cmp_gt_u32 s[6:7], 2, v2
    v_cmp_gt_u32 s[92:93], 3, v2
    s_waitcnt lgkmcnt(0)
    ds_read_b64 v[84:85], v18 offset:0
    ds_read_b64 v[86:87], v18 offset:8
    ds_read_b64 v[88:89], v18 offset:40
    ds_read_b64 v[90:91], v18 offset:48
    ds_read_b64 v[92:93], v18 offset:80
    ds_read_b64 v[94:95], v18 offset:88
    ds_read_b64 v[96:97], v18 offset:120
    ds_read_b64 v[98:99], v18 offset:128
    ds_read_b64 v[100:101], v18 offset:2816
    ds_read_b64 v[102:103], v18 offset:2824
    ds_read_b64 v[104:105], v18 offset:2856
    ds_read_b64 v[106:107], v18 offset:2864
    ds_read_b64 v[108:109], v18 offset:2896
    ds_read_b64 v[110:111], v18 offset:2904
    ds_read_b64 v[112:113], v18 offset:2936
    ds_read_b64 v[114:115], v18 offset:2944
    s_waitcnt lgkmcnt(14)
    v_cndmask_b32 v84, 0, v84, s[92:93]
    v_cndmask_b32 v85, 0, v85, s[92:93]
    v_cndmask_b32 v86, 0, v86, s[6:7]
    v_cndmask_b32 v87, 0, v87, s[6:7]
    s_add_u32 s5, s4, 0
    buffer_store_dwordx4 v[84:87], v19, s[52:55], s5 offen offset:0 sc1
    s_waitcnt lgkmcnt(12)
    v_cndmask_b32 v88, 0, v88, s[92:93]
    v_cndmask_b32 v89, 0, v89, s[92:93]
    v_cndmask_b32 v90, 0, v90, s[6:7]
    v_cndmask_b32 v91, 0, v91, s[6:7]
    s_add_u32 s5, s4, 0
    buffer_store_dwordx4 v[88:91], v19, s[52:55], s5 offen offset:1024 sc1
    s_waitcnt lgkmcnt(10)
    v_cndmask_b32 v92, 0, v92, s[92:93]
    v_cndmask_b32 v93, 0, v93, s[92:93]
    v_cndmask_b32 v94, 0, v94, s[6:7]
    v_cndmask_b32 v95, 0, v95, s[6:7]
    s_add_u32 s5, s4, 0
    buffer_store_dwordx4 v[92:95], v19, s[52:55], s5 offen offset:2048 sc1
    s_waitcnt lgkmcnt(8)
    v_cndmask_b32 v96, 0, v96, s[92:93]
    v_cndmask_b32 v97, 0, v97, s[92:93]
    v_cndmask_b32 v98, 0, v98, s[6:7]
    v_cndmask_b32 v99, 0, v99, s[6:7]
    s_add_u32 s5, s4, 0
    buffer_store_dwordx4 v[96:99], v19, s[52:55], s5 offen offset:3072 sc1
    s_waitcnt lgkmcnt(6)
    v_cndmask_b32 v100, 0, v100, s[92:93]
    v_cndmask_b32 v101, 0, v101, s[92:93]
    v_cndmask_b32 v102, 0, v102, s[6:7]
    v_cndmask_b32 v103, 0, v103, s[6:7]
    s_add_u32 s5, s4, 32768
    buffer_store_dwordx4 v[100:103], v19, s[52:55], s5 offen offset:0 sc1
    s_waitcnt lgkmcnt(4)
    v_cndmask_b32 v104, 0, v104, s[92:93]
    v_cndmask_b32 v105, 0, v105, s[92:93]
    v_cndmask_b32 v106, 0, v106, s[6:7]
    v_cndmask_b32 v107, 0, v107, s[6:7]
    s_add_u32 s5, s4, 32768
    buffer_store_dwordx4 v[104:107], v19, s[52:55], s5 offen offset:1024 sc1
    s_waitcnt lgkmcnt(2)
    v_cndmask_b32 v108, 0, v108, s[92:93]
    v_cndmask_b32 v109, 0, v109, s[92:93]
    v_cndmask_b32 v110, 0, v110, s[6:7]
    v_cndmask_b32 v111, 0, v111, s[6:7]
    s_add_u32 s5, s4, 32768
    buffer_store_dwordx4 v[108:111], v19, s[52:55], s5 offen offset:2048 sc1
    s_waitcnt lgkmcnt(0)
    v_cndmask_b32 v112, 0, v112, s[92:93]
    v_cndmask_b32 v113, 0, v113, s[92:93]
    v_cndmask_b32 v114, 0, v114, s[6:7]
    v_cndmask_b32 v115, 0, v115, s[6:7]
    s_add_u32 s5, s4, 32768
    buffer_store_dwordx4 v[112:115], v19, s[52:55], s5 offen offset:3072 sc1
    s_mov_b32 s60, s38
    s_and_b32 s61, s39, 0xffff
    s_mov_b32 s62, 256
    s_mov_b32 s63, 0x00020000
    s_waitcnt vmcnt(0)
    s_barrier
    s_cmp_lg_u32 s3, 0
    s_cbranch_scc1 SIG_Q
    s_mov_b64 exec, 1
    v_mov_b32 v13, 1
    s_lshl_b32 s5, s10, 2
    s_add_u32 s5, s5, 128
    v_mov_b32 v14, s5
    buffer_atomic_add v13, v14, s[60:63], 0 offen sc1
    s_mov_b64 exec, -1
SIG_Q:
    s_endpgm
K1_KGEN:
    s_and_b32 s88, s3, 3
    s_lshr_b32 s89, s3, 2
    s_sub_u32 s9, s2, 192
    s_and_b32 s4, s9, 7
    s_mul_i32 s4, s4, 20
    s_lshr_b32 s12, s9, 3
    s_add_u32 s12, s12, s4
    s_lshl_b32 s4, s12, 2
    s_add_u32 s14, s4, s88
    s_mov_b32 s64, s24
    s_and_b32 s65, s25, 0xffff
    s_mov_b32 s66, 245760
    s_mov_b32 s67, 0x00020000
    s_mov_b32 s68, s26
    s_and_b32 s69, s27, 0xffff
    s_mov_b32 s70, 245760
    s_mov_b32 s71, 0x00020000
    s_mov_b32 s72, s28
    s_and_b32 s73, s29, 0xffff
    s_mov_b32 s74, 245760
    s_mov_b32 s75, 0x00020000
    s_mov_b32 s76, s30
    s_and_b32 s77, s31, 0xffff
    s_mov_b32 s78, 245760
    s_mov_b32 s79, 0x00020000
    s_mov_b32 s80, s32
    s_and_b32 s81, s33, 0xffff
    s_mov_b32 s82, 1280
    s_mov_b32 s83, 0x00020000
    s_mul_i32 s4, s14, 384
    s_lshl_b32 s5, s14, 1
    v_lshlrev_b32 v4, 1, v1
    v_mov_b32 v5, s5
    buffer_load_ushort v8, v4, s[64:67], s4 offen offset:0
    buffer_load_ushort v9, v4, s[68:71], s4 offen offset:0
    buffer_load_ushort v10, v4, s[72:75], s4 offen offset:0
    buffer_load_ushort v11, v4, s[76:79], s4 offen offset:0
    buffer_load_ushort v12, v4, s[64:67], s4 offen offset:128
    buffer_load_ushort v13, v4, s[68:71], s4 offen offset:128
    buffer_load_ushort v14, v4, s[72:75], s4 offen offset:128
    buffer_load_ushort v15, v4, s[76:79], s4 offen offset:128
    buffer_load_ushort v16, v4, s[64:67], s4 offen offset:256
    buffer_load_ushort v17, v4, s[68:71], s4 offen offset:256
    buffer_load_ushort v18, v4, s[72:75], s4 offen offset:256
    buffer_load_ushort v19, v4, s[76:79], s4 offen offset:256
    buffer_load_ushort v6, v5, s[80:83], 0 offen
    s_mov_b32 s44, s22
    s_and_b32 s45, s23, 0xffff
    s_mov_b32 s46, 2621440
    s_mov_b32 s47, 0x00020000
    s_add_u32 s48, s40, 9437184
    s_addc_u32 s49, s41, 0
    s_and_b32 s49, s49, 0xffff
    s_mov_b32 s50, 2621440
    s_mov_b32 s51, 0x00020000
    s_mul_i32 s4, s9, 5
    s_add_u32 s4, s4, s3
    s_cmp_lt_u32 s9, 64
    s_cselect_b32 s101, s3, 99
    s_and_b32 s10, s4, 31
    s_lshr_b32 s11, s4, 5
    v_lshrrev_b32 v22, 3, v1
    v_and_b32 v23, 7, v1
    s_lshl_b32 s4, s10, 6
    v_lshl_add_u32 v24, v23, 3, s4
    s_movk_i32 s5, 1280
    v_mul_u32_u24 v24, s5, v24
    v_lshl_add_u32 v24, v22, 4, v24
    s_lshl_b32 s4, s11, 7
    v_add_u32 v24, s4, v24
    v_add_u32 v25, 5120, v24
    s_lshl_b32 s4, s11, 18
    s_lshl_b32 s5, s10, 7
    s_add_u32 s4, s4, s5
    v_lshlrev_b32 v124, 15, v22
    v_lshl_add_u32 v124, v23, 4, v124
    v_add_u32 v124, s4, v124
    s_mov_b32 s60, s38
    s_and_b32 s61, s39, 0xffff
    s_mov_b32 s62, 256
    s_mov_b32 s63, 0x00020000
    s_cmp_ge_u32 s101, 5
    s_cbranch_scc1 KG_NOU1
    buffer_load_dwordx4 v[92:95], v24, s[44:47], 0 offen offset:0
    buffer_load_dwordx4 v[96:99], v24, s[44:47], 0 offen offset:1280
    buffer_load_dwordx4 v[100:103], v24, s[44:47], 0 offen offset:2560
    buffer_load_dwordx4 v[104:107], v24, s[44:47], 0 offen offset:3840
    buffer_load_dwordx4 v[108:111], v25, s[44:47], 0 offen offset:0
    buffer_load_dwordx4 v[112:115], v25, s[44:47], 0 offen offset:1280
    buffer_load_dwordx4 v[116:119], v25, s[44:47], 0 offen offset:2560
    buffer_load_dwordx4 v[120:123], v25, s[44:47], 0 offen offset:3840
KG_NOU1:
    s_mul_i32 s15, s88, 15504
    s_mov_b32 s87, 0x3e22f983
    s_mov_b32 m0, s15
    v_lshlrev_b32 v20, 2, v1
    v_add_u32 v20, s15, v20
    v_and_b32 v21, 31, v1
    s_movk_i32 s5, 272
    v_mul_u32_u24 v21, s5, v21
    v_lshrrev_b32 v22, 5, v1
    v_lshl_add_u32 v21, v22, 4, v21
    s_lshl_b32 s5, s89, 7
    s_add_u32 s5, s5, s15
    v_add_u32 v21, s5, v21
    s_waitcnt vmcnt(8)
    s_cmp_lt_u32 s101, 5
    s_cbranch_scc1 KG_W1
    s_waitcnt vmcnt(0)
KG_W1:
    v_lshlrev_b32 v6, 16, v6
    v_mul_f32 v6, s84, v6
    v_exp_f32 v6, v6
    s_nop 0
    v_cvt_pk_bf16_f32 v6, v6, v6
    v_lshlrev_b32 v7, 16, v6
    v_lshlrev_b32 v8, 16, v8
    v_mul_f32 v8, s84, v8
    v_exp_f32 v8, v8
    v_lshlrev_b32 v9, 16, v9
    v_lshlrev_b32 v10, 16, v10
    v_lshlrev_b32 v11, 16, v11
    v_cvt_pk_bf16_f32 v8, v8, v8
    v_lshlrev_b32 v8, 16, v8
    v_mul_f32 v24, v8, -v7
    v_mul_f32 v25, v9, v7
    v_mul_f32 v24, s84, v24
    v_mul_f32 v25, s87, v25
    s_cmp_lg_u32 s89, 0
    s_cbranch_scc1 KG_ROWS0
    v_mov_b32 v66, 8.0
    v_mov_b32 v74, 64.0
    v_mov_b32 v82, 128.0
    v_mov_b32 v90, 192.0
    v_mul_f32 v64, v66, v24
    v_mul_f32 v72, v74, v24
    v_mul_f32 v80, v82, v24
    v_mul_f32 v88, v90, v24
    v_mul_f32 v65, v66, v25
    v_mul_f32 v73, v74, v25
    v_mul_f32 v81, v82, v25
    v_mul_f32 v89, v90, v25
    v_exp_f32 v64, v64
    v_exp_f32 v72, v72
    v_exp_f32 v80, v80
    v_exp_f32 v88, v88
    v_fract_f32 v65, v65
    v_fract_f32 v73, v73
    v_fract_f32 v81, v81
    v_fract_f32 v89, v89
    s_nop 0
    s_nop 0
    s_nop 0
    s_nop 0
    v_cos_f32 v66, v65
    v_cos_f32 v74, v73
    v_cos_f32 v82, v81
    v_cos_f32 v90, v89
    v_sin_f32 v67, v65
    v_sin_f32 v75, v73
    v_sin_f32 v83, v81
    v_sin_f32 v91, v89
    s_nop 0
    s_nop 0
    s_nop 0
    s_nop 0
    v_mul_f32 v34, v64, v66
    v_mul_f32 v68, v72, v74
    v_mul_f32 v76, v80, v82
    v_mul_f32 v84, v88, v90
    v_mul_f32 v35, v64, -v67
    v_mul_f32 v69, v72, -v75
    v_mul_f32 v77, v80, -v83
    v_mul_f32 v85, v88, -v91
    v_mov_b32 v60, 1.0
    v_mov_b32 v61, 0
    v_cvt_pk_bf16_f32 v66, v60, v61
    v_cvt_pk_bf16_f32 v74, v68, v69
    v_cvt_pk_bf16_f32 v82, v76, v77
    v_cvt_pk_bf16_f32 v90, v84, v85
    ds_write_addtid_b32 v66 offset:6800
    ds_write_addtid_b32 v74 offset:8976
    ds_write_addtid_b32 v82 offset:11152
    ds_write_addtid_b32 v90 offset:13328
    v_pk_mul_f32 v[64:65], v[60:61], v[34:35] op_sel:[1,1] op_sel_hi:[1,0] neg_lo:[0,1]
    v_pk_mul_f32 v[72:73], v[68:69], v[34:35] op_sel:[1,1] op_sel_hi:[1,0] neg_lo:[0,1]
    v_pk_mul_f32 v[80:81], v[76:77], v[34:35] op_sel:[1,1] op_sel_hi:[1,0] neg_lo:[0,1]
    v_pk_mul_f32 v[88:89], v[84:85], v[34:35] op_sel:[1,1] op_sel_hi:[1,0] neg_lo:[0,1]
    v_pk_fma_f32 v[62:63], v[60:61], v[34:35], v[64:65] op_sel:[0,0,0] op_sel_hi:[0,1,1]
    v_pk_fma_f32 v[70:71], v[68:69], v[34:35], v[72:73] op_sel:[0,0,0] op_sel_hi:[0,1,1]
    v_pk_fma_f32 v[78:79], v[76:77], v[34:35], v[80:81] op_sel:[0,0,0] op_sel_hi:[0,1,1]
    v_pk_fma_f32 v[86:87], v[84:85], v[34:35], v[88:89] op_sel:[0,0,0] op_sel_hi:[0,1,1]
    v_cvt_pk_bf16_f32 v66, v62, v63
    v_cvt_pk_bf16_f32 v74, v70, v71
    v_cvt_pk_bf16_f32 v82, v78, v79
    v_cvt_pk_bf16_f32 v90, v86, v87
    ds_write_addtid_b32 v66 offset:7072
    ds_write_addtid_b32 v74 offset:9248
    ds_write_addtid_b32 v82 offset:11424
    ds_write_addtid_b32 v90 offset:13600
    v_pk_mul_f32 v[64:65], v[62:63], v[34:35] op_sel:[1,1] op_sel_hi:[1,0] neg_lo:[0,1]
    v_pk_mul_f32 v[72:73], v[70:71], v[34:35] op_sel:[1,1] op_sel_hi:[1,0] neg_lo:[0,1]
    v_pk_mul_f32 v[80:81], v[78:79], v[34:35] op_sel:[1,1] op_sel_hi:[1,0] neg_lo:[0,1]
    v_pk_mul_f32 v[88:89], v[86:87], v[34:35] op_sel:[1,1] op_sel_hi:[1,0] neg_lo:[0,1]
    v_pk_fma_f32 v[60:61], v[62:63], v[34:35], v[64:65] op_sel:[0,0,0] op_sel_hi:[0,1,1]
    v_pk_fma_f32 v[68:69], v[70:71], v[34:35], v[72:73] op_sel:[0,0,0] op_sel_hi:[0,1,1]
    v_pk_fma_f32 v[76:77], v[78:79], v[34:35], v[80:81] op_sel:[0,0,0] op_sel_hi:[0,1,1]
    v_pk_fma_f32 v[84:85], v[86:87], v[34:35], v[88:89] op_sel:[0,0,0] op_sel_hi:[0,1,1]
    v_cvt_pk_bf16_f32 v66, v60, v61
    v_cvt_pk_bf16_f32 v74, v68, v69
    v_cvt_pk_bf16_f32 v82, v76, v77
    v_cvt_pk_bf16_f32 v90, v84, v85
    ds_write_addtid_b32 v66 offset:7344
    ds_write_addtid_b32 v74 offset:9520
    ds_write_addtid_b32 v82 offset:11696
    ds_write_addtid_b32 v90 offset:13872
    v_pk_mul_f32 v[64:65], v[60:61], v[34:35] op_sel:[1,1] op_sel_hi:[1,0] neg_lo:[0,1]
    v_pk_mul_f32 v[72:73], v[68:69], v[34:35] op_sel:[1,1] op_sel_hi:[1,0] neg_lo:[0,1]
    v_pk_mul_f32 v[80:81], v[76:77], v[34:35] op_sel:[1,1] op_sel_hi:[1,0] neg_lo:[0,1]
    v_pk_mul_f32 v[88:89], v[84:85], v[34:35] op_sel:[1,1] op_sel_hi:[1,0] neg_lo:[0,1]
    v_pk_fma_f32 v[62:63], v[60:61], v[34:35], v[64:65] op_sel:[0,0,0] op_sel_hi:[0,1,1]
    v_pk_fma_f32 v[70:71], v[68:69], v[34:35], v[72:73] op_sel:[0,0,0] op_sel_hi:[0,1,1]
    v_pk_fma_f32 v[78:79], v[76:77], v[34:35], v[80:81] op_sel:[0,0,0] op_sel_hi:[0,1,1]
    v_pk_fma_f32 v[86:87], v[84:85], v[34:35], v[88:89] op_sel:[0,0,0] op_sel_hi:[0,1,1]
    v_cvt_pk_bf16_f32 v66, v62, v63
    v_cvt_pk_bf16_f32 v74, v70, v71
    v_cvt_pk_bf16_f32 v82, v78, v79
    v_cvt_pk_bf16_f32 v90, v86, v87
    ds_write_addtid_b32 v66 offset:7616
    ds_write_addtid_b32 v74 offset:9792
    ds_write_addtid_b32 v82 offset:11968
    ds_write_addtid_b32 v90 offset:14144
    v_pk_mul_f32 v[64:65], v[62:63], v[34:35] op_sel:[1,1] op_sel_hi:[1,0] neg_lo:[0,1]
    v_pk_mul_f32 v[72:73], v[70:71], v[34:35] op_sel:[1,1] op_sel_hi:[1,0] neg_lo:[0,1]
    v_pk_mul_f32 v[80:81], v[78:79], v[34:35] op_sel:[1,1] op_sel_hi:[1,0] neg_lo:[0,1]
    v_pk_mul_f32 v[88:89], v[86:87], v[34:35] op_sel:[1,1] op_sel_hi:[1,0] neg_lo:[0,1]
    v_pk_fma_f32 v[60:61], v[62:63], v[34:35], v[64:65] op_sel:[0,0,0] op_sel_hi:[0,1,1]
    v_pk_fma_f32 v[68:69], v[70:71], v[34:35], v[72:73] op_sel:[0,0,0] op_sel_hi:[0,1,1]
    v_pk_fma_f32 v[76:77], v[78:79], v[34:35], v[80:81] op_sel:[0,0,0] op_sel_hi:[0,1,1]
    v_pk_fma_f32 v[84:85], v[86:87], v[34:35], v[88:89] op_sel:[0,0,0] op_sel_hi:[0,1,1]
    v_cvt_pk_bf16_f32 v66, v60, v61
    v_cvt_pk_bf16_f32 v74, v68, v69
    v_cvt_pk_bf16_f32 v82, v76, v77
    v_cvt_pk_bf16_f32 v90, v84, v85
    ds_write_addtid_b32 v66 offset:7888
    ds_write_addtid_b32 v74 offset:10064
    ds_write_addtid_b32 v82 offset:12240
    ds_write_addtid_b32 v90 offset:14416
    v_pk_mul_f32 v[64:65], v[60:61], v[34:35] op_sel:[1,1] op_sel_hi:[1,0] neg_lo:[0,1]
    v_pk_mul_f32 v[72:73], v[68:69], v[34:35] op_sel:[1,1] op_sel_hi:[1,0] neg_lo:[0,1]
    v_pk_mul_f32 v[80:81], v[76:77], v[34:35] op_sel:[1,1] op_sel_hi:[1,0] neg_lo:[0,1]
    v_pk_mul_f32 v[88:89], v[84:85], v[34:35] op_sel:[1,1] op_sel_hi:[1,0] neg_lo:[0,1]
    v_pk_fma_f32 v[62:63], v[60:61], v[34:35], v[64:65] op_sel:[0,0,0] op_sel_hi:[0,1,1]
    v_pk_fma_f32 v[70:71], v[68:69], v[34:35], v[72:73] op_sel:[0,0,0] op_sel_hi:[0,1,1]
    v_pk_fma_f32 v[78:79], v[76:77], v[34:35], v[80:81] op_sel:[0,0,0] op_sel_hi:[0,1,1]
    v_pk_fma_f32 v[86:87], v[84:85], v[34:35], v[88:89] op_sel:[0,0,0] op_sel_hi:[0,1,1]
    v_cvt_pk_bf16_f32 v66, v62, v63
    v_cvt_pk_bf16_f32 v74, v70, v71
    v_cvt_pk_bf16_f32 v82, v78, v79
    v_cvt_pk_bf16_f32 v90, v86, v87
    ds_write_addtid_b32 v66 offset:8160
    ds_write_addtid_b32 v74 offset:10336
    ds_write_addtid_b32 v82 offset:12512
    ds_write_addtid_b32 v90 offset:14688
    v_pk_mul_f32 v[64:65], v[62:63], v[34:35] op_sel:[1,1] op_sel_hi:[1,0] neg_lo:[0,1]
    v_pk_mul_f32 v[72:73], v[70:71], v[34:35] op_sel:[1,1] op_sel_hi:[1,0] neg_lo:[0,1]
    v_pk_mul_f32 v[80:81], v[78:79], v[34:35] op_sel:[1,1] op_sel_hi:[1,0] neg_lo:[0,1]
    v_pk_mul_f32 v[88:89], v[86:87], v[34:35] op_sel:[1,1] op_sel_hi:[1,0] neg_lo:[0,1]
    v_pk_fma_f32 v[60:61], v[62:63], v[34:35], v[64:65] op_sel:[0,0,0] op_sel_hi:[0,1,1]
    v_pk_fma_f32 v[68:69], v[70:71], v[34:35], v[72:73] op_sel:[0,0,0] op_sel_hi:[0,1,1]
    v_pk_fma_f32 v[76:77], v[78:79], v[34:35], v[80:81] op_sel:[0,0,0] op_sel_hi:[0,1,1]
    v_pk_fma_f32 v[84:85], v[86:87], v[34:35], v[88:89] op_sel:[0,0,0] op_sel_hi:[0,1,1]
    v_cvt_pk_bf16_f32 v66, v60, v61
    v_cvt_pk_bf16_f32 v74, v68, v69
    v_cvt_pk_bf16_f32 v82, v76, v77
    v_cvt_pk_bf16_f32 v90, v84, v85
    ds_write_addtid_b32 v66 offset:8432
    ds_write_addtid_b32 v74 offset:10608
    ds_write_addtid_b32 v82 offset:12784
    ds_write_addtid_b32 v90 offset:14960
    v_pk_mul_f32 v[64:65], v[60:61], v[34:35] op_sel:[1,1] op_sel_hi:[1,0] neg_lo:[0,1]
    v_pk_mul_f32 v[72:73], v[68:69], v[34:35] op_sel:[1,1] op_sel_hi:[1,0] neg_lo:[0,1]
    v_pk_mul_f32 v[80:81], v[76:77], v[34:35] op_sel:[1,1] op_sel_hi:[1,0] neg_lo:[0,1]
    v_pk_mul_f32 v[88:89], v[84:85], v[34:35] op_sel:[1,1] op_sel_hi:[1,0] neg_lo:[0,1]
    v_pk_fma_f32 v[62:63], v[60:61], v[34:35], v[64:65] op_sel:[0,0,0] op_sel_hi:[0,1,1]
    v_pk_fma_f32 v[70:71], v[68:69], v[34:35], v[72:73] op_sel:[0,0,0] op_sel_hi:[0,1,1]
    v_pk_fma_f32 v[78:79], v[76:77], v[34:35], v[80:81] op_sel:[0,0,0] op_sel_hi:[0,1,1]
    v_pk_fma_f32 v[86:87], v[84:85], v[34:35], v[88:89] op_sel:[0,0,0] op_sel_hi:[0,1,1]
    v_cvt_pk_bf16_f32 v66, v62, v63
    v_cvt_pk_bf16_f32 v74, v70, v71
    v_cvt_pk_bf16_f32 v82, v78, v79
    v_cvt_pk_bf16_f32 v90, v86, v87
    ds_write_addtid_b32 v66 offset:8704
    ds_write_addtid_b32 v74 offset:10880
    ds_write_addtid_b32 v82 offset:13056
    ds_write_addtid_b32 v90 offset:15232
    s_branch KG_JOIN0
KG_ROWS0:
    v_mul_f32 v26, v10, v7
    v_mul_f32 v27, v11, v7
    v_add_f32 v26, v26, v26
    v_add_f32 v27, v27, v27
    v_exp_f32 v64, v24
    v_mov_b32 v74, 4.0
    v_mov_b32 v82, 256.0
    v_mov_b32 v90, 512.0
    v_fract_f32 v65, v25
    v_mul_f32 v72, v74, v24
    v_mul_f32 v80, v82, v24
    v_mul_f32 v88, v90, v24
    s_nop 0
    v_mul_f32 v73, v74, v25
    v_mul_f32 v81, v82, v25
    v_mul_f32 v89, v90, v25
    v_cos_f32 v66, v65
    v_exp_f32 v72, v72
    v_exp_f32 v80, v80
    v_exp_f32 v88, v88
    v_sin_f32 v67, v65
    v_fract_f32 v73, v73
    v_fract_f32 v81, v81
    v_fract_f32 v89, v89
    s_nop 0
    s_nop 0
    s_nop 0
    s_nop 0
    v_mul_f32 v28, v64, v66
    v_cos_f32 v74, v73
    v_cos_f32 v82, v81
    v_cos_f32 v90, v89
    v_mul_f32 v29, v64, v67
    v_sin_f32 v75, v73
    v_sin_f32 v83, v81
    v_sin_f32 v91, v89
    v_pk_mul_f32 v[64:65], v[28:29], v[28:29] op_sel:[1,1] op_sel_hi:[1,0] neg_lo:[0,1]
    s_nop 0
    s_nop 0
    s_nop 0
    v_pk_fma_f32 v[30:31], v[28:29], v[28:29], v[64:65] op_sel:[0,0,0] op_sel_hi:[0,1,1]
    v_mul_f32 v32, v72, v74
    v_mul_f32 v36, v80, v82
    v_mul_f32 v40, v88, v90
    v_mul_f32 v33, v72, v75
    v_mul_f32 v37, v80, v83
    v_mul_f32 v41, v88, v91
    v_pk_mul_f32 v[88:89], v[40:41], v[40:41] op_sel:[1,1] op_sel_hi:[1,0] neg_lo:[0,1]
    v_pk_fma_f32 v[42:43], v[40:41], v[40:41], v[88:89] op_sel:[0,0,0] op_sel_hi:[0,1,1]
    v_cvt_pk_bf16_f32 v66, v26, v27
    v_pk_mul_f32 v[72:73], v[26:27], v[32:33] op_sel:[1,1] op_sel_hi:[1,0] neg_lo:[0,1]
    v_pk_mul_f32 v[80:81], v[26:27], v[36:37] op_sel:[1,1] op_sel_hi:[1,0] neg_lo:[0,1]
    v_pk_mul_f32 v[88:89], v[26:27], v[40:41] op_sel:[1,1] op_sel_hi:[1,0] neg_lo:[0,1]
    ds_write_addtid_b32 v66 offset:0
    v_pk_fma_f32 v[68:69], v[26:27], v[32:33], v[72:73] op_sel:[0,0,0] op_sel_hi:[0,1,1]
    v_pk_fma_f32 v[76:77], v[26:27], v[36:37], v[80:81] op_sel:[0,0,0] op_sel_hi:[0,1,1]
    v_pk_fma_f32 v[84:85], v[26:27], v[40:41], v[88:89] op_sel:[0,0,0] op_sel_hi:[0,1,1]
    v_pk_mul_f32 v[64:65], v[26:27], v[28:29] op_sel:[1,1] op_sel_hi:[1,0] neg_lo:[0,1]
    v_cvt_pk_bf16_f32 v74, v68, v69
    v_cvt_pk_bf16_f32 v82, v76, v77
    v_cvt_pk_bf16_f32 v90, v84, v85
    v_pk_fma_f32 v[60:61], v[26:27], v[28:29], v[64:65] op_sel:[0,0,0] op_sel_hi:[0,1,1]
    ds_write_addtid_b32 v74 offset:1088
    ds_write_addtid_b32 v82 offset:2176
    ds_write_addtid_b32 v90 offset:2720
    v_cvt_pk_bf16_f32 v66, v60, v61
    v_pk_mul_f32 v[72:73], v[68:69], v[28:29] op_sel:[1,1] op_sel_hi:[1,0] neg_lo:[0,1]
    v_pk_mul_f32 v[80:81], v[76:77], v[30:31] op_sel:[1,1] op_sel_hi:[1,0] neg_lo:[0,1]
    v_pk_mul_f32 v[88:89], v[84:85], v[32:33] op_sel:[1,1] op_sel_hi:[1,0] neg_lo:[0,1]
    ds_write_addtid_b32 v66 offset:272
    v_pk_fma_f32 v[70:71], v[68:69], v[28:29], v[72:73] op_sel:[0,0,0] op_sel_hi:[0,1,1]
    v_pk_fma_f32 v[78:79], v[76:77], v[30:31], v[80:81] op_sel:[0,0,0] op_sel_hi:[0,1,1]
    v_pk_fma_f32 v[86:87], v[84:85], v[32:33], v[88:89] op_sel:[0,0,0] op_sel_hi:[0,1,1]
    v_pk_mul_f32 v[64:65], v[60:61], v[28:29] op_sel:[1,1] op_sel_hi:[1,0] neg_lo:[0,1]
    v_cvt_pk_bf16_f32 v74, v70, v71
    v_cvt_pk_bf16_f32 v82, v78, v79
    v_cvt_pk_bf16_f32 v90, v86, v87
    v_pk_fma_f32 v[62:63], v[60:61], v[28:29], v[64:65] op_sel:[0,0,0] op_sel_hi:[0,1,1]
    ds_write_addtid_b32 v74 offset:1360
    ds_write_addtid_b32 v82 offset:2448
    ds_write_addtid_b32 v90 offset:3808
    v_cvt_pk_bf16_f32 v66, v62, v63
    v_pk_mul_f32 v[72:73], v[70:71], v[28:29] op_sel:[1,1] op_sel_hi:[1,0] neg_lo:[0,1]
    v_pk_mul_f32 v[80:81], v[78:79], v[30:31] op_sel:[1,1] op_sel_hi:[1,0] neg_lo:[0,1]
    v_pk_mul_f32 v[88:89], v[84:85], v[36:37] op_sel:[1,1] op_sel_hi:[1,0] neg_lo:[0,1]
    ds_write_addtid_b32 v66 offset:544
    v_pk_fma_f32 v[68:69], v[70:71], v[28:29], v[72:73] op_sel:[0,0,0] op_sel_hi:[0,1,1]
    v_pk_fma_f32 v[76:77], v[78:79], v[30:31], v[80:81] op_sel:[0,0,0] op_sel_hi:[0,1,1]
    v_pk_fma_f32 v[86:87], v[84:85], v[36:37], v[88:89] op_sel:[0,0,0] op_sel_hi:[0,1,1]
    v_pk_mul_f32 v[64:65], v[62:63], v[28:29] op_sel:[1,1] op_sel_hi:[1,0] neg_lo:[0,1]
    v_cvt_pk_bf16_f32 v74, v68, v69
    v_cvt_pk_bf16_f32 v82, v76, v77
    v_cvt_pk_bf16_f32 v90, v86, v87
    v_pk_fma_f32 v[60:61], v[62:63], v[28:29], v[64:65] op_sel:[0,0,0] op_sel_hi:[0,1,1]
    ds_write_addtid_b32 v74 offset:1632
    ds_write_addtid_b32 v82 offset:3264
    ds_write_addtid_b32 v90 offset:2992
    v_cvt_pk_bf16_f32 v66, v60, v61
    v_pk_mul_f32 v[72:73], v[68:69], v[28:29] op_sel:[1,1] op_sel_hi:[1,0] neg_lo:[0,1]
    v_pk_mul_f32 v[80:81], v[76:77], v[30:31] op_sel:[1,1] op_sel_hi:[1,0] neg_lo:[0,1]
    v_pk_mul_f32 v[88:89], v[86:87], v[32:33] op_sel:[1,1] op_sel_hi:[1,0] neg_lo:[0,1]
    ds_write_addtid_b32 v66 offset:816
    v_pk_fma_f32 v[70:71], v[68:69], v[28:29], v[72:73] op_sel:[0,0,0] op_sel_hi:[0,1,1]
    v_pk_fma_f32 v[78:79], v[76:77], v[30:31], v[80:81] op_sel:[0,0,0] op_sel_hi:[0,1,1]
    v_pk_fma_f32 v[34:35], v[86:87], v[32:33], v[88:89] op_sel:[0,0,0] op_sel_hi:[0,1,1]
    v_pk_mul_f32 v[64:65], v[26:27], v[42:43] op_sel:[1,1] op_sel_hi:[1,0] neg_lo:[0,1]
    v_cvt_pk_bf16_f32 v74, v70, v71
    v_cvt_pk_bf16_f32 v82, v78, v79
    v_cvt_pk_bf16_f32 v90, v34, v35
    v_pk_fma_f32 v[62:63], v[26:27], v[42:43], v[64:65] op_sel:[0,0,0] op_sel_hi:[0,1,1]
    ds_write_addtid_b32 v74 offset:1904
    ds_write_addtid_b32 v82 offset:3536
    ds_write_addtid_b32 v90 offset:4080
    v_cvt_pk_bf16_f32 v66, v62, v63
    v_pk_mul_f32 v[88:89], v[84:85], v[42:43] op_sel:[1,1] op_sel_hi:[1,0] neg_lo:[0,1]
    ds_write_addtid_b32 v66 offset:4352
    v_pk_fma_f32 v[34:35], v[84:85], v[42:43], v[88:89] op_sel:[0,0,0] op_sel_hi:[0,1,1]
    v_pk_mul_f32 v[64:65], v[62:63], v[36:37] op_sel:[1,1] op_sel_hi:[1,0] neg_lo:[0,1]
    v_cvt_pk_bf16_f32 v90, v34, v35
    v_pk_fma_f32 v[60:61], v[62:63], v[36:37], v[64:65] op_sel:[0,0,0] op_sel_hi:[0,1,1]
    ds_write_addtid_b32 v90 offset:4896
    v_cvt_pk_bf16_f32 v66, v60, v61
    v_pk_mul_f32 v[88:89], v[86:87], v[42:43] op_sel:[1,1] op_sel_hi:[1,0] neg_lo:[0,1]
    ds_write_addtid_b32 v66 offset:4624
    v_pk_fma_f32 v[34:35], v[86:87], v[42:43], v[88:89] op_sel:[0,0,0] op_sel_hi:[0,1,1]
    v_pk_mul_f32 v[64:65], v[62:63], v[42:43] op_sel:[1,1] op_sel_hi:[1,0] neg_lo:[0,1]
    v_cvt_pk_bf16_f32 v90, v34, v35
    v_pk_fma_f32 v[60:61], v[62:63], v[42:43], v[64:65] op_sel:[0,0,0] op_sel_hi:[0,1,1]
    ds_write_addtid_b32 v90 offset:5168
    v_cvt_pk_bf16_f32 v66, v60, v61
    ds_write_addtid_b32 v66 offset:6528
KG_JOIN0:
    s_cmp_ge_u32 s101, 5
    s_cbranch_scc1 KG_NOU2
    s_mov_b32 s64, 0x05040100
    s_mov_b32 s65, 0x07060302
    s_waitcnt vmcnt(0)
    v_perm_b32 v60, v96, v92, s64
    v_perm_b32 v61, v104, v100, s64
    v_perm_b32 v62, v112, v108, s64
    v_perm_b32 v63, v120, v116, s64
    s_mov_b32 s5, 0
    buffer_store_dwordx4 v[60:63], v124, s[48:51], s5 offen sc1
    v_perm_b32 v64, v96, v92, s65
    v_perm_b32 v65, v104, v100, s65
    v_perm_b32 v66, v112, v108, s65
    v_perm_b32 v67, v120, v116, s65
    s_mov_b32 s5, 4096
    buffer_store_dwordx4 v[64:67], v124, s[48:51], s5 offen sc1
    v_perm_b32 v68, v97, v93, s64
    v_perm_b32 v69, v105, v101, s64
    v_perm_b32 v70, v113, v109, s64
    v_perm_b32 v71, v121, v117, s64
    s_mov_b32 s5, 8192
    buffer_store_dwordx4 v[68:71], v124, s[48:51], s5 offen sc1
    v_perm_b32 v72, v97, v93, s65
    v_perm_b32 v73, v105, v101, s65
    v_perm_b32 v74, v113, v109, s65
    v_perm_b32 v75, v121, v117, s65
    s_mov_b32 s5, 12288
    buffer_store_dwordx4 v[72:75], v124, s[48:51], s5 offen sc1
    v_perm_b32 v76, v98, v94, s64
    v_perm_b32 v77, v106, v102, s64
    v_perm_b32 v78, v114, v110, s64
    v_perm_b32 v79, v122, v118, s64
    s_mov_b32 s5, 16384
    buffer_store_dwordx4 v[76:79], v124, s[48:51], s5 offen sc1
    v_perm_b32 v80, v98, v94, s65
    v_perm_b32 v81, v106, v102, s65
    v_perm_b32 v82, v114, v110, s65
    v_perm_b32 v83, v122, v118, s65
    s_mov_b32 s5, 20480
    buffer_store_dwordx4 v[80:83], v124, s[48:51], s5 offen sc1
    v_perm_b32 v84, v99, v95, s64
    v_perm_b32 v85, v107, v103, s64
    v_perm_b32 v86, v115, v111, s64
    v_perm_b32 v87, v123, v119, s64
    s_mov_b32 s5, 24576
    buffer_store_dwordx4 v[84:87], v124, s[48:51], s5 offen sc1
    v_perm_b32 v88, v99, v95, s65
    v_perm_b32 v89, v107, v103, s65
    v_perm_b32 v90, v115, v111, s65
    v_perm_b32 v91, v123, v119, s65
    s_mov_b32 s5, 28672
    buffer_store_dwordx4 v[88:91], v124, s[48:51], s5 offen sc1
    s_nop 1
KG_NOU2:
    s_waitcnt lgkmcnt(0)
    s_barrier
    ds_read_b128 v[60:63], v21 offset:0
    ds_read_b128 v[76:79], v21 offset:6800
    ds_read_b128 v[64:67], v21 offset:32
    ds_read_b128 v[80:83], v21 offset:6832
    ds_read_b128 v[68:71], v21 offset:64
    ds_read_b128 v[84:87], v21 offset:6864
    ds_read_b128 v[72:75], v21 offset:96
    ds_read_b128 v[88:91], v21 offset:6896
    s_waitcnt lgkmcnt(6)
    v_mfma_f32_32x32x16_bf16 v[44:59], v[60:63], v[76:79], 0
    s_waitcnt lgkmcnt(4)
    v_mfma_f32_32x32x16_bf16 v[44:59], v[64:67], v[80:83], v[44:59]
    s_waitcnt lgkmcnt(2)
    v_mfma_f32_32x32x16_bf16 v[44:59], v[68:71], v[84:87], v[44:59]
    s_waitcnt lgkmcnt(0)
    v_mfma_f32_32x32x16_bf16 v[44:59], v[72:75], v[88:91], v[44:59]
    s_barrier
    v_lshlrev_b32 v12, 16, v12
    v_mul_f32 v12, s84, v12
    v_exp_f32 v12, v12
    v_lshlrev_b32 v13, 16, v13
    v_lshlrev_b32 v14, 16, v14
    v_lshlrev_b32 v15, 16, v15
    v_cvt_pk_bf16_f32 v12, v12, v12
    v_lshlrev_b32 v12, 16, v12
    v_mul_f32 v24, v12, -v7
    v_mul_f32 v25, v13, v7
    v_mul_f32 v24, s84, v24
    v_mul_f32 v25, s87, v25
    s_cmp_lg_u32 s89, 0
    s_cbranch_scc1 KG_ROWS1
    v_mov_b32 v66, 8.0
    v_mov_b32 v74, 64.0
    v_mov_b32 v82, 128.0
    v_mov_b32 v90, 192.0
    v_mul_f32 v64, v66, v24
    v_mul_f32 v72, v74, v24
    v_mul_f32 v80, v82, v24
    v_mul_f32 v88, v90, v24
    v_mul_f32 v65, v66, v25
    v_mul_f32 v73, v74, v25
    v_mul_f32 v81, v82, v25
    v_mul_f32 v89, v90, v25
    v_exp_f32 v64, v64
    v_exp_f32 v72, v72
    v_exp_f32 v80, v80
    v_exp_f32 v88, v88
    v_fract_f32 v65, v65
    v_fract_f32 v73, v73
    v_fract_f32 v81, v81
    v_fract_f32 v89, v89
    s_nop 0
    s_nop 0
    s_nop 0
    s_nop 0
    v_cos_f32 v66, v65
    v_cos_f32 v74, v73
    v_cos_f32 v82, v81
    v_cos_f32 v90, v89
    v_sin_f32 v67, v65
    v_sin_f32 v75, v73
    v_sin_f32 v83, v81
    v_sin_f32 v91, v89
    s_nop 0
    s_nop 0
    s_nop 0
    s_nop 0
    v_mul_f32 v34, v64, v66
    v_mul_f32 v68, v72, v74
    v_mul_f32 v76, v80, v82
    v_mul_f32 v84, v88, v90
    v_mul_f32 v35, v64, -v67
    v_mul_f32 v69, v72, -v75
    v_mul_f32 v77, v80, -v83
    v_mul_f32 v85, v88, -v91
    v_mov_b32 v60, 1.0
    v_mov_b32 v61, 0
    v_cvt_pk_bf16_f32 v66, v60, v61
    v_cvt_pk_bf16_f32 v74, v68, v69
    v_cvt_pk_bf16_f32 v82, v76, v77
    v_cvt_pk_bf16_f32 v90, v84, v85
    ds_write_addtid_b32 v66 offset:6800
    ds_write_addtid_b32 v74 offset:8976
    ds_write_addtid_b32 v82 offset:11152
    ds_write_addtid_b32 v90 offset:13328
    v_pk_mul_f32 v[64:65], v[60:61], v[34:35] op_sel:[1,1] op_sel_hi:[1,0] neg_lo:[0,1]
    v_pk_mul_f32 v[72:73], v[68:69], v[34:35] op_sel:[1,1] op_sel_hi:[1,0] neg_lo:[0,1]
    v_pk_mul_f32 v[80:81], v[76:77], v[34:35] op_sel:[1,1] op_sel_hi:[1,0] neg_lo:[0,1]
    v_pk_mul_f32 v[88:89], v[84:85], v[34:35] op_sel:[1,1] op_sel_hi:[1,0] neg_lo:[0,1]
    v_pk_fma_f32 v[62:63], v[60:61], v[34:35], v[64:65] op_sel:[0,0,0] op_sel_hi:[0,1,1]
    v_pk_fma_f32 v[70:71], v[68:69], v[34:35], v[72:73] op_sel:[0,0,0] op_sel_hi:[0,1,1]
    v_pk_fma_f32 v[78:79], v[76:77], v[34:35], v[80:81] op_sel:[0,0,0] op_sel_hi:[0,1,1]
    v_pk_fma_f32 v[86:87], v[84:85], v[34:35], v[88:89] op_sel:[0,0,0] op_sel_hi:[0,1,1]
    v_cvt_pk_bf16_f32 v66, v62, v63
    v_cvt_pk_bf16_f32 v74, v70, v71
    v_cvt_pk_bf16_f32 v82, v78, v79
    v_cvt_pk_bf16_f32 v90, v86, v87
    ds_write_addtid_b32 v66 offset:7072
    ds_write_addtid_b32 v74 offset:9248
    ds_write_addtid_b32 v82 offset:11424
    ds_write_addtid_b32 v90 offset:13600
    v_pk_mul_f32 v[64:65], v[62:63], v[34:35] op_sel:[1,1] op_sel_hi:[1,0] neg_lo:[0,1]
    v_pk_mul_f32 v[72:73], v[70:71], v[34:35] op_sel:[1,1] op_sel_hi:[1,0] neg_lo:[0,1]
    v_pk_mul_f32 v[80:81], v[78:79], v[34:35] op_sel:[1,1] op_sel_hi:[1,0] neg_lo:[0,1]
    v_pk_mul_f32 v[88:89], v[86:87], v[34:35] op_sel:[1,1] op_sel_hi:[1,0] neg_lo:[0,1]
    v_pk_fma_f32 v[60:61], v[62:63], v[34:35], v[64:65] op_sel:[0,0,0] op_sel_hi:[0,1,1]
    v_pk_fma_f32 v[68:69], v[70:71], v[34:35], v[72:73] op_sel:[0,0,0] op_sel_hi:[0,1,1]
    v_pk_fma_f32 v[76:77], v[78:79], v[34:35], v[80:81] op_sel:[0,0,0] op_sel_hi:[0,1,1]
    v_pk_fma_f32 v[84:85], v[86:87], v[34:35], v[88:89] op_sel:[0,0,0] op_sel_hi:[0,1,1]
    v_cvt_pk_bf16_f32 v66, v60, v61
    v_cvt_pk_bf16_f32 v74, v68, v69
    v_cvt_pk_bf16_f32 v82, v76, v77
    v_cvt_pk_bf16_f32 v90, v84, v85
    ds_write_addtid_b32 v66 offset:7344
    ds_write_addtid_b32 v74 offset:9520
    ds_write_addtid_b32 v82 offset:11696
    ds_write_addtid_b32 v90 offset:13872
    v_pk_mul_f32 v[64:65], v[60:61], v[34:35] op_sel:[1,1] op_sel_hi:[1,0] neg_lo:[0,1]
    v_pk_mul_f32 v[72:73], v[68:69], v[34:35] op_sel:[1,1] op_sel_hi:[1,0] neg_lo:[0,1]
    v_pk_mul_f32 v[80:81], v[76:77], v[34:35] op_sel:[1,1] op_sel_hi:[1,0] neg_lo:[0,1]
    v_pk_mul_f32 v[88:89], v[84:85], v[34:35] op_sel:[1,1] op_sel_hi:[1,0] neg_lo:[0,1]
    v_pk_fma_f32 v[62:63], v[60:61], v[34:35], v[64:65] op_sel:[0,0,0] op_sel_hi:[0,1,1]
    v_pk_fma_f32 v[70:71], v[68:69], v[34:35], v[72:73] op_sel:[0,0,0] op_sel_hi:[0,1,1]
    v_pk_fma_f32 v[78:79], v[76:77], v[34:35], v[80:81] op_sel:[0,0,0] op_sel_hi:[0,1,1]
    v_pk_fma_f32 v[86:87], v[84:85], v[34:35], v[88:89] op_sel:[0,0,0] op_sel_hi:[0,1,1]
    v_cvt_pk_bf16_f32 v66, v62, v63
    v_cvt_pk_bf16_f32 v74, v70, v71
    v_cvt_pk_bf16_f32 v82, v78, v79
    v_cvt_pk_bf16_f32 v90, v86, v87
    ds_write_addtid_b32 v66 offset:7616
    ds_write_addtid_b32 v74 offset:9792
    ds_write_addtid_b32 v82 offset:11968
    ds_write_addtid_b32 v90 offset:14144
    v_pk_mul_f32 v[64:65], v[62:63], v[34:35] op_sel:[1,1] op_sel_hi:[1,0] neg_lo:[0,1]
    v_pk_mul_f32 v[72:73], v[70:71], v[34:35] op_sel:[1,1] op_sel_hi:[1,0] neg_lo:[0,1]
    v_pk_mul_f32 v[80:81], v[78:79], v[34:35] op_sel:[1,1] op_sel_hi:[1,0] neg_lo:[0,1]
    v_pk_mul_f32 v[88:89], v[86:87], v[34:35] op_sel:[1,1] op_sel_hi:[1,0] neg_lo:[0,1]
    v_pk_fma_f32 v[60:61], v[62:63], v[34:35], v[64:65] op_sel:[0,0,0] op_sel_hi:[0,1,1]
    v_pk_fma_f32 v[68:69], v[70:71], v[34:35], v[72:73] op_sel:[0,0,0] op_sel_hi:[0,1,1]
    v_pk_fma_f32 v[76:77], v[78:79], v[34:35], v[80:81] op_sel:[0,0,0] op_sel_hi:[0,1,1]
    v_pk_fma_f32 v[84:85], v[86:87], v[34:35], v[88:89] op_sel:[0,0,0] op_sel_hi:[0,1,1]
    v_cvt_pk_bf16_f32 v66, v60, v61
    v_cvt_pk_bf16_f32 v74, v68, v69
    v_cvt_pk_bf16_f32 v82, v76, v77
    v_cvt_pk_bf16_f32 v90, v84, v85
    ds_write_addtid_b32 v66 offset:7888
    ds_write_addtid_b32 v74 offset:10064
    ds_write_addtid_b32 v82 offset:12240
    ds_write_addtid_b32 v90 offset:14416
    v_pk_mul_f32 v[64:65], v[60:61], v[34:35] op_sel:[1,1] op_sel_hi:[1,0] neg_lo:[0,1]
    v_pk_mul_f32 v[72:73], v[68:69], v[34:35] op_sel:[1,1] op_sel_hi:[1,0] neg_lo:[0,1]
    v_pk_mul_f32 v[80:81], v[76:77], v[34:35] op_sel:[1,1] op_sel_hi:[1,0] neg_lo:[0,1]
    v_pk_mul_f32 v[88:89], v[84:85], v[34:35] op_sel:[1,1] op_sel_hi:[1,0] neg_lo:[0,1]
    v_pk_fma_f32 v[62:63], v[60:61], v[34:35], v[64:65] op_sel:[0,0,0] op_sel_hi:[0,1,1]
    v_pk_fma_f32 v[70:71], v[68:69], v[34:35], v[72:73] op_sel:[0,0,0] op_sel_hi:[0,1,1]
    v_pk_fma_f32 v[78:79], v[76:77], v[34:35], v[80:81] op_sel:[0,0,0] op_sel_hi:[0,1,1]
    v_pk_fma_f32 v[86:87], v[84:85], v[34:35], v[88:89] op_sel:[0,0,0] op_sel_hi:[0,1,1]
    v_cvt_pk_bf16_f32 v66, v62, v63
    v_cvt_pk_bf16_f32 v74, v70, v71
    v_cvt_pk_bf16_f32 v82, v78, v79
    v_cvt_pk_bf16_f32 v90, v86, v87
    ds_write_addtid_b32 v66 offset:8160
    ds_write_addtid_b32 v74 offset:10336
    ds_write_addtid_b32 v82 offset:12512
    ds_write_addtid_b32 v90 offset:14688
    v_pk_mul_f32 v[64:65], v[62:63], v[34:35] op_sel:[1,1] op_sel_hi:[1,0] neg_lo:[0,1]
    v_pk_mul_f32 v[72:73], v[70:71], v[34:35] op_sel:[1,1] op_sel_hi:[1,0] neg_lo:[0,1]
    v_pk_mul_f32 v[80:81], v[78:79], v[34:35] op_sel:[1,1] op_sel_hi:[1,0] neg_lo:[0,1]
    v_pk_mul_f32 v[88:89], v[86:87], v[34:35] op_sel:[1,1] op_sel_hi:[1,0] neg_lo:[0,1]
    v_pk_fma_f32 v[60:61], v[62:63], v[34:35], v[64:65] op_sel:[0,0,0] op_sel_hi:[0,1,1]
    v_pk_fma_f32 v[68:69], v[70:71], v[34:35], v[72:73] op_sel:[0,0,0] op_sel_hi:[0,1,1]
    v_pk_fma_f32 v[76:77], v[78:79], v[34:35], v[80:81] op_sel:[0,0,0] op_sel_hi:[0,1,1]
    v_pk_fma_f32 v[84:85], v[86:87], v[34:35], v[88:89] op_sel:[0,0,0] op_sel_hi:[0,1,1]
    v_cvt_pk_bf16_f32 v66, v60, v61
    v_cvt_pk_bf16_f32 v74, v68, v69
    v_cvt_pk_bf16_f32 v82, v76, v77
    v_cvt_pk_bf16_f32 v90, v84, v85
    ds_write_addtid_b32 v66 offset:8432
    ds_write_addtid_b32 v74 offset:10608
    ds_write_addtid_b32 v82 offset:12784
    ds_write_addtid_b32 v90 offset:14960
    v_pk_mul_f32 v[64:65], v[60:61], v[34:35] op_sel:[1,1] op_sel_hi:[1,0] neg_lo:[0,1]
    v_pk_mul_f32 v[72:73], v[68:69], v[34:35] op_sel:[1,1] op_sel_hi:[1,0] neg_lo:[0,1]
    v_pk_mul_f32 v[80:81], v[76:77], v[34:35] op_sel:[1,1] op_sel_hi:[1,0] neg_lo:[0,1]
    v_pk_mul_f32 v[88:89], v[84:85], v[34:35] op_sel:[1,1] op_sel_hi:[1,0] neg_lo:[0,1]
    v_pk_fma_f32 v[62:63], v[60:61], v[34:35], v[64:65] op_sel:[0,0,0] op_sel_hi:[0,1,1]
    v_pk_fma_f32 v[70:71], v[68:69], v[34:35], v[72:73] op_sel:[0,0,0] op_sel_hi:[0,1,1]
    v_pk_fma_f32 v[78:79], v[76:77], v[34:35], v[80:81] op_sel:[0,0,0] op_sel_hi:[0,1,1]
    v_pk_fma_f32 v[86:87], v[84:85], v[34:35], v[88:89] op_sel:[0,0,0] op_sel_hi:[0,1,1]
    v_cvt_pk_bf16_f32 v66, v62, v63
    v_cvt_pk_bf16_f32 v74, v70, v71
    v_cvt_pk_bf16_f32 v82, v78, v79
    v_cvt_pk_bf16_f32 v90, v86, v87
    ds_write_addtid_b32 v66 offset:8704
    ds_write_addtid_b32 v74 offset:10880
    ds_write_addtid_b32 v82 offset:13056
    ds_write_addtid_b32 v90 offset:15232
    s_branch KG_JOIN1
KG_ROWS1:
    v_mul_f32 v26, v14, v7
    v_mul_f32 v27, v15, v7
    v_add_f32 v26, v26, v26
    v_add_f32 v27, v27, v27
    v_exp_f32 v64, v24
    v_mov_b32 v74, 4.0
    v_mov_b32 v82, 256.0
    v_mov_b32 v90, 512.0
    v_fract_f32 v65, v25
    v_mul_f32 v72, v74, v24
    v_mul_f32 v80, v82, v24
    v_mul_f32 v88, v90, v24
    s_nop 0
    v_mul_f32 v73, v74, v25
    v_mul_f32 v81, v82, v25
    v_mul_f32 v89, v90, v25
    v_cos_f32 v66, v65
    v_exp_f32 v72, v72
    v_exp_f32 v80, v80
    v_exp_f32 v88, v88
    v_sin_f32 v67, v65
    v_fract_f32 v73, v73
    v_fract_f32 v81, v81
    v_fract_f32 v89, v89
    s_nop 0
    s_nop 0
    s_nop 0
    s_nop 0
    v_mul_f32 v28, v64, v66
    v_cos_f32 v74, v73
    v_cos_f32 v82, v81
    v_cos_f32 v90, v89
    v_mul_f32 v29, v64, v67
    v_sin_f32 v75, v73
    v_sin_f32 v83, v81
    v_sin_f32 v91, v89
    v_pk_mul_f32 v[64:65], v[28:29], v[28:29] op_sel:[1,1] op_sel_hi:[1,0] neg_lo:[0,1]
    s_nop 0
    s_nop 0
    s_nop 0
    v_pk_fma_f32 v[30:31], v[28:29], v[28:29], v[64:65] op_sel:[0,0,0] op_sel_hi:[0,1,1]
    v_mul_f32 v32, v72, v74
    v_mul_f32 v36, v80, v82
    v_mul_f32 v40, v88, v90
    v_mul_f32 v33, v72, v75
    v_mul_f32 v37, v80, v83
    v_mul_f32 v41, v88, v91
    v_pk_mul_f32 v[88:89], v[40:41], v[40:41] op_sel:[1,1] op_sel_hi:[1,0] neg_lo:[0,1]
    v_pk_fma_f32 v[42:43], v[40:41], v[40:41], v[88:89] op_sel:[0,0,0] op_sel_hi:[0,1,1]
    v_cvt_pk_bf16_f32 v66, v26, v27
    v_pk_mul_f32 v[72:73], v[26:27], v[32:33] op_sel:[1,1] op_sel_hi:[1,0] neg_lo:[0,1]
    v_pk_mul_f32 v[80:81], v[26:27], v[36:37] op_sel:[1,1] op_sel_hi:[1,0] neg_lo:[0,1]
    v_pk_mul_f32 v[88:89], v[26:27], v[40:41] op_sel:[1,1] op_sel_hi:[1,0] neg_lo:[0,1]
    ds_write_addtid_b32 v66 offset:0
    v_pk_fma_f32 v[68:69], v[26:27], v[32:33], v[72:73] op_sel:[0,0,0] op_sel_hi:[0,1,1]
    v_pk_fma_f32 v[76:77], v[26:27], v[36:37], v[80:81] op_sel:[0,0,0] op_sel_hi:[0,1,1]
    v_pk_fma_f32 v[84:85], v[26:27], v[40:41], v[88:89] op_sel:[0,0,0] op_sel_hi:[0,1,1]
    v_pk_mul_f32 v[64:65], v[26:27], v[28:29] op_sel:[1,1] op_sel_hi:[1,0] neg_lo:[0,1]
    v_cvt_pk_bf16_f32 v74, v68, v69
    v_cvt_pk_bf16_f32 v82, v76, v77
    v_cvt_pk_bf16_f32 v90, v84, v85
    v_pk_fma_f32 v[60:61], v[26:27], v[28:29], v[64:65] op_sel:[0,0,0] op_sel_hi:[0,1,1]
    ds_write_addtid_b32 v74 offset:1088
    ds_write_addtid_b32 v82 offset:2176
    ds_write_addtid_b32 v90 offset:2720
    v_cvt_pk_bf16_f32 v66, v60, v61
    v_pk_mul_f32 v[72:73], v[68:69], v[28:29] op_sel:[1,1] op_sel_hi:[1,0] neg_lo:[0,1]
    v_pk_mul_f32 v[80:81], v[76:77], v[30:31] op_sel:[1,1] op_sel_hi:[1,0] neg_lo:[0,1]
    v_pk_mul_f32 v[88:89], v[84:85], v[32:33] op_sel:[1,1] op_sel_hi:[1,0] neg_lo:[0,1]
    ds_write_addtid_b32 v66 offset:272
    v_pk_fma_f32 v[70:71], v[68:69], v[28:29], v[72:73] op_sel:[0,0,0] op_sel_hi:[0,1,1]
    v_pk_fma_f32 v[78:79], v[76:77], v[30:31], v[80:81] op_sel:[0,0,0] op_sel_hi:[0,1,1]
    v_pk_fma_f32 v[86:87], v[84:85], v[32:33], v[88:89] op_sel:[0,0,0] op_sel_hi:[0,1,1]
    v_pk_mul_f32 v[64:65], v[60:61], v[28:29] op_sel:[1,1] op_sel_hi:[1,0] neg_lo:[0,1]
    v_cvt_pk_bf16_f32 v74, v70, v71
    v_cvt_pk_bf16_f32 v82, v78, v79
    v_cvt_pk_bf16_f32 v90, v86, v87
    v_pk_fma_f32 v[62:63], v[60:61], v[28:29], v[64:65] op_sel:[0,0,0] op_sel_hi:[0,1,1]
    ds_write_addtid_b32 v74 offset:1360
    ds_write_addtid_b32 v82 offset:2448
    ds_write_addtid_b32 v90 offset:3808
    v_cvt_pk_bf16_f32 v66, v62, v63
    v_pk_mul_f32 v[72:73], v[70:71], v[28:29] op_sel:[1,1] op_sel_hi:[1,0] neg_lo:[0,1]
    v_pk_mul_f32 v[80:81], v[78:79], v[30:31] op_sel:[1,1] op_sel_hi:[1,0] neg_lo:[0,1]
    v_pk_mul_f32 v[88:89], v[84:85], v[36:37] op_sel:[1,1] op_sel_hi:[1,0] neg_lo:[0,1]
    ds_write_addtid_b32 v66 offset:544
    v_pk_fma_f32 v[68:69], v[70:71], v[28:29], v[72:73] op_sel:[0,0,0] op_sel_hi:[0,1,1]
    v_pk_fma_f32 v[76:77], v[78:79], v[30:31], v[80:81] op_sel:[0,0,0] op_sel_hi:[0,1,1]
    v_pk_fma_f32 v[86:87], v[84:85], v[36:37], v[88:89] op_sel:[0,0,0] op_sel_hi:[0,1,1]
    v_pk_mul_f32 v[64:65], v[62:63], v[28:29] op_sel:[1,1] op_sel_hi:[1,0] neg_lo:[0,1]
    v_cvt_pk_bf16_f32 v74, v68, v69
    v_cvt_pk_bf16_f32 v82, v76, v77
    v_cvt_pk_bf16_f32 v90, v86, v87
    v_pk_fma_f32 v[60:61], v[62:63], v[28:29], v[64:65] op_sel:[0,0,0] op_sel_hi:[0,1,1]
    ds_write_addtid_b32 v74 offset:1632
    ds_write_addtid_b32 v82 offset:3264
    ds_write_addtid_b32 v90 offset:2992
    v_cvt_pk_bf16_f32 v66, v60, v61
    v_pk_mul_f32 v[72:73], v[68:69], v[28:29] op_sel:[1,1] op_sel_hi:[1,0] neg_lo:[0,1]
    v_pk_mul_f32 v[80:81], v[76:77], v[30:31] op_sel:[1,1] op_sel_hi:[1,0] neg_lo:[0,1]
    v_pk_mul_f32 v[88:89], v[86:87], v[32:33] op_sel:[1,1] op_sel_hi:[1,0] neg_lo:[0,1]
    ds_write_addtid_b32 v66 offset:816
    v_pk_fma_f32 v[70:71], v[68:69], v[28:29], v[72:73] op_sel:[0,0,0] op_sel_hi:[0,1,1]
    v_pk_fma_f32 v[78:79], v[76:77], v[30:31], v[80:81] op_sel:[0,0,0] op_sel_hi:[0,1,1]
    v_pk_fma_f32 v[34:35], v[86:87], v[32:33], v[88:89] op_sel:[0,0,0] op_sel_hi:[0,1,1]
    v_pk_mul_f32 v[64:65], v[26:27], v[42:43] op_sel:[1,1] op_sel_hi:[1,0] neg_lo:[0,1]
    v_cvt_pk_bf16_f32 v74, v70, v71
    v_cvt_pk_bf16_f32 v82, v78, v79
    v_cvt_pk_bf16_f32 v90, v34, v35
    v_pk_fma_f32 v[62:63], v[26:27], v[42:43], v[64:65] op_sel:[0,0,0] op_sel_hi:[0,1,1]
    ds_write_addtid_b32 v74 offset:1904
    ds_write_addtid_b32 v82 offset:3536
    ds_write_addtid_b32 v90 offset:4080
    v_cvt_pk_bf16_f32 v66, v62, v63
    v_pk_mul_f32 v[88:89], v[84:85], v[42:43] op_sel:[1,1] op_sel_hi:[1,0] neg_lo:[0,1]
    ds_write_addtid_b32 v66 offset:4352
    v_pk_fma_f32 v[34:35], v[84:85], v[42:43], v[88:89] op_sel:[0,0,0] op_sel_hi:[0,1,1]
    v_pk_mul_f32 v[64:65], v[62:63], v[36:37] op_sel:[1,1] op_sel_hi:[1,0] neg_lo:[0,1]
    v_cvt_pk_bf16_f32 v90, v34, v35
    v_pk_fma_f32 v[60:61], v[62:63], v[36:37], v[64:65] op_sel:[0,0,0] op_sel_hi:[0,1,1]
    ds_write_addtid_b32 v90 offset:4896
    v_cvt_pk_bf16_f32 v66, v60, v61
    v_pk_mul_f32 v[88:89], v[86:87], v[42:43] op_sel:[1,1] op_sel_hi:[1,0] neg_lo:[0,1]
    ds_write_addtid_b32 v66 offset:4624
    v_pk_fma_f32 v[34:35], v[86:87], v[42:43], v[88:89] op_sel:[0,0,0] op_sel_hi:[0,1,1]
    v_pk_mul_f32 v[64:65], v[62:63], v[42:43] op_sel:[1,1] op_sel_hi:[1,0] neg_lo:[0,1]
    v_cvt_pk_bf16_f32 v90, v34, v35
    v_pk_fma_f32 v[60:61], v[62:63], v[42:43], v[64:65] op_sel:[0,0,0] op_sel_hi:[0,1,1]
    ds_write_addtid_b32 v90 offset:5168
    v_cvt_pk_bf16_f32 v66, v60, v61
    ds_write_addtid_b32 v66 offset:6528
KG_JOIN1:
    s_cmp_ge_u32 s101, 5
    s_cbranch_scc1 KG_NOU3
    s_lshl_b32 s5, s11, 2
    s_add_u32 s5, s5, 64
    v_mov_b32 v92, 1
    v_mov_b32 v93, s5
    s_waitcnt vmcnt(0)
    s_mov_b64 exec, 1
    buffer_atomic_add v92, v93, s[60:63], 0 offen sc1
    s_mov_b64 exec, -1
KG_NOU3:
    s_waitcnt lgkmcnt(0)
    s_barrier
    ds_read_b128 v[60:63], v21 offset:0
    ds_read_b128 v[76:79], v21 offset:6800
    ds_read_b128 v[64:67], v21 offset:32
    ds_read_b128 v[80:83], v21 offset:6832
    ds_read_b128 v[68:71], v21 offset:64
    ds_read_b128 v[84:87], v21 offset:6864
    ds_read_b128 v[72:75], v21 offset:96
    ds_read_b128 v[88:91], v21 offset:6896
    s_waitcnt lgkmcnt(6)
    v_mfma_f32_32x32x16_bf16 v[44:59], v[60:63], v[76:79], v[44:59]
    s_waitcnt lgkmcnt(4)
    v_mfma_f32_32x32x16_bf16 v[44:59], v[64:67], v[80:83], v[44:59]
    s_waitcnt lgkmcnt(2)
    v_mfma_f32_32x32x16_bf16 v[44:59], v[68:71], v[84:87], v[44:59]
    s_waitcnt lgkmcnt(0)
    v_mfma_f32_32x32x16_bf16 v[44:59], v[72:75], v[88:91], v[44:59]
    s_barrier
    v_lshlrev_b32 v16, 16, v16
    v_mul_f32 v16, s84, v16
    v_exp_f32 v16, v16
    v_lshlrev_b32 v17, 16, v17
    v_lshlrev_b32 v18, 16, v18
    v_lshlrev_b32 v19, 16, v19
    v_cvt_pk_bf16_f32 v16, v16, v16
    v_lshlrev_b32 v16, 16, v16
    v_mul_f32 v24, v16, -v7
    v_mul_f32 v25, v17, v7
    v_mul_f32 v24, s84, v24
    v_mul_f32 v25, s87, v25
    s_cmp_lg_u32 s89, 0
    s_cbranch_scc1 KG_ROWS2
    v_mov_b32 v66, 8.0
    v_mov_b32 v74, 64.0
    v_mov_b32 v82, 128.0
    v_mov_b32 v90, 192.0
    v_mul_f32 v64, v66, v24
    v_mul_f32 v72, v74, v24
    v_mul_f32 v80, v82, v24
    v_mul_f32 v88, v90, v24
    v_mul_f32 v65, v66, v25
    v_mul_f32 v73, v74, v25
    v_mul_f32 v81, v82, v25
    v_mul_f32 v89, v90, v25
    v_exp_f32 v64, v64
    v_exp_f32 v72, v72
    v_exp_f32 v80, v80
    v_exp_f32 v88, v88
    v_fract_f32 v65, v65
    v_fract_f32 v73, v73
    v_fract_f32 v81, v81
    v_fract_f32 v89, v89
    s_nop 0
    s_nop 0
    s_nop 0
    s_nop 0
    v_cos_f32 v66, v65
    v_cos_f32 v74, v73
    v_cos_f32 v82, v81
    v_cos_f32 v90, v89
    v_sin_f32 v67, v65
    v_sin_f32 v75, v73
    v_sin_f32 v83, v81
    v_sin_f32 v91, v89
    s_nop 0
    s_nop 0
    s_nop 0
    s_nop 0
    v_mul_f32 v34, v64, v66
    v_mul_f32 v68, v72, v74
    v_mul_f32 v76, v80, v82
    v_mul_f32 v84, v88, v90
    v_mul_f32 v35, v64, -v67
    v_mul_f32 v69, v72, -v75
    v_mul_f32 v77, v80, -v83
    v_mul_f32 v85, v88, -v91
    v_mov_b32 v60, 1.0
    v_mov_b32 v61, 0
    v_cvt_pk_bf16_f32 v66, v60, v61
    v_cvt_pk_bf16_f32 v74, v68, v69
    v_cvt_pk_bf16_f32 v82, v76, v77
    v_cvt_pk_bf16_f32 v90, v84, v85
    ds_write_addtid_b32 v66 offset:6800
    ds_write_addtid_b32 v74 offset:8976
    ds_write_addtid_b32 v82 offset:11152
    ds_write_addtid_b32 v90 offset:13328
    v_pk_mul_f32 v[64:65], v[60:61], v[34:35] op_sel:[1,1] op_sel_hi:[1,0] neg_lo:[0,1]
    v_pk_mul_f32 v[72:73], v[68:69], v[34:35] op_sel:[1,1] op_sel_hi:[1,0] neg_lo:[0,1]
    v_pk_mul_f32 v[80:81], v[76:77], v[34:35] op_sel:[1,1] op_sel_hi:[1,0] neg_lo:[0,1]
    v_pk_mul_f32 v[88:89], v[84:85], v[34:35] op_sel:[1,1] op_sel_hi:[1,0] neg_lo:[0,1]
    v_pk_fma_f32 v[62:63], v[60:61], v[34:35], v[64:65] op_sel:[0,0,0] op_sel_hi:[0,1,1]
    v_pk_fma_f32 v[70:71], v[68:69], v[34:35], v[72:73] op_sel:[0,0,0] op_sel_hi:[0,1,1]
    v_pk_fma_f32 v[78:79], v[76:77], v[34:35], v[80:81] op_sel:[0,0,0] op_sel_hi:[0,1,1]
    v_pk_fma_f32 v[86:87], v[84:85], v[34:35], v[88:89] op_sel:[0,0,0] op_sel_hi:[0,1,1]
    v_cvt_pk_bf16_f32 v66, v62, v63
    v_cvt_pk_bf16_f32 v74, v70, v71
    v_cvt_pk_bf16_f32 v82, v78, v79
    v_cvt_pk_bf16_f32 v90, v86, v87
    ds_write_addtid_b32 v66 offset:7072
    ds_write_addtid_b32 v74 offset:9248
    ds_write_addtid_b32 v82 offset:11424
    ds_write_addtid_b32 v90 offset:13600
    v_pk_mul_f32 v[64:65], v[62:63], v[34:35] op_sel:[1,1] op_sel_hi:[1,0] neg_lo:[0,1]
    v_pk_mul_f32 v[72:73], v[70:71], v[34:35] op_sel:[1,1] op_sel_hi:[1,0] neg_lo:[0,1]
    v_pk_mul_f32 v[80:81], v[78:79], v[34:35] op_sel:[1,1] op_sel_hi:[1,0] neg_lo:[0,1]
    v_pk_mul_f32 v[88:89], v[86:87], v[34:35] op_sel:[1,1] op_sel_hi:[1,0] neg_lo:[0,1]
    v_pk_fma_f32 v[60:61], v[62:63], v[34:35], v[64:65] op_sel:[0,0,0] op_sel_hi:[0,1,1]
    v_pk_fma_f32 v[68:69], v[70:71], v[34:35], v[72:73] op_sel:[0,0,0] op_sel_hi:[0,1,1]
    v_pk_fma_f32 v[76:77], v[78:79], v[34:35], v[80:81] op_sel:[0,0,0] op_sel_hi:[0,1,1]
    v_pk_fma_f32 v[84:85], v[86:87], v[34:35], v[88:89] op_sel:[0,0,0] op_sel_hi:[0,1,1]
    v_cvt_pk_bf16_f32 v66, v60, v61
    v_cvt_pk_bf16_f32 v74, v68, v69
    v_cvt_pk_bf16_f32 v82, v76, v77
    v_cvt_pk_bf16_f32 v90, v84, v85
    ds_write_addtid_b32 v66 offset:7344
    ds_write_addtid_b32 v74 offset:9520
    ds_write_addtid_b32 v82 offset:11696
    ds_write_addtid_b32 v90 offset:13872
    v_pk_mul_f32 v[64:65], v[60:61], v[34:35] op_sel:[1,1] op_sel_hi:[1,0] neg_lo:[0,1]
    v_pk_mul_f32 v[72:73], v[68:69], v[34:35] op_sel:[1,1] op_sel_hi:[1,0] neg_lo:[0,1]
    v_pk_mul_f32 v[80:81], v[76:77], v[34:35] op_sel:[1,1] op_sel_hi:[1,0] neg_lo:[0,1]
    v_pk_mul_f32 v[88:89], v[84:85], v[34:35] op_sel:[1,1] op_sel_hi:[1,0] neg_lo:[0,1]
    v_pk_fma_f32 v[62:63], v[60:61], v[34:35], v[64:65] op_sel:[0,0,0] op_sel_hi:[0,1,1]
    v_pk_fma_f32 v[70:71], v[68:69], v[34:35], v[72:73] op_sel:[0,0,0] op_sel_hi:[0,1,1]
    v_pk_fma_f32 v[78:79], v[76:77], v[34:35], v[80:81] op_sel:[0,0,0] op_sel_hi:[0,1,1]
    v_pk_fma_f32 v[86:87], v[84:85], v[34:35], v[88:89] op_sel:[0,0,0] op_sel_hi:[0,1,1]
    v_cvt_pk_bf16_f32 v66, v62, v63
    v_cvt_pk_bf16_f32 v74, v70, v71
    v_cvt_pk_bf16_f32 v82, v78, v79
    v_cvt_pk_bf16_f32 v90, v86, v87
    ds_write_addtid_b32 v66 offset:7616
    ds_write_addtid_b32 v74 offset:9792
    ds_write_addtid_b32 v82 offset:11968
    ds_write_addtid_b32 v90 offset:14144
    v_pk_mul_f32 v[64:65], v[62:63], v[34:35] op_sel:[1,1] op_sel_hi:[1,0] neg_lo:[0,1]
    v_pk_mul_f32 v[72:73], v[70:71], v[34:35] op_sel:[1,1] op_sel_hi:[1,0] neg_lo:[0,1]
    v_pk_mul_f32 v[80:81], v[78:79], v[34:35] op_sel:[1,1] op_sel_hi:[1,0] neg_lo:[0,1]
    v_pk_mul_f32 v[88:89], v[86:87], v[34:35] op_sel:[1,1] op_sel_hi:[1,0] neg_lo:[0,1]
    v_pk_fma_f32 v[60:61], v[62:63], v[34:35], v[64:65] op_sel:[0,0,0] op_sel_hi:[0,1,1]
    v_pk_fma_f32 v[68:69], v[70:71], v[34:35], v[72:73] op_sel:[0,0,0] op_sel_hi:[0,1,1]
    v_pk_fma_f32 v[76:77], v[78:79], v[34:35], v[80:81] op_sel:[0,0,0] op_sel_hi:[0,1,1]
    v_pk_fma_f32 v[84:85], v[86:87], v[34:35], v[88:89] op_sel:[0,0,0] op_sel_hi:[0,1,1]
    v_cvt_pk_bf16_f32 v66, v60, v61
    v_cvt_pk_bf16_f32 v74, v68, v69
    v_cvt_pk_bf16_f32 v82, v76, v77
    v_cvt_pk_bf16_f32 v90, v84, v85
    ds_write_addtid_b32 v66 offset:7888
    ds_write_addtid_b32 v74 offset:10064
    ds_write_addtid_b32 v82 offset:12240
    ds_write_addtid_b32 v90 offset:14416
    v_pk_mul_f32 v[64:65], v[60:61], v[34:35] op_sel:[1,1] op_sel_hi:[1,0] neg_lo:[0,1]
    v_pk_mul_f32 v[72:73], v[68:69], v[34:35] op_sel:[1,1] op_sel_hi:[1,0] neg_lo:[0,1]
    v_pk_mul_f32 v[80:81], v[76:77], v[34:35] op_sel:[1,1] op_sel_hi:[1,0] neg_lo:[0,1]
    v_pk_mul_f32 v[88:89], v[84:85], v[34:35] op_sel:[1,1] op_sel_hi:[1,0] neg_lo:[0,1]
    v_pk_fma_f32 v[62:63], v[60:61], v[34:35], v[64:65] op_sel:[0,0,0] op_sel_hi:[0,1,1]
    v_pk_fma_f32 v[70:71], v[68:69], v[34:35], v[72:73] op_sel:[0,0,0] op_sel_hi:[0,1,1]
    v_pk_fma_f32 v[78:79], v[76:77], v[34:35], v[80:81] op_sel:[0,0,0] op_sel_hi:[0,1,1]
    v_pk_fma_f32 v[86:87], v[84:85], v[34:35], v[88:89] op_sel:[0,0,0] op_sel_hi:[0,1,1]
    v_cvt_pk_bf16_f32 v66, v62, v63
    v_cvt_pk_bf16_f32 v74, v70, v71
    v_cvt_pk_bf16_f32 v82, v78, v79
    v_cvt_pk_bf16_f32 v90, v86, v87
    ds_write_addtid_b32 v66 offset:8160
    ds_write_addtid_b32 v74 offset:10336
    ds_write_addtid_b32 v82 offset:12512
    ds_write_addtid_b32 v90 offset:14688
    v_pk_mul_f32 v[64:65], v[62:63], v[34:35] op_sel:[1,1] op_sel_hi:[1,0] neg_lo:[0,1]
    v_pk_mul_f32 v[72:73], v[70:71], v[34:35] op_sel:[1,1] op_sel_hi:[1,0] neg_lo:[0,1]
    v_pk_mul_f32 v[80:81], v[78:79], v[34:35] op_sel:[1,1] op_sel_hi:[1,0] neg_lo:[0,1]
    v_pk_mul_f32 v[88:89], v[86:87], v[34:35] op_sel:[1,1] op_sel_hi:[1,0] neg_lo:[0,1]
    v_pk_fma_f32 v[60:61], v[62:63], v[34:35], v[64:65] op_sel:[0,0,0] op_sel_hi:[0,1,1]
    v_pk_fma_f32 v[68:69], v[70:71], v[34:35], v[72:73] op_sel:[0,0,0] op_sel_hi:[0,1,1]
    v_pk_fma_f32 v[76:77], v[78:79], v[34:35], v[80:81] op_sel:[0,0,0] op_sel_hi:[0,1,1]
    v_pk_fma_f32 v[84:85], v[86:87], v[34:35], v[88:89] op_sel:[0,0,0] op_sel_hi:[0,1,1]
    v_cvt_pk_bf16_f32 v66, v60, v61
    v_cvt_pk_bf16_f32 v74, v68, v69
    v_cvt_pk_bf16_f32 v82, v76, v77
    v_cvt_pk_bf16_f32 v90, v84, v85
    ds_write_addtid_b32 v66 offset:8432
    ds_write_addtid_b32 v74 offset:10608
    ds_write_addtid_b32 v82 offset:12784
    ds_write_addtid_b32 v90 offset:14960
    v_pk_mul_f32 v[64:65], v[60:61], v[34:35] op_sel:[1,1] op_sel_hi:[1,0] neg_lo:[0,1]
    v_pk_mul_f32 v[72:73], v[68:69], v[34:35] op_sel:[1,1] op_sel_hi:[1,0] neg_lo:[0,1]
    v_pk_mul_f32 v[80:81], v[76:77], v[34:35] op_sel:[1,1] op_sel_hi:[1,0] neg_lo:[0,1]
    v_pk_mul_f32 v[88:89], v[84:85], v[34:35] op_sel:[1,1] op_sel_hi:[1,0] neg_lo:[0,1]
    v_pk_fma_f32 v[62:63], v[60:61], v[34:35], v[64:65] op_sel:[0,0,0] op_sel_hi:[0,1,1]
    v_pk_fma_f32 v[70:71], v[68:69], v[34:35], v[72:73] op_sel:[0,0,0] op_sel_hi:[0,1,1]
    v_pk_fma_f32 v[78:79], v[76:77], v[34:35], v[80:81] op_sel:[0,0,0] op_sel_hi:[0,1,1]
    v_pk_fma_f32 v[86:87], v[84:85], v[34:35], v[88:89] op_sel:[0,0,0] op_sel_hi:[0,1,1]
    v_cvt_pk_bf16_f32 v66, v62, v63
    v_cvt_pk_bf16_f32 v74, v70, v71
    v_cvt_pk_bf16_f32 v82, v78, v79
    v_cvt_pk_bf16_f32 v90, v86, v87
    ds_write_addtid_b32 v66 offset:8704
    ds_write_addtid_b32 v74 offset:10880
    ds_write_addtid_b32 v82 offset:13056
    ds_write_addtid_b32 v90 offset:15232
    s_branch KG_JOIN2
KG_ROWS2:
    v_mul_f32 v26, v18, v7
    v_mul_f32 v27, v19, v7
    v_add_f32 v26, v26, v26
    v_add_f32 v27, v27, v27
    v_exp_f32 v64, v24
    v_mov_b32 v74, 4.0
    v_mov_b32 v82, 256.0
    v_mov_b32 v90, 512.0
    v_fract_f32 v65, v25
    v_mul_f32 v72, v74, v24
    v_mul_f32 v80, v82, v24
    v_mul_f32 v88, v90, v24
    s_nop 0
    v_mul_f32 v73, v74, v25
    v_mul_f32 v81, v82, v25
    v_mul_f32 v89, v90, v25
    v_cos_f32 v66, v65
    v_exp_f32 v72, v72
    v_exp_f32 v80, v80
    v_exp_f32 v88, v88
    v_sin_f32 v67, v65
    v_fract_f32 v73, v73
    v_fract_f32 v81, v81
    v_fract_f32 v89, v89
    s_nop 0
    s_nop 0
    s_nop 0
    s_nop 0
    v_mul_f32 v28, v64, v66
    v_cos_f32 v74, v73
    v_cos_f32 v82, v81
    v_cos_f32 v90, v89
    v_mul_f32 v29, v64, v67
    v_sin_f32 v75, v73
    v_sin_f32 v83, v81
    v_sin_f32 v91, v89
    v_pk_mul_f32 v[64:65], v[28:29], v[28:29] op_sel:[1,1] op_sel_hi:[1,0] neg_lo:[0,1]
    s_nop 0
    s_nop 0
    s_nop 0
    v_pk_fma_f32 v[30:31], v[28:29], v[28:29], v[64:65] op_sel:[0,0,0] op_sel_hi:[0,1,1]
    v_mul_f32 v32, v72, v74
    v_mul_f32 v36, v80, v82
    v_mul_f32 v40, v88, v90
    v_mul_f32 v33, v72, v75
    v_mul_f32 v37, v80, v83
    v_mul_f32 v41, v88, v91
    v_pk_mul_f32 v[88:89], v[40:41], v[40:41] op_sel:[1,1] op_sel_hi:[1,0] neg_lo:[0,1]
    v_pk_fma_f32 v[42:43], v[40:41], v[40:41], v[88:89] op_sel:[0,0,0] op_sel_hi:[0,1,1]
    v_cvt_pk_bf16_f32 v66, v26, v27
    v_pk_mul_f32 v[72:73], v[26:27], v[32:33] op_sel:[1,1] op_sel_hi:[1,0] neg_lo:[0,1]
    v_pk_mul_f32 v[80:81], v[26:27], v[36:37] op_sel:[1,1] op_sel_hi:[1,0] neg_lo:[0,1]
    v_pk_mul_f32 v[88:89], v[26:27], v[40:41] op_sel:[1,1] op_sel_hi:[1,0] neg_lo:[0,1]
    ds_write_addtid_b32 v66 offset:0
    v_pk_fma_f32 v[68:69], v[26:27], v[32:33], v[72:73] op_sel:[0,0,0] op_sel_hi:[0,1,1]
    v_pk_fma_f32 v[76:77], v[26:27], v[36:37], v[80:81] op_sel:[0,0,0] op_sel_hi:[0,1,1]
    v_pk_fma_f32 v[84:85], v[26:27], v[40:41], v[88:89] op_sel:[0,0,0] op_sel_hi:[0,1,1]
    v_pk_mul_f32 v[64:65], v[26:27], v[28:29] op_sel:[1,1] op_sel_hi:[1,0] neg_lo:[0,1]
    v_cvt_pk_bf16_f32 v74, v68, v69
    v_cvt_pk_bf16_f32 v82, v76, v77
    v_cvt_pk_bf16_f32 v90, v84, v85
    v_pk_fma_f32 v[60:61], v[26:27], v[28:29], v[64:65] op_sel:[0,0,0] op_sel_hi:[0,1,1]
    ds_write_addtid_b32 v74 offset:1088
    ds_write_addtid_b32 v82 offset:2176
    ds_write_addtid_b32 v90 offset:2720
    v_cvt_pk_bf16_f32 v66, v60, v61
    v_pk_mul_f32 v[72:73], v[68:69], v[28:29] op_sel:[1,1] op_sel_hi:[1,0] neg_lo:[0,1]
    v_pk_mul_f32 v[80:81], v[76:77], v[30:31] op_sel:[1,1] op_sel_hi:[1,0] neg_lo:[0,1]
    v_pk_mul_f32 v[88:89], v[84:85], v[32:33] op_sel:[1,1] op_sel_hi:[1,0] neg_lo:[0,1]
    ds_write_addtid_b32 v66 offset:272
    v_pk_fma_f32 v[70:71], v[68:69], v[28:29], v[72:73] op_sel:[0,0,0] op_sel_hi:[0,1,1]
    v_pk_fma_f32 v[78:79], v[76:77], v[30:31], v[80:81] op_sel:[0,0,0] op_sel_hi:[0,1,1]
    v_pk_fma_f32 v[86:87], v[84:85], v[32:33], v[88:89] op_sel:[0,0,0] op_sel_hi:[0,1,1]
    v_pk_mul_f32 v[64:65], v[60:61], v[28:29] op_sel:[1,1] op_sel_hi:[1,0] neg_lo:[0,1]
    v_cvt_pk_bf16_f32 v74, v70, v71
    v_cvt_pk_bf16_f32 v82, v78, v79
    v_cvt_pk_bf16_f32 v90, v86, v87
    v_pk_fma_f32 v[62:63], v[60:61], v[28:29], v[64:65] op_sel:[0,0,0] op_sel_hi:[0,1,1]
    ds_write_addtid_b32 v74 offset:1360
    ds_write_addtid_b32 v82 offset:2448
    ds_write_addtid_b32 v90 offset:3808
    v_cvt_pk_bf16_f32 v66, v62, v63
    v_pk_mul_f32 v[72:73], v[70:71], v[28:29] op_sel:[1,1] op_sel_hi:[1,0] neg_lo:[0,1]
    v_pk_mul_f32 v[80:81], v[78:79], v[30:31] op_sel:[1,1] op_sel_hi:[1,0] neg_lo:[0,1]
    v_pk_mul_f32 v[88:89], v[84:85], v[36:37] op_sel:[1,1] op_sel_hi:[1,0] neg_lo:[0,1]
    ds_write_addtid_b32 v66 offset:544
    v_pk_fma_f32 v[68:69], v[70:71], v[28:29], v[72:73] op_sel:[0,0,0] op_sel_hi:[0,1,1]
    v_pk_fma_f32 v[76:77], v[78:79], v[30:31], v[80:81] op_sel:[0,0,0] op_sel_hi:[0,1,1]
    v_pk_fma_f32 v[86:87], v[84:85], v[36:37], v[88:89] op_sel:[0,0,0] op_sel_hi:[0,1,1]
    v_pk_mul_f32 v[64:65], v[62:63], v[28:29] op_sel:[1,1] op_sel_hi:[1,0] neg_lo:[0,1]
    v_cvt_pk_bf16_f32 v74, v68, v69
    v_cvt_pk_bf16_f32 v82, v76, v77
    v_cvt_pk_bf16_f32 v90, v86, v87
    v_pk_fma_f32 v[60:61], v[62:63], v[28:29], v[64:65] op_sel:[0,0,0] op_sel_hi:[0,1,1]
    ds_write_addtid_b32 v74 offset:1632
    ds_write_addtid_b32 v82 offset:3264
    ds_write_addtid_b32 v90 offset:2992
    v_cvt_pk_bf16_f32 v66, v60, v61
    v_pk_mul_f32 v[72:73], v[68:69], v[28:29] op_sel:[1,1] op_sel_hi:[1,0] neg_lo:[0,1]
    v_pk_mul_f32 v[80:81], v[76:77], v[30:31] op_sel:[1,1] op_sel_hi:[1,0] neg_lo:[0,1]
    v_pk_mul_f32 v[88:89], v[86:87], v[32:33] op_sel:[1,1] op_sel_hi:[1,0] neg_lo:[0,1]
    ds_write_addtid_b32 v66 offset:816
    v_pk_fma_f32 v[70:71], v[68:69], v[28:29], v[72:73] op_sel:[0,0,0] op_sel_hi:[0,1,1]
    v_pk_fma_f32 v[78:79], v[76:77], v[30:31], v[80:81] op_sel:[0,0,0] op_sel_hi:[0,1,1]
    v_pk_fma_f32 v[34:35], v[86:87], v[32:33], v[88:89] op_sel:[0,0,0] op_sel_hi:[0,1,1]
    v_pk_mul_f32 v[64:65], v[26:27], v[42:43] op_sel:[1,1] op_sel_hi:[1,0] neg_lo:[0,1]
    v_cvt_pk_bf16_f32 v74, v70, v71
    v_cvt_pk_bf16_f32 v82, v78, v79
    v_cvt_pk_bf16_f32 v90, v34, v35
    v_pk_fma_f32 v[62:63], v[26:27], v[42:43], v[64:65] op_sel:[0,0,0] op_sel_hi:[0,1,1]
    ds_write_addtid_b32 v74 offset:1904
    ds_write_addtid_b32 v82 offset:3536
    ds_write_addtid_b32 v90 offset:4080
    v_cvt_pk_bf16_f32 v66, v62, v63
    v_pk_mul_f32 v[88:89], v[84:85], v[42:43] op_sel:[1,1] op_sel_hi:[1,0] neg_lo:[0,1]
    ds_write_addtid_b32 v66 offset:4352
    v_pk_fma_f32 v[34:35], v[84:85], v[42:43], v[88:89] op_sel:[0,0,0] op_sel_hi:[0,1,1]
    v_pk_mul_f32 v[64:65], v[62:63], v[36:37] op_sel:[1,1] op_sel_hi:[1,0] neg_lo:[0,1]
    v_cvt_pk_bf16_f32 v90, v34, v35
    v_pk_fma_f32 v[60:61], v[62:63], v[36:37], v[64:65] op_sel:[0,0,0] op_sel_hi:[0,1,1]
    ds_write_addtid_b32 v90 offset:4896
    v_cvt_pk_bf16_f32 v66, v60, v61
    v_pk_mul_f32 v[88:89], v[86:87], v[42:43] op_sel:[1,1] op_sel_hi:[1,0] neg_lo:[0,1]
    ds_write_addtid_b32 v66 offset:4624
    v_pk_fma_f32 v[34:35], v[86:87], v[42:43], v[88:89] op_sel:[0,0,0] op_sel_hi:[0,1,1]
    v_pk_mul_f32 v[64:65], v[62:63], v[42:43] op_sel:[1,1] op_sel_hi:[1,0] neg_lo:[0,1]
    v_cvt_pk_bf16_f32 v90, v34, v35
    v_pk_fma_f32 v[60:61], v[62:63], v[42:43], v[64:65] op_sel:[0,0,0] op_sel_hi:[0,1,1]
    ds_write_addtid_b32 v90 offset:5168
    v_cvt_pk_bf16_f32 v66, v60, v61
    ds_write_addtid_b32 v66 offset:6528
KG_JOIN2:
    s_waitcnt lgkmcnt(0)
    s_barrier
    ds_read_b128 v[60:63], v21 offset:0
    ds_read_b128 v[76:79], v21 offset:6800
    ds_read_b128 v[64:67], v21 offset:32
    ds_read_b128 v[80:83], v21 offset:6832
    ds_read_b128 v[68:71], v21 offset:64
    ds_read_b128 v[84:87], v21 offset:6864
    ds_read_b128 v[72:75], v21 offset:96
    ds_read_b128 v[88:91], v21 offset:6896
    s_waitcnt lgkmcnt(6)
    v_mfma_f32_32x32x16_bf16 v[44:59], v[60:63], v[76:79], v[44:59]
    s_waitcnt lgkmcnt(4)
    v_mfma_f32_32x32x16_bf16 v[44:59], v[64:67], v[80:83], v[44:59]
    s_waitcnt lgkmcnt(2)
    v_mfma_f32_32x32x16_bf16 v[44:59], v[68:71], v[84:87], v[44:59]
    s_waitcnt lgkmcnt(0)
    v_mfma_f32_32x32x16_bf16 v[44:59], v[72:75], v[88:91], v[44:59]
    s_barrier
    v_and_b32 v22, 31, v1
    v_lshlrev_b32 v22, 5, v22
    v_lshrrev_b32 v23, 5, v1
    v_lshl_add_u32 v22, v23, 4, v22
    v_add_u32 v22, s15, v22
    v_lshlrev_b32 v23, 3, v1
    s_lshl_b32 s5, s89, 10
    v_add_u32 v23, s5, v23
    v_cvt_f32_u32 v23, v23
    v_add_f32 v24, 0.0, v23
    v_add_f32 v25, 1.0, v23
    v_cvt_pk_bf16_f32 v24, v24, v25
    v_lshlrev_b32 v25, 16, v24
    v_and_b32 v24, s85, v24
    v_cvt_u32_f32 v25, v25
    v_cvt_u32_f32 v24, v24
    v_lshl_add_u32 v60, v25, 2, s15
    v_lshl_add_u32 v61, v24, 2, s15
    v_add_f32 v24, 2.0, v23
    v_add_f32 v25, 3.0, v23
    v_cvt_pk_bf16_f32 v24, v24, v25
    v_lshlrev_b32 v25, 16, v24
    v_and_b32 v24, s85, v24
    v_cvt_u32_f32 v25, v25
    v_cvt_u32_f32 v24, v24
    v_lshl_add_u32 v62, v25, 2, s15
    v_lshl_add_u32 v63, v24, 2, s15
    v_add_f32 v24, 4.0, v23
    v_add_f32 v25, 5.0, v23
    v_cvt_pk_bf16_f32 v24, v24, v25
    v_lshlrev_b32 v25, 16, v24
    v_and_b32 v24, s85, v24
    v_cvt_u32_f32 v25, v25
    v_cvt_u32_f32 v24, v24
    v_lshl_add_u32 v64, v25, 2, s15
    v_lshl_add_u32 v65, v24, 2, s15
    v_add_f32 v24, 6.0, v23
    v_add_f32 v25, 7.0, v23
    v_cvt_pk_bf16_f32 v24, v24, v25
    v_lshlrev_b32 v25, 16, v24
    v_and_b32 v24, s85, v24
    v_cvt_u32_f32 v25, v25
    v_cvt_u32_f32 v24, v24
    v_lshl_add_u32 v66, v25, 2, s15
    v_lshl_add_u32 v67, v24, 2, s15
    v_add_f32 v24, 512.0, v23
    v_add_f32 v25, 513.0, v23
    v_cvt_pk_bf16_f32 v24, v24, v25
    v_lshlrev_b32 v25, 16, v24
    v_and_b32 v24, s85, v24
    v_cvt_u32_f32 v25, v25
    v_cvt_u32_f32 v24, v24
    v_lshl_add_u32 v68, v25, 2, s15
    v_lshl_add_u32 v69, v24, 2, s15
    v_add_f32 v24, 514.0, v23
    v_add_f32 v25, 515.0, v23
    v_cvt_pk_bf16_f32 v24, v24, v25
    v_lshlrev_b32 v25, 16, v24
    v_and_b32 v24, s85, v24
    v_cvt_u32_f32 v25, v25
    v_cvt_u32_f32 v24, v24
    v_lshl_add_u32 v70, v25, 2, s15
    v_lshl_add_u32 v71, v24, 2, s15
    v_add_f32 v24, 516.0, v23
    v_add_f32 v25, 517.0, v23
    v_cvt_pk_bf16_f32 v24, v24, v25
    v_lshlrev_b32 v25, 16, v24
    v_and_b32 v24, s85, v24
    v_cvt_u32_f32 v25, v25
    v_cvt_u32_f32 v24, v24
    v_lshl_add_u32 v72, v25, 2, s15
    v_lshl_add_u32 v73, v24, 2, s15
    v_add_f32 v24, 518.0, v23
    v_add_f32 v25, 519.0, v23
    v_cvt_pk_bf16_f32 v24, v24, v25
    v_lshlrev_b32 v25, 16, v24
    v_and_b32 v24, s85, v24
    v_cvt_u32_f32 v25, v25
    v_cvt_u32_f32 v24, v24
    v_lshl_add_u32 v74, v25, 2, s15
    v_lshl_add_u32 v75, v24, 2, s15
    s_cmp_eq_u32 s89, 0
    s_cbranch_scc1 KG_K1
    ds_write_addtid_b32 v44 offset:9728
    ds_write_addtid_b32 v45 offset:9984
    ds_write_addtid_b32 v46 offset:10240
    ds_write_addtid_b32 v47 offset:10496
    ds_write_addtid_b32 v48 offset:10752
    ds_write_addtid_b32 v49 offset:11008
    ds_write_addtid_b32 v50 offset:11264
    ds_write_addtid_b32 v51 offset:11520
    ds_write_addtid_b32 v52 offset:11776
    ds_write_addtid_b32 v53 offset:12032
    ds_write_addtid_b32 v54 offset:12288
    ds_write_addtid_b32 v55 offset:12544
    ds_write_addtid_b32 v56 offset:12800
    s_waitcnt lgkmcnt(0)
KG_K1:
    s_barrier
    s_cmp_lg_u32 s89, 0
    s_cbranch_scc1 KG_K2
    ds_read_b32 v76, v20 offset:9728
    ds_read_b32 v77, v20 offset:9984
    ds_read_b32 v78, v20 offset:10240
    ds_read_b32 v79, v20 offset:10496
    ds_read_b32 v80, v20 offset:10752
    ds_read_b32 v81, v20 offset:11008
    ds_read_b32 v82, v20 offset:11264
    ds_read_b32 v83, v20 offset:11520
    ds_read_b32 v84, v20 offset:11776
    ds_read_b32 v85, v20 offset:12032
    ds_read_b32 v86, v20 offset:12288
    ds_read_b32 v87, v20 offset:12544
    ds_read_b32 v88, v20 offset:12800
    s_waitcnt lgkmcnt(12)
    v_add_f32 v44, v44, v76
    ds_write_b32 v22, v44 offset:0
    s_waitcnt lgkmcnt(11)
    v_add_f32 v45, v45, v77
    ds_write_b32 v22, v45 offset:4
    s_waitcnt lgkmcnt(10)
    v_add_f32 v46, v46, v78
    ds_write_b32 v22, v46 offset:8
    s_waitcnt lgkmcnt(9)
    v_add_f32 v47, v47, v79
    ds_write_b32 v22, v47 offset:12
    s_waitcnt lgkmcnt(8)
    v_add_f32 v48, v48, v80
    ds_write_b32 v22, v48 offset:1024
    s_waitcnt lgkmcnt(7)
    v_add_f32 v49, v49, v81
    ds_write_b32 v22, v49 offset:1032
    s_waitcnt lgkmcnt(6)
    v_add_f32 v50, v50, v82
    ds_write_b32 v22, v50 offset:2048
    s_waitcnt lgkmcnt(5)
    v_add_f32 v51, v51, v83
    ds_write_b32 v22, v51 offset:3072
    s_waitcnt lgkmcnt(4)
    v_add_f32 v52, v52, v84
    ds_write_b32 v22, v52 offset:4096
    s_waitcnt lgkmcnt(3)
    v_add_f32 v53, v53, v85
    ds_write_b32 v22, v53 offset:5120
    s_waitcnt lgkmcnt(2)
    v_add_f32 v54, v54, v86
    ds_write_b32 v22, v54 offset:6144
    s_waitcnt lgkmcnt(1)
    v_add_f32 v55, v55, v87
    ds_write_b32 v22, v55 offset:7168
    s_waitcnt lgkmcnt(0)
    v_add_f32 v56, v56, v88
    ds_write_b32 v22, v56 offset:8192
    s_waitcnt lgkmcnt(0)
KG_K2:
    s_barrier
    ds_read_b32 v76, v60
    ds_read_b32 v77, v61
    ds_read_b32 v78, v62
    ds_read_b32 v79, v63
    ds_read_b32 v80, v64
    ds_read_b32 v81, v65
    ds_read_b32 v82, v66
    ds_read_b32 v83, v67
    ds_read_b32 v84, v68
    ds_read_b32 v85, v69
    ds_read_b32 v86, v70
    ds_read_b32 v87, v71
    ds_read_b32 v88, v72
    ds_read_b32 v89, v73
    ds_read_b32 v90, v74
    ds_read_b32 v91, v75
    s_lshl_b32 s5, s89, 11
    s_add_u32 s5, s5, s15
    v_lshl_add_u32 v26, v1, 4, s5
    v_lshl_add_u32 v27, v1, 4, s15
    v_mov_b32 v28, 0
    v_mov_b32 v29, 0
    v_mov_b32 v30, 0
    v_mov_b32 v31, 0
    v_cmp_gt_u32 vcc, 32, v1
    s_and_saveexec_b64 s[6:7], vcc
    ds_write_b128 v27, v[28:31] offset:10880
    s_mov_b64 exec, s[6:7]
    s_waitcnt lgkmcnt(9)
    v_cvt_pk_bf16_f32 v32, v83, v82
    v_cvt_pk_bf16_f32 v33, v81, v80
    v_cvt_pk_bf16_f32 v34, v79, v78
    v_cvt_pk_bf16_f32 v35, v77, v76
    ds_write_b128 v26, v[32:35] offset:11392
    s_waitcnt lgkmcnt(1)
    v_cvt_pk_bf16_f32 v36, v91, v90
    v_cvt_pk_bf16_f32 v37, v89, v88
    v_cvt_pk_bf16_f32 v38, v87, v86
    v_cvt_pk_bf16_f32 v39, v85, v84
    ds_write_b128 v26, v[36:39] offset:12416
    s_add_u32 s44, s40, 9437184
    s_addc_u32 s45, s41, 0
    s_and_b32 s45, s45, 0xffff
    s_mov_b32 s46, 2621440
    s_mov_b32 s47, 0x00020000
    s_mov_b32 s52, s36
    s_and_b32 s53, s37, 0xffff
    s_mov_b32 s54, 5242880
    s_mov_b32 s55, 0x00020000
    s_mov_b32 s56, s34
    s_and_b32 s57, s35, 0xffff
    s_mov_b32 s58, 1280
    s_mov_b32 s59, 0x00020000
    s_lshl_b32 s5, s14, 1
    v_mov_b32 v10, s5
    buffer_load_ushort v7, v10, s[56:59], 0 offen
    s_lshr_b32 s5, s14, 6
    s_lshl_b32 s5, s5, 2
    s_add_u32 s5, s5, 64
    v_mov_b32 v11, s5
    s_cmp_lg_u32 s3, 0
    s_cbranch_scc1 CV_GO
CV_SPIN:
    buffer_load_dword v10, v11, s[60:63], 0 offen sc1
    s_waitcnt vmcnt(0)
    v_readfirstlane_b32 s5, v10
    s_cmp_ge_u32 s5, 32
    s_cbranch_scc1 CV_GO
    s_sleep 8
    s_branch CV_SPIN
CV_GO:
    s_barrier
    s_mul_i32 s13, s88, 4128
    s_add_u32 s13, s13, 62016
    v_lshlrev_b32 v10, 4, v1
    s_lshl_b32 s5, s14, 12
    s_lshl_b32 s6, s89, 11
    s_add_u32 s5, s5, s6
    buffer_load_dwordx4 v[16:19], v10, s[44:47], s5 offen sc1
    buffer_load_dwordx4 v[20:23], v10, s[44:47], s5 offen offset:1024 sc1
    s_add_u32 s6, s6, s13
    v_add_u32 v12, s6, v10
    v_lshrrev_b32 v10, 1, v2
    v_and_b32 v11, 1, v2
    v_sub_u32 v13, v3, v10
    v_lshlrev_b32 v13, 5, v13
    v_lshl_add_u32 v13, v11, 4, v13
    s_lshl_b32 s5, s89, 8
    s_sub_u32 s5, s15, s5
    s_add_u32 s5, s5, 11200
    v_add_u32 v4, s5, v13
    v_lshl_add_u32 v13, v10, 4, v3
    v_lshlrev_b32 v14, 3, v11
    v_sub_u32 v13, v13, v14
    v_add_u32 v13, 9, v13
    v_and_b32 v6, 1, v13
    v_lshlrev_b32 v6, 4, v6
    v_lshrrev_b32 v13, 1, v13
    s_lshl_b32 s5, s89, 8
    s_add_u32 s5, s5, s13
    v_lshl_add_u32 v5, v13, 2, s5
    v_lshlrev_b32 v13, 5, v3
    v_lshl_add_u32 v13, v2, 3, v13
    s_lshl_b32 s5, s89, 11
    s_add_u32 s5, s5, s13
    v_add_u32 v8, s5, v13
    v_lshl_add_u32 v13, v2, 6, v3
    v_lshlrev_b32 v13, 3, v13
    s_lshl_b32 s5, s88, 1
    s_lshl_b32 s6, s89, 13
    s_add_u32 s5, s5, s6
    v_add_u32 v9, s5, v13
    v_mov_b32 v10, 0
    v_lshl_add_u32 v11, v1, 2, s13
    v_cmp_gt_u32 vcc, 8, v1
    s_and_saveexec_b64 s[6:7], vcc
    ds_write_b32 v11, v10
    s_mov_b64 exec, s[6:7]
    s_waitcnt vmcnt(1)
    ds_write_b128 v12, v[16:19] offset:32
    s_waitcnt vmcnt(0)
    ds_write_b128 v12, v[20:23] offset:1056
    s_waitcnt lgkmcnt(0)
    s_barrier
    ds_read_b128 v[48:51], v4 offset:192
    ds_read_b128 v[52:55], v4 offset:704
    ds_read_b128 v[56:59], v4 offset:1216
    ds_read_b128 v[60:63], v4 offset:1728
    ds_read_b128 v[64:67], v4 offset:2240
    ds_read_b128 v[68:71], v4 offset:2752
    ds_read_b128 v[72:75], v4 offset:3264
    ds_read_b128 v[76:79], v4 offset:3776
    v_add_u32 v85, 0, v5
    ds_read2_b32 v[80:81], v85 offset0:0 offset1:1
    ds_read2_b32 v[82:83], v85 offset0:2 offset1:3
    ds_read_b32 v84, v85 offset:16
    v_add_u32 v91, 512, v5
    ds_read2_b32 v[86:87], v91 offset0:0 offset1:1
    ds_read2_b32 v[88:89], v91 offset0:2 offset1:3
    ds_read_b32 v90, v91 offset:16
    v_add_u32 v97, 1024, v5
    ds_read2_b32 v[92:93], v97 offset0:0 offset1:1
    ds_read2_b32 v[94:95], v97 offset0:2 offset1:3
    ds_read_b32 v96, v97 offset:16
    v_add_u32 v103, 1536, v5
    ds_read2_b32 v[98:99], v103 offset0:0 offset1:1
    ds_read2_b32 v[100:101], v103 offset0:2 offset1:3
    ds_read_b32 v102, v103 offset:16
    v_add_u32 v109, 2048, v5
    ds_read2_b32 v[104:105], v109 offset0:0 offset1:1
    ds_read2_b32 v[106:107], v109 offset0:2 offset1:3
    ds_read_b32 v108, v109 offset:16
    v_add_u32 v115, 2560, v5
    ds_read2_b32 v[110:111], v115 offset0:0 offset1:1
    ds_read2_b32 v[112:113], v115 offset0:2 offset1:3
    ds_read_b32 v114, v115 offset:16
    v_add_u32 v121, 3072, v5
    ds_read2_b32 v[116:117], v121 offset0:0 offset1:1
    ds_read2_b32 v[118:119], v121 offset0:2 offset1:3
    ds_read_b32 v120, v121 offset:16
    s_waitcnt lgkmcnt(15)
    v_alignbit_b32 v80, v81, v80, v6
    v_alignbit_b32 v81, v82, v81, v6
    v_alignbit_b32 v82, v83, v82, v6
    v_alignbit_b32 v83, v84, v83, v6
    s_nop 1
    v_mfma_f32_16x16x32_bf16 v[16:19], v[80:83], v[48:51], 0
    v_mfma_f32_16x16x32_bf16 v[20:23], v[80:83], v[52:55], 0
    v_mfma_f32_16x16x32_bf16 v[24:27], v[80:83], v[56:59], 0
    v_mfma_f32_16x16x32_bf16 v[28:31], v[80:83], v[60:63], 0
    v_mfma_f32_16x16x32_bf16 v[32:35], v[80:83], v[64:67], 0
    v_mfma_f32_16x16x32_bf16 v[36:39], v[80:83], v[68:71], 0
    v_mfma_f32_16x16x32_bf16 v[40:43], v[80:83], v[72:75], 0
    v_mfma_f32_16x16x32_bf16 v[44:47], v[80:83], v[76:79], 0
    v_add_u32 v85, 3584, v5
    ds_read2_b32 v[80:81], v85 offset0:0 offset1:1
    ds_read2_b32 v[82:83], v85 offset0:2 offset1:3
    ds_read_b32 v84, v85 offset:16
    s_waitcnt lgkmcnt(15)
    v_alignbit_b32 v86, v87, v86, v6
    v_alignbit_b32 v87, v88, v87, v6
    v_alignbit_b32 v88, v89, v88, v6
    v_alignbit_b32 v89, v90, v89, v6
    s_nop 1
    v_mfma_f32_16x16x32_bf16 v[20:23], v[86:89], v[48:51], v[20:23]
    v_mfma_f32_16x16x32_bf16 v[24:27], v[86:89], v[52:55], v[24:27]
    v_mfma_f32_16x16x32_bf16 v[28:31], v[86:89], v[56:59], v[28:31]
    v_mfma_f32_16x16x32_bf16 v[32:35], v[86:89], v[60:63], v[32:35]
    v_mfma_f32_16x16x32_bf16 v[36:39], v[86:89], v[64:67], v[36:39]
    v_mfma_f32_16x16x32_bf16 v[40:43], v[86:89], v[68:71], v[40:43]
    v_mfma_f32_16x16x32_bf16 v[44:47], v[86:89], v[72:75], v[44:47]
    s_waitcnt lgkmcnt(12)
    v_alignbit_b32 v92, v93, v92, v6
    v_alignbit_b32 v93, v94, v93, v6
    v_alignbit_b32 v94, v95, v94, v6
    v_alignbit_b32 v95, v96, v95, v6
    s_nop 1
    v_mfma_f32_16x16x32_bf16 v[24:27], v[92:95], v[48:51], v[24:27]
    v_mfma_f32_16x16x32_bf16 v[28:31], v[92:95], v[52:55], v[28:31]
    v_mfma_f32_16x16x32_bf16 v[32:35], v[92:95], v[56:59], v[32:35]
    v_mfma_f32_16x16x32_bf16 v[36:39], v[92:95], v[60:63], v[36:39]
    v_mfma_f32_16x16x32_bf16 v[40:43], v[92:95], v[64:67], v[40:43]
    v_mfma_f32_16x16x32_bf16 v[44:47], v[92:95], v[68:71], v[44:47]
    s_waitcnt lgkmcnt(9)
    v_alignbit_b32 v98, v99, v98, v6
    v_alignbit_b32 v99, v100, v99, v6
    v_alignbit_b32 v100, v101, v100, v6
    v_alignbit_b32 v101, v102, v101, v6
    s_nop 1
    v_mfma_f32_16x16x32_bf16 v[28:31], v[98:101], v[48:51], v[28:31]
    v_mfma_f32_16x16x32_bf16 v[32:35], v[98:101], v[52:55], v[32:35]
    v_mfma_f32_16x16x32_bf16 v[36:39], v[98:101], v[56:59], v[36:39]
    v_mfma_f32_16x16x32_bf16 v[40:43], v[98:101], v[60:63], v[40:43]
    v_mfma_f32_16x16x32_bf16 v[44:47], v[98:101], v[64:67], v[44:47]
    s_waitcnt lgkmcnt(6)
    v_alignbit_b32 v104, v105, v104, v6
    v_alignbit_b32 v105, v106, v105, v6
    v_alignbit_b32 v106, v107, v106, v6
    v_alignbit_b32 v107, v108, v107, v6
    s_nop 1
    v_mfma_f32_16x16x32_bf16 v[32:35], v[104:107], v[48:51], v[32:35]
    v_mfma_f32_16x16x32_bf16 v[36:39], v[104:107], v[52:55], v[36:39]
    v_mfma_f32_16x16x32_bf16 v[40:43], v[104:107], v[56:59], v[40:43]
    v_mfma_f32_16x16x32_bf16 v[44:47], v[104:107], v[60:63], v[44:47]
    s_waitcnt lgkmcnt(3)
    v_alignbit_b32 v110, v111, v110, v6
    v_alignbit_b32 v111, v112, v111, v6
    v_alignbit_b32 v112, v113, v112, v6
    v_alignbit_b32 v113, v114, v113, v6
    s_nop 1
    v_mfma_f32_16x16x32_bf16 v[36:39], v[110:113], v[48:51], v[36:39]
    v_mfma_f32_16x16x32_bf16 v[40:43], v[110:113], v[52:55], v[40:43]
    v_mfma_f32_16x16x32_bf16 v[44:47], v[110:113], v[56:59], v[44:47]
    s_waitcnt lgkmcnt(0)
    v_alignbit_b32 v116, v117, v116, v6
    v_alignbit_b32 v117, v118, v117, v6
    v_alignbit_b32 v118, v119, v118, v6
    v_alignbit_b32 v119, v120, v119, v6
    s_nop 1
    v_mfma_f32_16x16x32_bf16 v[40:43], v[116:119], v[48:51], v[40:43]
    v_mfma_f32_16x16x32_bf16 v[44:47], v[116:119], v[52:55], v[44:47]
    s_waitcnt lgkmcnt(0)
    v_alignbit_b32 v80, v81, v80, v6
    v_alignbit_b32 v81, v82, v81, v6
    v_alignbit_b32 v82, v83, v82, v6
    v_alignbit_b32 v83, v84, v83, v6
    s_nop 1
    v_mfma_f32_16x16x32_bf16 v[44:47], v[80:83], v[48:51], v[44:47]
    ds_read_b128 v[48:51], v4 offset:128
    ds_read_b128 v[52:55], v4 offset:640
    ds_read_b128 v[56:59], v4 offset:1152
    ds_read_b128 v[60:63], v4 offset:1664
    ds_read_b128 v[64:67], v4 offset:2176
    ds_read_b128 v[68:71], v4 offset:2688
    ds_read_b128 v[72:75], v4 offset:3200
    ds_read_b128 v[76:79], v4 offset:3712
    v_add_u32 v85, 64, v5
    ds_read2_b32 v[80:81], v85 offset0:0 offset1:1
    ds_read2_b32 v[82:83], v85 offset0:2 offset1:3
    ds_read_b32 v84, v85 offset:16
    v_add_u32 v91, 576, v5
    ds_read2_b32 v[86:87], v91 offset0:0 offset1:1
    ds_read2_b32 v[88:89], v91 offset0:2 offset1:3
    ds_read_b32 v90, v91 offset:16
    v_add_u32 v97, 1088, v5
    ds_read2_b32 v[92:93], v97 offset0:0 offset1:1
    ds_read2_b32 v[94:95], v97 offset0:2 offset1:3
    ds_read_b32 v96, v97 offset:16
    v_add_u32 v103, 1600, v5
    ds_read2_b32 v[98:99], v103 offset0:0 offset1:1
    ds_read2_b32 v[100:101], v103 offset0:2 offset1:3
    ds_read_b32 v102, v103 offset:16
    v_add_u32 v109, 2112, v5
    ds_read2_b32 v[104:105], v109 offset0:0 offset1:1
    ds_read2_b32 v[106:107], v109 offset0:2 offset1:3
    ds_read_b32 v108, v109 offset:16
    v_add_u32 v115, 2624, v5
    ds_read2_b32 v[110:111], v115 offset0:0 offset1:1
    ds_read2_b32 v[112:113], v115 offset0:2 offset1:3
    ds_read_b32 v114, v115 offset:16
    v_add_u32 v121, 3136, v5
    ds_read2_b32 v[116:117], v121 offset0:0 offset1:1
    ds_read2_b32 v[118:119], v121 offset0:2 offset1:3
    ds_read_b32 v120, v121 offset:16
    s_waitcnt lgkmcnt(15)
    v_alignbit_b32 v80, v81, v80, v6
    v_alignbit_b32 v81, v82, v81, v6
    v_alignbit_b32 v82, v83, v82, v6
    v_alignbit_b32 v83, v84, v83, v6
    s_nop 1
    v_mfma_f32_16x16x32_bf16 v[16:19], v[80:83], v[48:51], v[16:19]
    v_mfma_f32_16x16x32_bf16 v[20:23], v[80:83], v[52:55], v[20:23]
    v_mfma_f32_16x16x32_bf16 v[24:27], v[80:83], v[56:59], v[24:27]
    v_mfma_f32_16x16x32_bf16 v[28:31], v[80:83], v[60:63], v[28:31]
    v_mfma_f32_16x16x32_bf16 v[32:35], v[80:83], v[64:67], v[32:35]
    v_mfma_f32_16x16x32_bf16 v[36:39], v[80:83], v[68:71], v[36:39]
    v_mfma_f32_16x16x32_bf16 v[40:43], v[80:83], v[72:75], v[40:43]
    v_mfma_f32_16x16x32_bf16 v[44:47], v[80:83], v[76:79], v[44:47]
    v_add_u32 v85, 3648, v5
    ds_read2_b32 v[80:81], v85 offset0:0 offset1:1
    ds_read2_b32 v[82:83], v85 offset0:2 offset1:3
    ds_read_b32 v84, v85 offset:16
    s_waitcnt lgkmcnt(15)
    v_alignbit_b32 v86, v87, v86, v6
    v_alignbit_b32 v87, v88, v87, v6
    v_alignbit_b32 v88, v89, v88, v6
    v_alignbit_b32 v89, v90, v89, v6
    s_nop 1
    v_mfma_f32_16x16x32_bf16 v[20:23], v[86:89], v[48:51], v[20:23]
    v_mfma_f32_16x16x32_bf16 v[24:27], v[86:89], v[52:55], v[24:27]
    v_mfma_f32_16x16x32_bf16 v[28:31], v[86:89], v[56:59], v[28:31]
    v_mfma_f32_16x16x32_bf16 v[32:35], v[86:89], v[60:63], v[32:35]
    v_mfma_f32_16x16x32_bf16 v[36:39], v[86:89], v[64:67], v[36:39]
    v_mfma_f32_16x16x32_bf16 v[40:43], v[86:89], v[68:71], v[40:43]
    v_mfma_f32_16x16x32_bf16 v[44:47], v[86:89], v[72:75], v[44:47]
    s_waitcnt lgkmcnt(12)
    v_alignbit_b32 v92, v93, v92, v6
    v_alignbit_b32 v93, v94, v93, v6
    v_alignbit_b32 v94, v95, v94, v6
    v_alignbit_b32 v95, v96, v95, v6
    s_nop 1
    v_mfma_f32_16x16x32_bf16 v[24:27], v[92:95], v[48:51], v[24:27]
    v_mfma_f32_16x16x32_bf16 v[28:31], v[92:95], v[52:55], v[28:31]
    v_mfma_f32_16x16x32_bf16 v[32:35], v[92:95], v[56:59], v[32:35]
    v_mfma_f32_16x16x32_bf16 v[36:39], v[92:95], v[60:63], v[36:39]
    v_mfma_f32_16x16x32_bf16 v[40:43], v[92:95], v[64:67], v[40:43]
    v_mfma_f32_16x16x32_bf16 v[44:47], v[92:95], v[68:71], v[44:47]
    s_waitcnt lgkmcnt(9)
    v_alignbit_b32 v98, v99, v98, v6
    v_alignbit_b32 v99, v100, v99, v6
    v_alignbit_b32 v100, v101, v100, v6
    v_alignbit_b32 v101, v102, v101, v6
    s_nop 1
    v_mfma_f32_16x16x32_bf16 v[28:31], v[98:101], v[48:51], v[28:31]
    v_mfma_f32_16x16x32_bf16 v[32:35], v[98:101], v[52:55], v[32:35]
    v_mfma_f32_16x16x32_bf16 v[36:39], v[98:101], v[56:59], v[36:39]
    v_mfma_f32_16x16x32_bf16 v[40:43], v[98:101], v[60:63], v[40:43]
    v_mfma_f32_16x16x32_bf16 v[44:47], v[98:101], v[64:67], v[44:47]
    s_waitcnt lgkmcnt(6)
    v_alignbit_b32 v104, v105, v104, v6
    v_alignbit_b32 v105, v106, v105, v6
    v_alignbit_b32 v106, v107, v106, v6
    v_alignbit_b32 v107, v108, v107, v6
    s_nop 1
    v_mfma_f32_16x16x32_bf16 v[32:35], v[104:107], v[48:51], v[32:35]
    v_mfma_f32_16x16x32_bf16 v[36:39], v[104:107], v[52:55], v[36:39]
    v_mfma_f32_16x16x32_bf16 v[40:43], v[104:107], v[56:59], v[40:43]
    v_mfma_f32_16x16x32_bf16 v[44:47], v[104:107], v[60:63], v[44:47]
    s_waitcnt lgkmcnt(3)
    v_alignbit_b32 v110, v111, v110, v6
    v_alignbit_b32 v111, v112, v111, v6
    v_alignbit_b32 v112, v113, v112, v6
    v_alignbit_b32 v113, v114, v113, v6
    s_nop 1
    v_mfma_f32_16x16x32_bf16 v[36:39], v[110:113], v[48:51], v[36:39]
    v_mfma_f32_16x16x32_bf16 v[40:43], v[110:113], v[52:55], v[40:43]
    v_mfma_f32_16x16x32_bf16 v[44:47], v[110:113], v[56:59], v[44:47]
    s_waitcnt lgkmcnt(0)
    v_alignbit_b32 v116, v117, v116, v6
    v_alignbit_b32 v117, v118, v117, v6
    v_alignbit_b32 v118, v119, v118, v6
    v_alignbit_b32 v119, v120, v119, v6
    s_nop 1
    v_mfma_f32_16x16x32_bf16 v[40:43], v[116:119], v[48:51], v[40:43]
    v_mfma_f32_16x16x32_bf16 v[44:47], v[116:119], v[52:55], v[44:47]
    s_waitcnt lgkmcnt(0)
    v_alignbit_b32 v80, v81, v80, v6
    v_alignbit_b32 v81, v82, v81, v6
    v_alignbit_b32 v82, v83, v82, v6
    v_alignbit_b32 v83, v84, v83, v6
    s_nop 1
    v_mfma_f32_16x16x32_bf16 v[44:47], v[80:83], v[48:51], v[44:47]
    ds_read_b128 v[48:51], v4 offset:64
    ds_read_b128 v[52:55], v4 offset:576
    ds_read_b128 v[56:59], v4 offset:1088
    ds_read_b128 v[60:63], v4 offset:1600
    ds_read_b128 v[64:67], v4 offset:2112
    ds_read_b128 v[68:71], v4 offset:2624
    ds_read_b128 v[72:75], v4 offset:3136
    ds_read_b128 v[76:79], v4 offset:3648
    v_add_u32 v85, 128, v5
    ds_read2_b32 v[80:81], v85 offset0:0 offset1:1
    ds_read2_b32 v[82:83], v85 offset0:2 offset1:3
    ds_read_b32 v84, v85 offset:16
    v_add_u32 v91, 640, v5
    ds_read2_b32 v[86:87], v91 offset0:0 offset1:1
    ds_read2_b32 v[88:89], v91 offset0:2 offset1:3
    ds_read_b32 v90, v91 offset:16
    v_add_u32 v97, 1152, v5
    ds_read2_b32 v[92:93], v97 offset0:0 offset1:1
    ds_read2_b32 v[94:95], v97 offset0:2 offset1:3
    ds_read_b32 v96, v97 offset:16
    v_add_u32 v103, 1664, v5
    ds_read2_b32 v[98:99], v103 offset0:0 offset1:1
    ds_read2_b32 v[100:101], v103 offset0:2 offset1:3
    ds_read_b32 v102, v103 offset:16
    v_add_u32 v109, 2176, v5
    ds_read2_b32 v[104:105], v109 offset0:0 offset1:1
    ds_read2_b32 v[106:107], v109 offset0:2 offset1:3
    ds_read_b32 v108, v109 offset:16
    v_add_u32 v115, 2688, v5
    ds_read2_b32 v[110:111], v115 offset0:0 offset1:1
    ds_read2_b32 v[112:113], v115 offset0:2 offset1:3
    ds_read_b32 v114, v115 offset:16
    v_add_u32 v121, 3200, v5
    ds_read2_b32 v[116:117], v121 offset0:0 offset1:1
    ds_read2_b32 v[118:119], v121 offset0:2 offset1:3
    ds_read_b32 v120, v121 offset:16
    s_waitcnt lgkmcnt(15)
    v_alignbit_b32 v80, v81, v80, v6
    v_alignbit_b32 v81, v82, v81, v6
    v_alignbit_b32 v82, v83, v82, v6
    v_alignbit_b32 v83, v84, v83, v6
    s_nop 1
    v_mfma_f32_16x16x32_bf16 v[16:19], v[80:83], v[48:51], v[16:19]
    v_mfma_f32_16x16x32_bf16 v[20:23], v[80:83], v[52:55], v[20:23]
    v_mfma_f32_16x16x32_bf16 v[24:27], v[80:83], v[56:59], v[24:27]
    v_mfma_f32_16x16x32_bf16 v[28:31], v[80:83], v[60:63], v[28:31]
    v_mfma_f32_16x16x32_bf16 v[32:35], v[80:83], v[64:67], v[32:35]
    v_mfma_f32_16x16x32_bf16 v[36:39], v[80:83], v[68:71], v[36:39]
    v_mfma_f32_16x16x32_bf16 v[40:43], v[80:83], v[72:75], v[40:43]
    v_mfma_f32_16x16x32_bf16 v[44:47], v[80:83], v[76:79], v[44:47]
    v_add_u32 v85, 3712, v5
    ds_read2_b32 v[80:81], v85 offset0:0 offset1:1
    ds_read2_b32 v[82:83], v85 offset0:2 offset1:3
    ds_read_b32 v84, v85 offset:16
    s_waitcnt lgkmcnt(15)
    v_alignbit_b32 v86, v87, v86, v6
    v_alignbit_b32 v87, v88, v87, v6
    v_alignbit_b32 v88, v89, v88, v6
    v_alignbit_b32 v89, v90, v89, v6
    s_nop 1
    v_mfma_f32_16x16x32_bf16 v[20:23], v[86:89], v[48:51], v[20:23]
    v_mfma_f32_16x16x32_bf16 v[24:27], v[86:89], v[52:55], v[24:27]
    v_mfma_f32_16x16x32_bf16 v[28:31], v[86:89], v[56:59], v[28:31]
    v_mfma_f32_16x16x32_bf16 v[32:35], v[86:89], v[60:63], v[32:35]
    v_mfma_f32_16x16x32_bf16 v[36:39], v[86:89], v[64:67], v[36:39]
    v_mfma_f32_16x16x32_bf16 v[40:43], v[86:89], v[68:71], v[40:43]
    v_mfma_f32_16x16x32_bf16 v[44:47], v[86:89], v[72:75], v[44:47]
    s_waitcnt lgkmcnt(12)
    v_alignbit_b32 v92, v93, v92, v6
    v_alignbit_b32 v93, v94, v93, v6
    v_alignbit_b32 v94, v95, v94, v6
    v_alignbit_b32 v95, v96, v95, v6
    s_nop 1
    v_mfma_f32_16x16x32_bf16 v[24:27], v[92:95], v[48:51], v[24:27]
    v_mfma_f32_16x16x32_bf16 v[28:31], v[92:95], v[52:55], v[28:31]
    v_mfma_f32_16x16x32_bf16 v[32:35], v[92:95], v[56:59], v[32:35]
    v_mfma_f32_16x16x32_bf16 v[36:39], v[92:95], v[60:63], v[36:39]
    v_mfma_f32_16x16x32_bf16 v[40:43], v[92:95], v[64:67], v[40:43]
    v_mfma_f32_16x16x32_bf16 v[44:47], v[92:95], v[68:71], v[44:47]
    s_waitcnt lgkmcnt(9)
    v_alignbit_b32 v98, v99, v98, v6
    v_alignbit_b32 v99, v100, v99, v6
    v_alignbit_b32 v100, v101, v100, v6
    v_alignbit_b32 v101, v102, v101, v6
    s_nop 1
    v_mfma_f32_16x16x32_bf16 v[28:31], v[98:101], v[48:51], v[28:31]
    v_mfma_f32_16x16x32_bf16 v[32:35], v[98:101], v[52:55], v[32:35]
    v_mfma_f32_16x16x32_bf16 v[36:39], v[98:101], v[56:59], v[36:39]
    v_mfma_f32_16x16x32_bf16 v[40:43], v[98:101], v[60:63], v[40:43]
    v_mfma_f32_16x16x32_bf16 v[44:47], v[98:101], v[64:67], v[44:47]
    s_waitcnt lgkmcnt(6)
    v_alignbit_b32 v104, v105, v104, v6
    v_alignbit_b32 v105, v106, v105, v6
    v_alignbit_b32 v106, v107, v106, v6
    v_alignbit_b32 v107, v108, v107, v6
    s_nop 1
    v_mfma_f32_16x16x32_bf16 v[32:35], v[104:107], v[48:51], v[32:35]
    v_mfma_f32_16x16x32_bf16 v[36:39], v[104:107], v[52:55], v[36:39]
    v_mfma_f32_16x16x32_bf16 v[40:43], v[104:107], v[56:59], v[40:43]
    v_mfma_f32_16x16x32_bf16 v[44:47], v[104:107], v[60:63], v[44:47]
    s_waitcnt lgkmcnt(3)
    v_alignbit_b32 v110, v111, v110, v6
    v_alignbit_b32 v111, v112, v111, v6
    v_alignbit_b32 v112, v113, v112, v6
    v_alignbit_b32 v113, v114, v113, v6
    s_nop 1
    v_mfma_f32_16x16x32_bf16 v[36:39], v[110:113], v[48:51], v[36:39]
    v_mfma_f32_16x16x32_bf16 v[40:43], v[110:113], v[52:55], v[40:43]
    v_mfma_f32_16x16x32_bf16 v[44:47], v[110:113], v[56:59], v[44:47]
    s_waitcnt lgkmcnt(0)
    v_alignbit_b32 v116, v117, v116, v6
    v_alignbit_b32 v117, v118, v117, v6
    v_alignbit_b32 v118, v119, v118, v6
    v_alignbit_b32 v119, v120, v119, v6
    s_nop 1
    v_mfma_f32_16x16x32_bf16 v[40:43], v[116:119], v[48:51], v[40:43]
    v_mfma_f32_16x16x32_bf16 v[44:47], v[116:119], v[52:55], v[44:47]
    s_waitcnt lgkmcnt(0)
    v_alignbit_b32 v80, v81, v80, v6
    v_alignbit_b32 v81, v82, v81, v6
    v_alignbit_b32 v82, v83, v82, v6
    v_alignbit_b32 v83, v84, v83, v6
    s_nop 1
    v_mfma_f32_16x16x32_bf16 v[44:47], v[80:83], v[48:51], v[44:47]
    ds_read_b128 v[48:51], v4 offset:0
    ds_read_b128 v[52:55], v4 offset:512
    ds_read_b128 v[56:59], v4 offset:1024
    ds_read_b128 v[60:63], v4 offset:1536
    ds_read_b128 v[64:67], v4 offset:2048
    ds_read_b128 v[68:71], v4 offset:2560
    ds_read_b128 v[72:75], v4 offset:3072
    ds_read_b128 v[76:79], v4 offset:3584
    v_add_u32 v85, 192, v5
    ds_read2_b32 v[80:81], v85 offset0:0 offset1:1
    ds_read2_b32 v[82:83], v85 offset0:2 offset1:3
    ds_read_b32 v84, v85 offset:16
    v_add_u32 v91, 704, v5
    ds_read2_b32 v[86:87], v91 offset0:0 offset1:1
    ds_read2_b32 v[88:89], v91 offset0:2 offset1:3
    ds_read_b32 v90, v91 offset:16
    v_add_u32 v97, 1216, v5
    ds_read2_b32 v[92:93], v97 offset0:0 offset1:1
    ds_read2_b32 v[94:95], v97 offset0:2 offset1:3
    ds_read_b32 v96, v97 offset:16
    v_add_u32 v103, 1728, v5
    ds_read2_b32 v[98:99], v103 offset0:0 offset1:1
    ds_read2_b32 v[100:101], v103 offset0:2 offset1:3
    ds_read_b32 v102, v103 offset:16
    v_add_u32 v109, 2240, v5
    ds_read2_b32 v[104:105], v109 offset0:0 offset1:1
    ds_read2_b32 v[106:107], v109 offset0:2 offset1:3
    ds_read_b32 v108, v109 offset:16
    v_add_u32 v115, 2752, v5
    ds_read2_b32 v[110:111], v115 offset0:0 offset1:1
    ds_read2_b32 v[112:113], v115 offset0:2 offset1:3
    ds_read_b32 v114, v115 offset:16
    v_add_u32 v121, 3264, v5
    ds_read2_b32 v[116:117], v121 offset0:0 offset1:1
    ds_read2_b32 v[118:119], v121 offset0:2 offset1:3
    ds_read_b32 v120, v121 offset:16
    s_waitcnt lgkmcnt(15)
    v_alignbit_b32 v80, v81, v80, v6
    v_alignbit_b32 v81, v82, v81, v6
    v_alignbit_b32 v82, v83, v82, v6
    v_alignbit_b32 v83, v84, v83, v6
    s_nop 1
    v_mfma_f32_16x16x32_bf16 v[16:19], v[80:83], v[48:51], v[16:19]
    v_mfma_f32_16x16x32_bf16 v[20:23], v[80:83], v[52:55], v[20:23]
    v_mfma_f32_16x16x32_bf16 v[24:27], v[80:83], v[56:59], v[24:27]
    v_mfma_f32_16x16x32_bf16 v[28:31], v[80:83], v[60:63], v[28:31]
    v_mfma_f32_16x16x32_bf16 v[32:35], v[80:83], v[64:67], v[32:35]
    v_mfma_f32_16x16x32_bf16 v[36:39], v[80:83], v[68:71], v[36:39]
    v_mfma_f32_16x16x32_bf16 v[40:43], v[80:83], v[72:75], v[40:43]
    v_mfma_f32_16x16x32_bf16 v[44:47], v[80:83], v[76:79], v[44:47]
    v_add_u32 v85, 3776, v5
    ds_read2_b32 v[80:81], v85 offset0:0 offset1:1
    ds_read2_b32 v[82:83], v85 offset0:2 offset1:3
    ds_read_b32 v84, v85 offset:16
    s_waitcnt lgkmcnt(15)
    v_alignbit_b32 v86, v87, v86, v6
    v_alignbit_b32 v87, v88, v87, v6
    v_alignbit_b32 v88, v89, v88, v6
    v_alignbit_b32 v89, v90, v89, v6
    s_nop 1
    v_mfma_f32_16x16x32_bf16 v[20:23], v[86:89], v[48:51], v[20:23]
    v_mfma_f32_16x16x32_bf16 v[24:27], v[86:89], v[52:55], v[24:27]
    v_mfma_f32_16x16x32_bf16 v[28:31], v[86:89], v[56:59], v[28:31]
    v_mfma_f32_16x16x32_bf16 v[32:35], v[86:89], v[60:63], v[32:35]
    v_mfma_f32_16x16x32_bf16 v[36:39], v[86:89], v[64:67], v[36:39]
    v_mfma_f32_16x16x32_bf16 v[40:43], v[86:89], v[68:71], v[40:43]
    v_mfma_f32_16x16x32_bf16 v[44:47], v[86:89], v[72:75], v[44:47]
    s_waitcnt lgkmcnt(12)
    v_alignbit_b32 v92, v93, v92, v6
    v_alignbit_b32 v93, v94, v93, v6
    v_alignbit_b32 v94, v95, v94, v6
    v_alignbit_b32 v95, v96, v95, v6
    s_nop 1
    v_mfma_f32_16x16x32_bf16 v[24:27], v[92:95], v[48:51], v[24:27]
    v_mfma_f32_16x16x32_bf16 v[28:31], v[92:95], v[52:55], v[28:31]
    v_mfma_f32_16x16x32_bf16 v[32:35], v[92:95], v[56:59], v[32:35]
    v_mfma_f32_16x16x32_bf16 v[36:39], v[92:95], v[60:63], v[36:39]
    v_mfma_f32_16x16x32_bf16 v[40:43], v[92:95], v[64:67], v[40:43]
    v_mfma_f32_16x16x32_bf16 v[44:47], v[92:95], v[68:71], v[44:47]
    s_waitcnt lgkmcnt(9)
    v_alignbit_b32 v98, v99, v98, v6
    v_alignbit_b32 v99, v100, v99, v6
    v_alignbit_b32 v100, v101, v100, v6
    v_alignbit_b32 v101, v102, v101, v6
    s_nop 1
    v_mfma_f32_16x16x32_bf16 v[28:31], v[98:101], v[48:51], v[28:31]
    v_mfma_f32_16x16x32_bf16 v[32:35], v[98:101], v[52:55], v[32:35]
    v_mfma_f32_16x16x32_bf16 v[36:39], v[98:101], v[56:59], v[36:39]
    v_mfma_f32_16x16x32_bf16 v[40:43], v[98:101], v[60:63], v[40:43]
    v_mfma_f32_16x16x32_bf16 v[44:47], v[98:101], v[64:67], v[44:47]
    s_waitcnt lgkmcnt(6)
    v_alignbit_b32 v104, v105, v104, v6
    v_alignbit_b32 v105, v106, v105, v6
    v_alignbit_b32 v106, v107, v106, v6
    v_alignbit_b32 v107, v108, v107, v6
    s_nop 1
    v_mfma_f32_16x16x32_bf16 v[32:35], v[104:107], v[48:51], v[32:35]
    v_mfma_f32_16x16x32_bf16 v[36:39], v[104:107], v[52:55], v[36:39]
    v_mfma_f32_16x16x32_bf16 v[40:43], v[104:107], v[56:59], v[40:43]
    v_mfma_f32_16x16x32_bf16 v[44:47], v[104:107], v[60:63], v[44:47]
    s_waitcnt lgkmcnt(3)
    v_alignbit_b32 v110, v111, v110, v6
    v_alignbit_b32 v111, v112, v111, v6
    v_alignbit_b32 v112, v113, v112, v6
    v_alignbit_b32 v113, v114, v113, v6
    s_nop 1
    v_mfma_f32_16x16x32_bf16 v[36:39], v[110:113], v[48:51], v[36:39]
    v_mfma_f32_16x16x32_bf16 v[40:43], v[110:113], v[52:55], v[40:43]
    v_mfma_f32_16x16x32_bf16 v[44:47], v[110:113], v[56:59], v[44:47]
    s_waitcnt lgkmcnt(0)
    v_alignbit_b32 v116, v117, v116, v6
    v_alignbit_b32 v117, v118, v117, v6
    v_alignbit_b32 v118, v119, v118, v6
    v_alignbit_b32 v119, v120, v119, v6
    s_nop 1
    v_mfma_f32_16x16x32_bf16 v[40:43], v[116:119], v[48:51], v[40:43]
    v_mfma_f32_16x16x32_bf16 v[44:47], v[116:119], v[52:55], v[44:47]
    s_waitcnt lgkmcnt(0)
    v_alignbit_b32 v80, v81, v80, v6
    v_alignbit_b32 v81, v82, v81, v6
    v_alignbit_b32 v82, v83, v82, v6
    v_alignbit_b32 v83, v84, v83, v6
    s_nop 1
    v_mfma_f32_16x16x32_bf16 v[44:47], v[80:83], v[48:51], v[44:47]
    s_lshl_b32 s5, s89, 12
    s_add_u32 s5, s5, s15
    v_lshl_add_u32 v10, v1, 4, s5
    s_xor_b32 s6, s89, 1
    s_lshl_b32 s6, s6, 12
    s_add_u32 s6, s6, s15
    v_lshl_add_u32 v11, v1, 4, s6
    s_nop 2
    s_cmp_lg_u32 s89, 0
    s_cbranch_scc1 CV_X1
    ds_write_b128 v10, v[32:35] offset:0
    ds_write_b128 v10, v[36:39] offset:1024
    ds_write_b128 v10, v[40:43] offset:2048
    ds_write_b128 v10, v[44:47] offset:3072
    s_branch CV_X2
CV_X1:
    ds_write_b128 v10, v[16:19] offset:0
    ds_write_b128 v10, v[20:23] offset:1024
    ds_write_b128 v10, v[24:27] offset:2048
    ds_write_b128 v10, v[28:31] offset:3072
    v_mov_b32 v16, v32
    v_mov_b32 v17, v33
    v_mov_b32 v18, v34
    v_mov_b32 v19, v35
    v_mov_b32 v20, v36
    v_mov_b32 v21, v37
    v_mov_b32 v22, v38
    v_mov_b32 v23, v39
    v_mov_b32 v24, v40
    v_mov_b32 v25, v41
    v_mov_b32 v26, v42
    v_mov_b32 v27, v43
    v_mov_b32 v28, v44
    v_mov_b32 v29, v45
    v_mov_b32 v30, v46
    v_mov_b32 v31, v47
CV_X2:
    ds_read_b64 v[48:49], v8 offset:32
    ds_read_b64 v[50:51], v8 offset:544
    ds_read_b64 v[52:53], v8 offset:1056
    ds_read_b64 v[54:55], v8 offset:1568
    v_lshlrev_b32 v7, 16, v7
    s_waitcnt lgkmcnt(0)
    s_barrier
    ds_read_b128 v[32:35], v11 offset:0
    ds_read_b128 v[36:39], v11 offset:1024
    ds_read_b128 v[40:43], v11 offset:2048
    ds_read_b128 v[44:47], v11 offset:3072
    s_waitcnt lgkmcnt(0)
    s_barrier
    v_add_f32 v16, v16, v32
    v_add_f32 v17, v17, v33
    v_add_f32 v18, v18, v34
    v_add_f32 v19, v19, v35
    v_cvt_pk_bf16_f32 v10, v16, v17
    v_lshlrev_b32 v12, 16, v48
    v_and_b32 v13, s85, v48
    v_mul_f32 v12, v7, v12
    v_mul_f32 v13, v7, v13
    v_cvt_pk_bf16_f32 v12, v12, v13
    v_lshlrev_b32 v11, 16, v10
    v_and_b32 v10, s85, v10
    v_lshlrev_b32 v13, 16, v12
    v_and_b32 v12, s85, v12
    v_add_f32 v11, v11, v13
    v_add_f32 v10, v10, v12
    v_cvt_pk_bf16_f32 v14, v11, v10
    ds_write_b16 v9, v14 offset:0
    ds_write_b16_d16_hi v9, v14 offset:128
    v_cvt_pk_bf16_f32 v10, v18, v19
    v_lshlrev_b32 v12, 16, v49
    v_and_b32 v13, s85, v49
    v_mul_f32 v12, v7, v12
    v_mul_f32 v13, v7, v13
    v_cvt_pk_bf16_f32 v12, v12, v13
    v_lshlrev_b32 v11, 16, v10
    v_and_b32 v10, s85, v10
    v_lshlrev_b32 v13, 16, v12
    v_and_b32 v12, s85, v12
    v_add_f32 v11, v11, v13
    v_add_f32 v10, v10, v12
    v_cvt_pk_bf16_f32 v15, v11, v10
    ds_write_b16 v9, v15 offset:256
    ds_write_b16_d16_hi v9, v15 offset:384
    v_add_f32 v20, v20, v36
    v_add_f32 v21, v21, v37
    v_add_f32 v22, v22, v38
    v_add_f32 v23, v23, v39
    v_cvt_pk_bf16_f32 v10, v20, v21
    v_lshlrev_b32 v12, 16, v50
    v_and_b32 v13, s85, v50
    v_mul_f32 v12, v7, v12
    v_mul_f32 v13, v7, v13
    v_cvt_pk_bf16_f32 v12, v12, v13
    v_lshlrev_b32 v11, 16, v10
    v_and_b32 v10, s85, v10
    v_lshlrev_b32 v13, 16, v12
    v_and_b32 v12, s85, v12
    v_add_f32 v11, v11, v13
    v_add_f32 v10, v10, v12
    v_cvt_pk_bf16_f32 v14, v11, v10
    ds_write_b16 v9, v14 offset:2048
    ds_write_b16_d16_hi v9, v14 offset:2176
    v_cvt_pk_bf16_f32 v10, v22, v23
    v_lshlrev_b32 v12, 16, v51
    v_and_b32 v13, s85, v51
    v_mul_f32 v12, v7, v12
    v_mul_f32 v13, v7, v13
    v_cvt_pk_bf16_f32 v12, v12, v13
    v_lshlrev_b32 v11, 16, v10
    v_and_b32 v10, s85, v10
    v_lshlrev_b32 v13, 16, v12
    v_and_b32 v12, s85, v12
    v_add_f32 v11, v11, v13
    v_add_f32 v10, v10, v12
    v_cvt_pk_bf16_f32 v15, v11, v10
    ds_write_b16 v9, v15 offset:2304
    ds_write_b16_d16_hi v9, v15 offset:2432
    v_add_f32 v24, v24, v40
    v_add_f32 v25, v25, v41
    v_add_f32 v26, v26, v42
    v_add_f32 v27, v27, v43
    v_cvt_pk_bf16_f32 v10, v24, v25
    v_lshlrev_b32 v12, 16, v52
    v_and_b32 v13, s85, v52
    v_mul_f32 v12, v7, v12
    v_mul_f32 v13, v7, v13
    v_cvt_pk_bf16_f32 v12, v12, v13
    v_lshlrev_b32 v11, 16, v10
    v_and_b32 v10, s85, v10
    v_lshlrev_b32 v13, 16, v12
    v_and_b32 v12, s85, v12
    v_add_f32 v11, v11, v13
    v_add_f32 v10, v10, v12
    v_cvt_pk_bf16_f32 v14, v11, v10
    ds_write_b16 v9, v14 offset:4096
    ds_write_b16_d16_hi v9, v14 offset:4224
    v_cvt_pk_bf16_f32 v10, v26, v27
    v_lshlrev_b32 v12, 16, v53
    v_and_b32 v13, s85, v53
    v_mul_f32 v12, v7, v12
    v_mul_f32 v13, v7, v13
    v_cvt_pk_bf16_f32 v12, v12, v13
    v_lshlrev_b32 v11, 16, v10
    v_and_b32 v10, s85, v10
    v_lshlrev_b32 v13, 16, v12
    v_and_b32 v12, s85, v12
    v_add_f32 v11, v11, v13
    v_add_f32 v10, v10, v12
    v_cvt_pk_bf16_f32 v15, v11, v10
    ds_write_b16 v9, v15 offset:4352
    ds_write_b16_d16_hi v9, v15 offset:4480
    v_add_f32 v28, v28, v44
    v_add_f32 v29, v29, v45
    v_add_f32 v30, v30, v46
    v_add_f32 v31, v31, v47
    v_cvt_pk_bf16_f32 v10, v28, v29
    v_lshlrev_b32 v12, 16, v54
    v_and_b32 v13, s85, v54
    v_mul_f32 v12, v7, v12
    v_mul_f32 v13, v7, v13
    v_cvt_pk_bf16_f32 v12, v12, v13
    v_lshlrev_b32 v11, 16, v10
    v_and_b32 v10, s85, v10
    v_lshlrev_b32 v13, 16, v12
    v_and_b32 v12, s85, v12
    v_add_f32 v11, v11, v13
    v_add_f32 v10, v10, v12
    v_cvt_pk_bf16_f32 v14, v11, v10
    ds_write_b16 v9, v14 offset:6144
    ds_write_b16_d16_hi v9, v14 offset:6272
    v_cvt_pk_bf16_f32 v10, v30, v31
    v_lshlrev_b32 v12, 16, v55
    v_and_b32 v13, s85, v55
    v_mul_f32 v12, v7, v12
    v_mul_f32 v13, v7, v13
    v_cvt_pk_bf16_f32 v12, v12, v13
    v_lshlrev_b32 v11, 16, v10
    v_and_b32 v10, s85, v10
    v_lshlrev_b32 v13, 16, v12
    v_and_b32 v12, s85, v12
    v_add_f32 v11, v11, v13
    v_add_f32 v10, v10, v12
    v_cvt_pk_bf16_f32 v15, v11, v10
    ds_write_b16 v9, v15 offset:6400
    ds_write_b16_d16_hi v9, v15 offset:6528
    v_and_b32 v10, 15, v0
    v_lshlrev_b32 v10, 4, v10
    v_bfe_u32 v11, v0, 6, 2
    v_lshl_add_u32 v10, v11, 2, v10
    v_bfe_u32 v11, v0, 4, 2
    v_add_u32 v10, v10, v11
    v_lshrrev_b32 v11, 8, v0
    v_lshl_add_u32 v10, v11, 8, v10
    s_movk_i32 s5, 2560
    v_mul_u32_u24 v10, s5, v10
    s_lshl_b32 s5, s12, 3
    s_add_u32 s5, s5, 1280
    v_add_u32 v10, s5, v10
    v_lshlrev_b32 v11, 3, v0
    s_waitcnt lgkmcnt(0)
    s_barrier
    ds_read_b64 v[48:49], v11 offset:0
    ds_read_b64 v[50:51], v11 offset:4096
    ds_read_b64 v[52:53], v11 offset:8192
    ds_read_b64 v[54:55], v11 offset:12288
    s_waitcnt lgkmcnt(3)
    s_mov_b32 s5, 0
    buffer_store_dwordx2 v[48:49], v10, s[52:55], s5 offen
    s_waitcnt lgkmcnt(2)
    s_mov_b32 s5, 1310720
    buffer_store_dwordx2 v[50:51], v10, s[52:55], s5 offen
    s_waitcnt lgkmcnt(1)
    s_mov_b32 s5, 2621440
    buffer_store_dwordx2 v[52:53], v10, s[52:55], s5 offen
    s_waitcnt lgkmcnt(0)
    s_mov_b32 s5, 3932160
    buffer_store_dwordx2 v[54:55], v10, s[52:55], s5 offen
    s_endpgm
K1_EXIT:
    s_endpgm
.section .rodata,"a"
.p2align 6
.amdhsa_kernel concat_heads__linear_attn_block__ssm_conv_s4d__prompt_kernel
  .amdhsa_next_free_vgpr 128
  .amdhsa_next_free_sgpr 102
  .amdhsa_accum_offset 128
  .amdhsa_group_segment_fixed_size 0
  .amdhsa_kernarg_size 104
  .amdhsa_user_sgpr_count 2
  .amdhsa_user_sgpr_kernarg_segment_ptr 1
  .amdhsa_system_sgpr_workgroup_id_x 1
  .amdhsa_float_denorm_mode_32 3
.end_amdhsa_kernel
```
